```python
import torch

def _softmax(x, axis=-1):
    return torch.softmax(x, dim=axis)
def _gelu(x):
    return torch.nn.functional.gelu(x, approximate="tanh")
def _silu(x):
    return torch.nn.functional.silu(x)
def _sigmoid(x):
    return torch.sigmoid(x)
def _layernorm(x, axis=-1, eps=1e-5):
    m = x.mean(dim=axis, keepdim=True)
    v = x.var(dim=axis, keepdim=True, unbiased=False)
    return (x - m) / torch.sqrt(v + eps)
def _scatter_add(tgt, idx, src, axis=0):
    return tgt.clone().index_add_(axis, idx, src)
def _segment_sum(src, seg, n):
    out = torch.zeros((n,) + src.shape[1:], dtype=src.dtype)
    return out.index_add_(0, seg, src)
def _pad(x, pw):
    flat = tuple(v for pair in reversed(pw) for v in pair)
    return torch.nn.functional.pad(x, flat)

kernel_name = 'standalone__gqa_block_cached__near_ridge'

def setup_inputs():

    _w = (lambda a: (lambda t: t.to(torch.bfloat16) if t.is_floating_point() else t)(torch.as_tensor(a)))
    B, Sq, D = 8, 80, 512
    Hq, Hkv, Sk, Dh = 32, 8, 2048, 128
    assert Hq % Hkv == 0, (Hq, Hkv)
    return {
        "x": _w((lambda *s: torch.randn(*s, dtype=torch.bfloat16) * 0.8)(B, Sq, D)),
        "k_cache": _w((lambda *s: torch.randn(*s, dtype=torch.bfloat16) * 0.8)(B, Hkv, Sk, Dh)),
        "v_cache": _w((lambda *s: torch.randn(*s, dtype=torch.bfloat16) * 0.05)(B, Hkv, Sk, Dh)),
        "wq": _w((lambda *s: torch.randn(*s, dtype=torch.bfloat16) * 0.8)(D, Hq * Dh) * (D ** -0.5)),
        "wo": _w((lambda *s: torch.randn(*s, dtype=torch.bfloat16) * 0.05)(Hq * Dh, D) * ((Hq * Dh) ** -0.5)),
    }

def reference(x, k_cache, v_cache, wq, wo):
    B, Sq, D = x.shape
    Hq, Dh = 32, 128
    Hkv = k_cache.shape[1]
    rep = Hq // Hkv
    q = (lambda x, *d: x.permute(*d))((x @ wq).reshape(B, Sq, Hq, Dh), 0, 2, 1, 3)
    k = (lambda x, n, axis: torch.repeat_interleave(x, n, dim=axis))(k_cache, rep, axis=1)
    v = (lambda x, n, axis: torch.repeat_interleave(x, n, dim=axis))(v_cache, rep, axis=1)
    scores = torch.einsum("bhqd,bhkd->bhqk", q, k) * (Dh ** -0.5)
    p = _softmax(scores, axis=-1)
    o = torch.einsum("bhqk,bhkd->bhqd", p, v)
    return (lambda x, *d: x.permute(*d))(o, 0, 2, 1, 3).reshape(B, Sq, Hq * Dh) @ wo
```

```asm
; @launch grid=(256,1,1) block=(256,1,1) lds=163840
.amdgcn_target "amdgcn-amd-amdhsa--gfx950"
.text
.globl standalone__gqa_block_cached__near_ridge_kernel
.p2align 8
.type standalone__gqa_block_cached__near_ridge_kernel,@function
standalone__gqa_block_cached__near_ridge_kernel:
    s_cmp_ge_u32 s2, 256
    s_cbranch_scc1 L_end
    s_load_dwordx8 s[4:11], s[0:1], 0
    s_load_dwordx4 s[44:47], s[0:1], 32
    s_load_dwordx4 s[48:51], s[0:1], 48
    v_lshrrev_b32 v1, 6, v0
    v_and_b32 v0, 63, v0
    v_readfirstlane_b32 s20, v1
    s_and_b32 s23, s2, 7
    s_lshr_b32 s22, s2, 3
    s_and_b32 s22, s22, 3
    s_lshr_b32 s21, s2, 5
    s_lshl_b32 s65, s21, 3
    s_add_u32 s65, s65, s23
    s_mov_b32 s27, 0
    s_mov_b32 s64, 0
L_restart:
    v_and_b32 v2, 15, v0
    v_lshrrev_b32 v3, 4, v0
    v_lshlrev_b32 v252, 4, v0
    v_xor_b32 v4, v2, v3
    s_lshl_b32 s28, s20, 4
    v_add_u32 v6, s28, v3
    v_xor_b32 v5, 0, v4
    v_lshlrev_b32 v5, 4, v5
    v_lshl_add_u32 v5, v6, 10, v5
    v_add_u32 v60, 0, v5
    v_xor_b32 v5, 4, v4
    v_lshlrev_b32 v5, 4, v5
    v_lshl_add_u32 v5, v6, 10, v5
    v_add_u32 v61, 3072, v5
    v_xor_b32 v5, 8, v4
    v_lshlrev_b32 v5, 4, v5
    v_lshl_add_u32 v5, v6, 10, v5
    v_add_u32 v62, 6144, v5
    v_xor_b32 v5, 12, v4
    v_lshlrev_b32 v5, 4, v5
    v_lshl_add_u32 v5, v6, 10, v5
    v_add_u32 v63, 9216, v5
    s_lshl_b32 s28, s20, 2
    v_xor_b32 v5, s28, v4
    v_lshlrev_b32 v5, 4, v5
    s_add_u32 s28, s28, 64
    v_add_u32 v6, s28, v3
    v_lshl_add_u32 v64, v6, 10, v5
    s_lshl_b32 s28, s20, 5
    v_add_u32 v4, s28, v3
    v_lshlrev_b32 v5, 2, v3
    v_xor_b32 v5, v5, v2
    v_lshlrev_b32 v5, 4, v5
    v_lshl_add_u32 v5, v4, 13, v5
    v_add_u32 v65, 0, v5
    v_add_u32 v66, 31744, v5
    v_add_u32 v67, 63488, v5
    v_add_u32 v68, 95232, v5
    s_add_u32 s28, s22, s21
    s_and_b32 s67, s28, 3
    s_lshr_b32 s28, s21, 2
    s_lshl_b32 s90, s28, 17
    s_lshl_b32 s91, s28, 12
    s_lshl_b32 s28, s23, 2
    s_add_u32 s28, s28, s22
    s_lshl_b32 s31, s28, 8
    s_waitcnt lgkmcnt(0)
    s_mul_i32 s28, s21, 81920
    s_add_u32 s32, s4, s28
    s_addc_u32 s33, s5, 0
    s_and_b32 s33, s33, 0xffff
    s_mov_b32 s34, 81920
    s_mov_b32 s35, 0x20000
    s_mov_b32 s36, s10
    s_and_b32 s37, s11, 0xffff
    s_mov_b32 s38, 0x400000
    s_mov_b32 s39, 0x20000
    s_add_u32 s28, s67, 0
    s_and_b32 s28, s28, 3
    s_lshl_b32 s29, s28, 8
    s_lshl_b32 s30, s20, 12
    s_add_u32 m0, s30, 143360
    s_nop 0
    buffer_load_dwordx4 v60, s[32:35], s29 offen offset:0 lds
    buffer_load_dwordx4 v61, s[32:35], s29 offen offset:1024 lds
    buffer_load_dwordx4 v62, s[32:35], s29 offen offset:2048 lds
    buffer_load_dwordx4 v63, s[32:35], s29 offen offset:3072 lds
    s_lshl_b32 s30, s20, 10
    s_add_u32 m0, s30, 159744
    s_nop 0
    buffer_load_dwordx4 v64, s[32:35], s29 offen offset:0 lds
    s_lshl_b32 s29, s28, 20
    s_add_u32 s29, s29, s31
    s_add_u32 s28, s29, s90
    s_lshl_b32 s30, s20, 13
    s_add_u32 s30, s30, 110592
    s_add_u32 m0, s30, s91
    s_nop 0
    buffer_load_dwordx4 v65, s[36:39], s28 offen offset:0 lds
    buffer_load_dwordx4 v66, s[36:39], s28 offen offset:1024 lds
    buffer_load_dwordx4 v67, s[36:39], s28 offen offset:2048 lds
    buffer_load_dwordx4 v68, s[36:39], s28 offen offset:3072 lds
    s_xor_b32 s28, s90, 131072
    s_add_u32 s28, s28, s29
    s_xor_b32 s29, s91, 4096
    s_add_u32 m0, s30, s29
    s_nop 0
    buffer_load_dwordx4 v65, s[36:39], s28 offen offset:0 lds
    buffer_load_dwordx4 v66, s[36:39], s28 offen offset:1024 lds
    buffer_load_dwordx4 v67, s[36:39], s28 offen offset:2048 lds
    buffer_load_dwordx4 v68, s[36:39], s28 offen offset:3072 lds
    s_lshl_b32 s28, s65, 19
    s_lshl_b32 s29, s20, 17
    s_add_u32 s28, s28, s29
    s_add_u32 s12, s6, s28
    s_addc_u32 s13, s7, 0
    s_and_b32 s13, s13, 0xffff
    s_mov_b32 s14, 0x20000
    s_mov_b32 s15, 0x20000
    s_add_u32 s16, s8, s28
    s_addc_u32 s17, s9, 0
    s_and_b32 s17, s17, 0xffff
    s_mov_b32 s18, 0x20000
    s_mov_b32 s19, 0x20000
    s_mov_b32 s40, s50
    s_and_b32 s41, s51, 0xffff
    s_mov_b32 s42, 0x4000000
    s_mov_b32 s43, 0x20000
    s_mov_b32 s52, s44
    s_and_b32 s53, s45, 0xffff
    s_mov_b32 s54, 0x400000
    s_mov_b32 s55, 0x20000
    s_mov_b32 s56, s46
    s_and_b32 s57, s47, 0xffff
    s_mov_b32 s58, 0xa0000
    s_mov_b32 s59, 0x20000
    s_mov_b32 s60, s48
    s_and_b32 s61, s49, 0xffff
    s_mov_b32 s62, 0x100
    s_mov_b32 s63, 0x20000
    s_cmp_eq_u32 s27, 0
    s_cbranch_scc0 L_not_leader
    s_or_b32 s28, s23, s22
    s_or_b32 s28, s28, s20
    s_cmp_eq_u32 s28, 0
    s_cbranch_scc0 L_not_leader
    s_memrealtime s[28:29]
    s_waitcnt lgkmcnt(0)
    s_or_b32 s28, s28, 1
    v_mov_b32 v5, s28
    s_lshl_b32 s29, s21, 5
    v_mov_b32 v4, s29
    buffer_store_dword v5, v4, s[60:63], 0 offen sc1
L_not_leader:
    v_lshrrev_b32 v4, 2, v2
    v_xor_b32 v5, s20, v4
    v_lshlrev_b32 v5, 6, v5
    v_lshl_add_u32 v6, v3, 3, v4
    v_lshl_add_u32 v5, v6, 8, v5
    v_and_b32 v6, 3, v0
    v_lshl_add_u32 v69, v6, 4, v5
    v_add_u32 v5, 0, v3
    v_xor_b32 v5, v5, v2
    v_lshlrev_b32 v5, 4, v5
    v_lshl_add_u32 v56, v2, 8, v5
    v_add_u32 v5, 4, v3
    v_xor_b32 v5, v5, v2
    v_lshlrev_b32 v5, 4, v5
    v_lshl_add_u32 v57, v2, 8, v5
    v_add_u32 v5, 8, v3
    v_xor_b32 v5, v5, v2
    v_lshlrev_b32 v5, 4, v5
    v_lshl_add_u32 v58, v2, 8, v5
    v_add_u32 v5, 12, v3
    v_xor_b32 v5, v5, v2
    v_lshlrev_b32 v5, 4, v5
    v_lshl_add_u32 v59, v2, 8, v5
    s_lshl_b32 s24, s20, 13
    v_xor_b32 v6, v2, v3
    v_xor_b32 v5, 0, v6
    v_lshlrev_b32 v5, 4, v5
    v_lshl_add_u32 v20, v3, 8, v5
    v_xor_b32 v5, 4, v6
    v_lshlrev_b32 v5, 4, v5
    v_lshl_add_u32 v21, v3, 8, v5
    v_xor_b32 v5, 8, v6
    v_lshlrev_b32 v5, 4, v5
    v_lshl_add_u32 v22, v3, 8, v5
    v_xor_b32 v5, 12, v6
    v_lshlrev_b32 v5, 4, v5
    v_lshl_add_u32 v23, v3, 8, v5
    v_add_u32 v5, 0, v3
    v_lshlrev_b32 v5, 1, v5
    v_xor_b32 v5, v5, v2
    v_lshlrev_b32 v5, 4, v5
    v_lshl_add_u32 v24, v3, 8, v5
    v_add_u32 v5, 4, v3
    v_lshlrev_b32 v5, 1, v5
    v_xor_b32 v5, v5, v2
    v_lshlrev_b32 v5, 4, v5
    v_lshl_add_u32 v25, v3, 8, v5
    v_add_u32 v5, 0, v3
    v_xor_b32 v5, v5, v2
    v_lshlrev_b32 v5, 4, v5
    v_lshl_add_u32 v5, v2, 8, v5
    v_add_u32 v8, s24, v5
    v_add_u32 v5, 4, v3
    v_xor_b32 v5, v5, v2
    v_lshlrev_b32 v5, 4, v5
    v_lshl_add_u32 v5, v2, 8, v5
    v_add_u32 v9, s24, v5
    v_add_u32 v5, 8, v3
    v_xor_b32 v5, v5, v2
    v_lshlrev_b32 v5, 4, v5
    v_lshl_add_u32 v5, v2, 8, v5
    v_add_u32 v10, s24, v5
    v_add_u32 v5, 12, v3
    v_xor_b32 v5, v5, v2
    v_lshlrev_b32 v5, 4, v5
    v_lshl_add_u32 v5, v2, 8, v5
    v_add_u32 v11, s24, v5
    v_lshrrev_b32 v4, 2, v2
    v_lshl_add_u32 v4, v3, 2, v4
    v_and_b32 v5, 7, v4
    v_lshlrev_b32 v5, 1, v5
    v_and_b32 v6, 3, v0
    v_lshrrev_b32 v6, 1, v6
    v_and_b32 v7, 1, v0
    v_lshlrev_b32 v7, 3, v7
    v_lshl_add_u32 v7, v4, 8, v7
    s_lshl_b32 s28, s20, 2
    s_add_u32 s29, s28, 0
    v_add_u32 v1, s29, v6
    v_xor_b32 v1, v1, v5
    v_lshl_add_u32 v26, v1, 4, v7
    s_add_u32 s29, s28, 2
    v_add_u32 v1, s29, v6
    v_xor_b32 v1, v1, v5
    v_lshl_add_u32 v27, v1, 4, v7
    s_add_u32 s28, s24, 65536
    v_add_u32 v7, s28, v7
    v_add_u32 v1, 0, v6
    v_xor_b32 v1, v1, v5
    v_lshl_add_u32 v12, v1, 4, v7
    v_add_u32 v1, 2, v6
    v_xor_b32 v1, v1, v5
    v_lshl_add_u32 v13, v1, 4, v7
    v_add_u32 v1, 4, v6
    v_xor_b32 v1, v1, v5
    v_lshl_add_u32 v14, v1, 4, v7
    v_add_u32 v1, 6, v6
    v_xor_b32 v1, v1, v5
    v_lshl_add_u32 v15, v1, 4, v7
    v_add_u32 v1, 8, v6
    v_xor_b32 v1, v1, v5
    v_lshl_add_u32 v16, v1, 4, v7
    v_add_u32 v1, 10, v6
    v_xor_b32 v1, v1, v5
    v_lshl_add_u32 v17, v1, 4, v7
    v_add_u32 v1, 12, v6
    v_xor_b32 v1, v1, v5
    v_lshl_add_u32 v18, v1, 4, v7
    v_add_u32 v1, 14, v6
    v_xor_b32 v1, v1, v5
    v_lshl_add_u32 v19, v1, 4, v7
    v_add_u32 v5, 0, v3
    v_lshlrev_b32 v5, 1, v5
    v_xor_b32 v5, v5, v2
    v_lshlrev_b32 v5, 4, v5
    v_add_u32 v6, 0, v3
    v_lshl_add_u32 v5, v6, 10, v5
    v_subrev_u32 v244, 0, v5
    v_add_u32 v5, 4, v3
    v_lshlrev_b32 v5, 1, v5
    v_xor_b32 v5, v5, v2
    v_lshlrev_b32 v5, 4, v5
    v_add_u32 v6, 4, v3
    v_lshl_add_u32 v5, v6, 10, v5
    v_subrev_u32 v245, 1024, v5
    v_add_u32 v5, 0, v3
    v_lshlrev_b32 v5, 1, v5
    v_xor_b32 v5, v5, v2
    v_lshlrev_b32 v5, 4, v5
    v_add_u32 v6, 8, v3
    v_lshl_add_u32 v5, v6, 10, v5
    v_subrev_u32 v246, 2048, v5
    v_add_u32 v5, 4, v3
    v_lshlrev_b32 v5, 1, v5
    v_xor_b32 v5, v5, v2
    v_lshlrev_b32 v5, 4, v5
    v_add_u32 v6, 12, v3
    v_lshl_add_u32 v5, v6, 10, v5
    v_subrev_u32 v247, 3072, v5
    s_and_b32 s28, s21, 3
    s_lshl_b32 s28, s28, 2
    s_add_u32 s28, s28, s22
    s_mov_b32 s92, 0
    s_mov_b32 s93, 0
    s_cmp_eq_u32 s28, 0
    s_cselect_b32 s92, 0x76543210, s92
    s_cselect_b32 s93, 0xfedcba98, s93
    s_cmp_eq_u32 s28, 1
    s_cselect_b32 s92, 0x47650321, s92
    s_cselect_b32 s93, 0xcfed8ba9, s93
    s_cmp_eq_u32 s28, 2
    s_cselect_b32 s92, 0x54761032, s92
    s_cselect_b32 s93, 0xdcfe98ba, s93
    s_cmp_eq_u32 s28, 3
    s_cselect_b32 s92, 0x65472103, s92
    s_cselect_b32 s93, 0xedcfa98b, s93
    s_cmp_eq_u32 s28, 4
    s_cselect_b32 s92, 0x76543210, s92
    s_cselect_b32 s93, 0xfedcba98, s93
    s_cmp_eq_u32 s28, 5
    s_cselect_b32 s92, 0x87614320, s92
    s_cselect_b32 s93, 0xdfe9cba5, s93
    s_cmp_eq_u32 s28, 6
    s_cselect_b32 s92, 0x58721430, s92
    s_cselect_b32 s93, 0xedfa9cb6, s93
    s_cmp_eq_u32 s28, 7
    s_cselect_b32 s92, 0x65832140, s92
    s_cselect_b32 s93, 0xfedba9c7, s93
    s_cmp_eq_u32 s28, 8
    s_cselect_b32 s92, 0x76543210, s92
    s_cselect_b32 s93, 0xfedcba98, s93
    s_cmp_eq_u32 s28, 9
    s_cselect_b32 s92, 0x87254301, s92
    s_cselect_b32 s93, 0xefadcb69, s93
    s_cmp_eq_u32 s28, 10
    s_cselect_b32 s92, 0x98325410, s92
    s_cselect_b32 s93, 0xfebadc76, s93
    s_cmp_eq_u32 s28, 11
    s_cselect_b32 s92, 0x69432501, s92
    s_cselect_b32 s93, 0xefcbad87, s93
    s_cmp_eq_u32 s28, 12
    s_cselect_b32 s92, 0x76543210, s92
    s_cselect_b32 s93, 0xfedcba98, s93
    s_cmp_eq_u32 s28, 13
    s_cselect_b32 s92, 0x83654021, s92
    s_cselect_b32 s93, 0xfbedc7a9, s93
    s_cmp_eq_u32 s28, 14
    s_cselect_b32 s92, 0x94365102, s92
    s_cselect_b32 s93, 0xfcbed87a, s93
    s_cmp_eq_u32 s28, 15
    s_cselect_b32 s92, 0xa5436210, s92
    s_cselect_b32 s93, 0xfdcbe987, s93
    s_lshl_b32 s28, s21, 16
    s_lshl_b32 s29, s20, 14
    s_add_u32 s28, s28, s29
    s_lshl_b32 s29, s23, 19
    s_add_u32 s28, s28, s29
    s_lshl_b32 s29, s22, 8
    s_add_u32 s66, s28, s29
    s_lshl_b32 s28, s20, 13
    s_add_u32 s101, s28, 131072
    s_add_u32 s28, s22, 0
    s_and_b32 s28, s28, 3
    s_lshl_b32 s28, s28, 17
    s_lshl_b32 s29, s23, 19
    s_add_u32 s28, s28, s29
    s_lshl_b32 s29, s22, 8
    s_add_u32 s28, s28, s29
    s_lshl_b32 s29, s20, 15
    s_add_u32 s94, s28, s29
    s_add_u32 s28, s22, 1
    s_and_b32 s28, s28, 3
    s_lshl_b32 s28, s28, 17
    s_lshl_b32 s29, s23, 19
    s_add_u32 s28, s28, s29
    s_lshl_b32 s29, s22, 8
    s_add_u32 s28, s28, s29
    s_lshl_b32 s29, s20, 15
    s_add_u32 s95, s28, s29
    s_add_u32 s28, s22, 2
    s_and_b32 s28, s28, 3
    s_lshl_b32 s28, s28, 17
    s_lshl_b32 s29, s23, 19
    s_add_u32 s28, s28, s29
    s_lshl_b32 s29, s22, 8
    s_add_u32 s28, s28, s29
    s_lshl_b32 s29, s20, 15
    s_add_u32 s96, s28, s29
    s_add_u32 s28, s22, 3
    s_and_b32 s28, s28, 3
    s_lshl_b32 s28, s28, 17
    s_lshl_b32 s29, s23, 19
    s_add_u32 s28, s28, s29
    s_lshl_b32 s29, s22, 8
    s_add_u32 s28, s28, s29
    s_lshl_b32 s29, s20, 15
    s_add_u32 s97, s28, s29
    v_mov_b32 v1, 0x3f803f80
    v_accvgpr_write_b32 a164, v1
    v_mov_b32 v1, 0x3f803f80
    v_accvgpr_write_b32 a165, v1
    v_mov_b32 v1, 0x3f803f80
    v_accvgpr_write_b32 a166, v1
    v_mov_b32 v1, 0x3f803f80
    v_accvgpr_write_b32 a167, v1
    v_lshrrev_b32 v4, 2, v2
    v_cmp_eq_u32 vcc, v4, v3
    v_and_b32 v5, 1, v0
    v_lshlrev_b32 v5, 4, v5
    v_mov_b32 v6, 0x3f80
    v_lshlrev_b32 v6, v5, v6
    v_cndmask_b32 v6, 0, v6, vcc
    v_and_b32 v5, 2, v0
    v_cmp_eq_u32 vcc, 0, v5
    s_nop 1
    v_cndmask_b32 v72, 0, v6, vcc
    v_cndmask_b32 v73, v6, 0, vcc
    v_mov_b32 v74, 0
    v_mov_b32 v75, 0
    v_mov_b32 v76, 0
    v_mov_b32 v77, 0
    v_mov_b32 v78, v72
    v_mov_b32 v79, v73
    v_accvgpr_write_b32 a168, v72
    v_accvgpr_write_b32 a169, v73
    v_accvgpr_write_b32 a170, v74
    v_accvgpr_write_b32 a171, v75
    v_accvgpr_write_b32 a172, v76
    v_accvgpr_write_b32 a173, v77
    v_accvgpr_write_b32 a174, v78
    v_accvgpr_write_b32 a175, v79
    v_mov_b32 v28, 0
    v_mov_b32 v29, 0
    v_mov_b32 v30, 0
    v_mov_b32 v31, 0
    v_mov_b32 v32, 0
    v_mov_b32 v33, 0
    v_mov_b32 v34, 0
    v_mov_b32 v35, 0
    v_mov_b32 v36, 0
    v_mov_b32 v37, 0
    v_mov_b32 v38, 0
    v_mov_b32 v39, 0
    v_mov_b32 v40, 0
    v_mov_b32 v41, 0
    v_mov_b32 v42, 0
    v_mov_b32 v43, 0
    v_mov_b32 v44, 0
    v_mov_b32 v45, 0
    v_mov_b32 v46, 0
    v_mov_b32 v47, 0
    s_add_u32 s28, s67, 1
    s_and_b32 s28, s28, 3
    s_lshl_b32 s29, s28, 8
    s_lshl_b32 s30, s20, 12
    s_add_u32 m0, s30, 32768
    s_nop 0
    buffer_load_dwordx4 v60, s[32:35], s29 offen offset:0 lds
    buffer_load_dwordx4 v61, s[32:35], s29 offen offset:1024 lds
    buffer_load_dwordx4 v62, s[32:35], s29 offen offset:2048 lds
    buffer_load_dwordx4 v63, s[32:35], s29 offen offset:3072 lds
    s_lshl_b32 s30, s20, 10
    s_add_u32 m0, s30, 49152
    s_nop 0
    buffer_load_dwordx4 v64, s[32:35], s29 offen offset:0 lds
    s_lshl_b32 s29, s28, 20
    s_add_u32 s29, s29, s31
    s_add_u32 s28, s29, s90
    s_lshl_b32 s30, s20, 13
    s_add_u32 s30, s30, 0
    s_add_u32 m0, s30, s91
    s_nop 0
    buffer_load_dwordx4 v65, s[36:39], s28 offen offset:0 lds
    buffer_load_dwordx4 v66, s[36:39], s28 offen offset:1024 lds
    buffer_load_dwordx4 v67, s[36:39], s28 offen offset:2048 lds
    buffer_load_dwordx4 v68, s[36:39], s28 offen offset:3072 lds
    s_xor_b32 s28, s90, 131072
    s_add_u32 s28, s28, s29
    s_xor_b32 s29, s91, 4096
    s_add_u32 m0, s30, s29
    s_nop 0
    buffer_load_dwordx4 v65, s[36:39], s28 offen offset:0 lds
    buffer_load_dwordx4 v66, s[36:39], s28 offen offset:1024 lds
    buffer_load_dwordx4 v67, s[36:39], s28 offen offset:2048 lds
    buffer_load_dwordx4 v68, s[36:39], s28 offen offset:3072 lds
    s_waitcnt vmcnt(14)
    s_barrier
    v_add_u32 v250, 110592, v69
    v_add_u32 v48, 143360, v56
    v_add_u32 v49, 143360, v57
    v_add_u32 v50, 143360, v58
    v_add_u32 v51, 143360, v59
    ds_read_b64_tr_b16 v[164:165], v250 offset:0
    ds_read_b64_tr_b16 v[166:167], v250 offset:1024
    ds_read_b128 v[172:175], v48 offset:0
    ds_read_b64_tr_b16 v[168:169], v250 offset:8
    ds_read_b64_tr_b16 v[170:171], v250 offset:1032
    ds_read_b128 v[176:179], v48 offset:4096
    ds_read_b128 v[180:183], v48 offset:8192
    ds_read_b128 v[184:187], v48 offset:12288
    ds_read_b128 v[188:191], v48 offset:16384
    s_waitcnt lgkmcnt(6)
    v_mfma_f32_16x16x32_bf16 v[84:87], v[164:167], v[172:175], 0
    s_add_u32 s28, s67, 2
    s_and_b32 s28, s28, 3
    s_waitcnt lgkmcnt(4)
    v_mfma_f32_16x16x32_bf16 v[104:107], v[168:171], v[172:175], 0
    s_lshl_b32 s29, s28, 8
    s_lshl_b32 s30, s20, 12
    s_waitcnt lgkmcnt(3)
    v_mfma_f32_16x16x32_bf16 v[88:91], v[164:167], v[176:179], 0
    s_add_u32 m0, s30, 90112
    s_nop 0
    buffer_load_dwordx4 v60, s[32:35], s29 offen offset:0 lds
    v_mfma_f32_16x16x32_bf16 v[108:111], v[168:171], v[176:179], 0
    buffer_load_dwordx4 v61, s[32:35], s29 offen offset:1024 lds
    ds_read_b64_tr_b16 v[200:201], v250 offset:8192
    s_waitcnt lgkmcnt(3)
    v_mfma_f32_16x16x32_bf16 v[92:95], v[164:167], v[180:183], 0
    buffer_load_dwordx4 v62, s[32:35], s29 offen offset:2048 lds
    ds_read_b64_tr_b16 v[202:203], v250 offset:9216
    v_mfma_f32_16x16x32_bf16 v[112:115], v[168:171], v[180:183], 0
    ds_read_b128 v[208:211], v49 offset:0
    ds_read_b64_tr_b16 v[204:205], v250 offset:8200
    s_waitcnt lgkmcnt(4)
    v_mfma_f32_16x16x32_bf16 v[96:99], v[164:167], v[184:187], 0
    buffer_load_dwordx4 v63, s[32:35], s29 offen offset:3072 lds
    ds_read_b64_tr_b16 v[206:207], v250 offset:9224
    v_mfma_f32_16x16x32_bf16 v[116:119], v[168:171], v[184:187], 0
    ds_read_b128 v[212:215], v49 offset:4096
    ds_read_b128 v[216:219], v49 offset:8192
    v_mfma_f32_16x16x32_bf16 v[100:103], v[164:167], v[188:191], 0
    ds_read_b128 v[220:223], v49 offset:12288
    ds_read_b128 v[224:227], v49 offset:16384
    v_mfma_f32_16x16x32_bf16 v[120:123], v[168:171], v[188:191], 0
    s_lshl_b32 s30, s20, 10
    s_add_u32 m0, s30, 106496
    s_waitcnt lgkmcnt(6)
    v_mfma_f32_16x16x32_bf16 v[84:87], v[200:203], v[208:211], v[84:87]
    buffer_load_dwordx4 v64, s[32:35], s29 offen offset:0 lds
    s_lshl_b32 s29, s28, 20
    s_waitcnt lgkmcnt(4)
    v_mfma_f32_16x16x32_bf16 v[104:107], v[204:207], v[208:211], v[104:107]
    s_add_u32 s29, s29, s31
    s_add_u32 s28, s29, s90
    s_waitcnt lgkmcnt(3)
    v_mfma_f32_16x16x32_bf16 v[88:91], v[200:203], v[212:215], v[88:91]
    s_lshl_b32 s30, s20, 13
    s_add_u32 s30, s30, 57344
    s_add_u32 m0, s30, s91
    s_nop 0
    buffer_load_dwordx4 v65, s[36:39], s28 offen offset:0 lds
    v_mfma_f32_16x16x32_bf16 v[108:111], v[204:207], v[212:215], v[108:111]
    buffer_load_dwordx4 v66, s[36:39], s28 offen offset:1024 lds
    ds_read_b64_tr_b16 v[164:165], v250 offset:16384
    s_waitcnt lgkmcnt(1)
    v_mfma_f32_16x16x32_bf16 v[92:95], v[200:203], v[216:219], v[92:95]
    buffer_load_dwordx4 v67, s[36:39], s28 offen offset:2048 lds
    ds_read_b64_tr_b16 v[166:167], v250 offset:17408
    v_mfma_f32_16x16x32_bf16 v[112:115], v[204:207], v[216:219], v[112:115]
    ds_read_b128 v[172:175], v50 offset:0
    ds_read_b64_tr_b16 v[168:169], v250 offset:16392
    v_mfma_f32_16x16x32_bf16 v[96:99], v[200:203], v[220:223], v[96:99]
    buffer_load_dwordx4 v68, s[36:39], s28 offen offset:3072 lds
    ds_read_b64_tr_b16 v[170:171], v250 offset:17416
    v_mfma_f32_16x16x32_bf16 v[116:119], v[204:207], v[220:223], v[116:119]
    ds_read_b128 v[176:179], v50 offset:4096
    ds_read_b128 v[180:183], v50 offset:8192
    v_mfma_f32_16x16x32_bf16 v[100:103], v[200:203], v[224:227], v[100:103]
    ds_read_b128 v[184:187], v50 offset:12288
    ds_read_b128 v[188:191], v50 offset:16384
    v_mfma_f32_16x16x32_bf16 v[120:123], v[204:207], v[224:227], v[120:123]
    s_xor_b32 s28, s90, 131072
    s_add_u32 s28, s28, s29
    s_waitcnt lgkmcnt(6)
    v_mfma_f32_16x16x32_bf16 v[84:87], v[164:167], v[172:175], v[84:87]
    s_xor_b32 s29, s91, 4096
    s_add_u32 m0, s30, s29
    s_nop 0
    buffer_load_dwordx4 v65, s[36:39], s28 offen offset:0 lds
    s_waitcnt lgkmcnt(4)
    v_mfma_f32_16x16x32_bf16 v[104:107], v[168:171], v[172:175], v[104:107]
    buffer_load_dwordx4 v66, s[36:39], s28 offen offset:1024 lds
    ds_read_b64_tr_b16 v[200:201], v250 offset:24576
    s_waitcnt lgkmcnt(4)
    v_mfma_f32_16x16x32_bf16 v[88:91], v[164:167], v[176:179], v[88:91]
    buffer_load_dwordx4 v67, s[36:39], s28 offen offset:2048 lds
    ds_read_b64_tr_b16 v[202:203], v250 offset:25600
    v_mfma_f32_16x16x32_bf16 v[108:111], v[168:171], v[176:179], v[108:111]
    ds_read_b128 v[208:211], v51 offset:0
    ds_read_b64_tr_b16 v[204:205], v250 offset:24584
    s_waitcnt lgkmcnt(4)
    v_mfma_f32_16x16x32_bf16 v[92:95], v[164:167], v[180:183], v[92:95]
    buffer_load_dwordx4 v68, s[36:39], s28 offen offset:3072 lds
    ds_read_b64_tr_b16 v[206:207], v250 offset:25608
    v_mfma_f32_16x16x32_bf16 v[112:115], v[168:171], v[180:183], v[112:115]
    ds_read_b128 v[212:215], v51 offset:4096
    v_mfma_f32_16x16x32_bf16 v[96:99], v[164:167], v[184:187], v[96:99]
    ds_read_b128 v[216:219], v51 offset:8192
    v_mfma_f32_16x16x32_bf16 v[116:119], v[168:171], v[184:187], v[116:119]
    ds_read_b128 v[220:223], v51 offset:12288
    v_mfma_f32_16x16x32_bf16 v[100:103], v[164:167], v[188:191], v[100:103]
    ds_read_b128 v[224:227], v51 offset:16384
    v_mfma_f32_16x16x32_bf16 v[120:123], v[168:171], v[188:191], v[120:123]
    s_waitcnt lgkmcnt(0)
    s_waitcnt vmcnt(13)
    s_barrier
    v_add_u32 v251, 0, v69
    v_add_u32 v52, 32768, v56
    v_add_u32 v53, 32768, v57
    v_add_u32 v54, 32768, v58
    v_add_u32 v55, 32768, v59
    v_mfma_f32_16x16x32_bf16 v[84:87], v[200:203], v[208:211], v[84:87]
    ds_read_b64_tr_b16 v[164:165], v251 offset:0
    v_mfma_f32_16x16x32_bf16 v[104:107], v[204:207], v[208:211], v[104:107]
    s_add_u32 s28, s67, 3
    s_and_b32 s28, s28, 3
    v_mfma_f32_16x16x32_bf16 v[88:91], v[200:203], v[212:215], v[88:91]
    s_lshl_b32 s29, s28, 8
    s_lshl_b32 s30, s20, 12
    v_mfma_f32_16x16x32_bf16 v[108:111], v[204:207], v[212:215], v[108:111]
    s_add_u32 m0, s30, 143360
    s_nop 0
    buffer_load_dwordx4 v60, s[32:35], s29 offen offset:0 lds
    v_mfma_f32_16x16x32_bf16 v[92:95], v[200:203], v[216:219], v[92:95]
    buffer_load_dwordx4 v61, s[32:35], s29 offen offset:1024 lds
    ds_read_b64_tr_b16 v[166:167], v251 offset:1024
    v_mfma_f32_16x16x32_bf16 v[112:115], v[204:207], v[216:219], v[112:115]
    ds_read_b128 v[172:175], v52 offset:0
    ds_read_b64_tr_b16 v[168:169], v251 offset:8
    v_mfma_f32_16x16x32_bf16 v[96:99], v[200:203], v[220:223], v[96:99]
    ds_read_b64_tr_b16 v[170:171], v251 offset:1032
    ds_read_b128 v[176:179], v52 offset:4096
    v_mfma_f32_16x16x32_bf16 v[116:119], v[204:207], v[220:223], v[116:119]
    ds_read_b128 v[180:183], v52 offset:8192
    ds_read_b128 v[184:187], v52 offset:12288
    v_mfma_f32_16x16x32_bf16 v[100:103], v[200:203], v[224:227], v[100:103]
    ds_read_b128 v[188:191], v52 offset:16384
    buffer_load_dwordx4 v62, s[32:35], s29 offen offset:2048 lds
    v_mfma_f32_16x16x32_bf16 v[120:123], v[204:207], v[224:227], v[120:123]
    s_waitcnt lgkmcnt(6)
    v_mfma_f32_16x16x32_bf16 v[84:87], v[164:167], v[172:175], v[84:87]
    buffer_load_dwordx4 v63, s[32:35], s29 offen offset:3072 lds
    ds_read_b64_tr_b16 v[200:201], v251 offset:8192
    s_waitcnt lgkmcnt(5)
    v_mfma_f32_16x16x32_bf16 v[104:107], v[168:171], v[172:175], v[104:107]
    ds_read_b64_tr_b16 v[202:203], v251 offset:9216
    s_waitcnt lgkmcnt(5)
    v_mfma_f32_16x16x32_bf16 v[88:91], v[164:167], v[176:179], v[88:91]
    ds_read_b128 v[208:211], v53 offset:0
    v_mfma_f32_16x16x32_bf16 v[108:111], v[168:171], v[176:179], v[108:111]
    s_lshl_b32 s30, s20, 10
    s_add_u32 m0, s30, 159744
    s_waitcnt lgkmcnt(4)
    v_mfma_f32_16x16x32_bf16 v[92:95], v[164:167], v[180:183], v[92:95]
    buffer_load_dwordx4 v64, s[32:35], s29 offen offset:0 lds
    ds_read_b64_tr_b16 v[204:205], v251 offset:8200
    v_mfma_f32_16x16x32_bf16 v[112:115], v[168:171], v[180:183], v[112:115]
    ds_read_b64_tr_b16 v[206:207], v251 offset:9224
    ds_read_b128 v[212:215], v53 offset:4096
    v_mfma_f32_16x16x32_bf16 v[96:99], v[164:167], v[184:187], v[96:99]
    ds_read_b128 v[216:219], v53 offset:8192
    s_lshl_b32 s29, s28, 20
    v_mfma_f32_16x16x32_bf16 v[116:119], v[168:171], v[184:187], v[116:119]
    ds_read_b128 v[220:223], v53 offset:12288
    s_add_u32 s29, s29, s31
    s_waitcnt lgkmcnt(6)
    v_mfma_f32_16x16x32_bf16 v[100:103], v[164:167], v[188:191], v[100:103]
    ds_read_b128 v[224:227], v53 offset:16384
    s_add_u32 s28, s29, s90
    v_mfma_f32_16x16x32_bf16 v[120:123], v[168:171], v[188:191], v[120:123]
    s_lshl_b32 s30, s20, 13
    s_add_u32 s30, s30, 110592
    s_add_u32 m0, s30, s91
    s_nop 0
    buffer_load_dwordx4 v65, s[36:39], s28 offen offset:0 lds
    s_waitcnt lgkmcnt(5)
    v_mfma_f32_16x16x32_bf16 v[84:87], v[200:203], v[208:211], v[84:87]
    buffer_load_dwordx4 v66, s[36:39], s28 offen offset:1024 lds
    ds_read_b64_tr_b16 v[164:165], v251 offset:16384
    s_waitcnt lgkmcnt(4)
    v_mfma_f32_16x16x32_bf16 v[104:107], v[204:207], v[208:211], v[104:107]
    ds_read_b64_tr_b16 v[166:167], v251 offset:17408
    v_mfma_f32_16x16x32_bf16 v[88:91], v[200:203], v[212:215], v[88:91]
    buffer_load_dwordx4 v67, s[36:39], s28 offen offset:2048 lds
    ds_read_b128 v[172:175], v54 offset:0
    v_mfma_f32_16x16x32_bf16 v[108:111], v[204:207], v[212:215], v[108:111]
    ds_read_b64_tr_b16 v[168:169], v251 offset:16392
    s_waitcnt lgkmcnt(4)
    v_mfma_f32_16x16x32_bf16 v[92:95], v[200:203], v[216:219], v[92:95]
    ds_read_b64_tr_b16 v[170:171], v251 offset:17416
    v_mfma_f32_16x16x32_bf16 v[112:115], v[204:207], v[216:219], v[112:115]
    buffer_load_dwordx4 v68, s[36:39], s28 offen offset:3072 lds
    ds_read_b128 v[176:179], v54 offset:4096
    v_mfma_f32_16x16x32_bf16 v[96:99], v[200:203], v[220:223], v[96:99]
    ds_read_b128 v[180:183], v54 offset:8192
    v_mfma_f32_16x16x32_bf16 v[116:119], v[204:207], v[220:223], v[116:119]
    ds_read_b128 v[184:187], v54 offset:12288
    v_mfma_f32_16x16x32_bf16 v[100:103], v[200:203], v[224:227], v[100:103]
    ds_read_b128 v[188:191], v54 offset:16384
    s_xor_b32 s28, s90, 131072
    v_mfma_f32_16x16x32_bf16 v[120:123], v[204:207], v[224:227], v[120:123]
    s_add_u32 s28, s28, s29
    s_xor_b32 s29, s91, 4096
    s_waitcnt lgkmcnt(5)
    v_mfma_f32_16x16x32_bf16 v[84:87], v[164:167], v[172:175], v[84:87]
    s_add_u32 m0, s30, s29
    s_nop 0
    buffer_load_dwordx4 v65, s[36:39], s28 offen offset:0 lds
    s_waitcnt lgkmcnt(4)
    v_mfma_f32_16x16x32_bf16 v[104:107], v[168:171], v[172:175], v[104:107]
    buffer_load_dwordx4 v66, s[36:39], s28 offen offset:1024 lds
    ds_read_b64_tr_b16 v[200:201], v251 offset:24576
    s_waitcnt lgkmcnt(4)
    v_mfma_f32_16x16x32_bf16 v[88:91], v[164:167], v[176:179], v[88:91]
    ds_read_b64_tr_b16 v[202:203], v251 offset:25600
    ds_read_b128 v[208:211], v55 offset:0
    v_mfma_f32_16x16x32_bf16 v[108:111], v[168:171], v[176:179], v[108:111]
    ds_read_b64_tr_b16 v[204:205], v251 offset:24584
    s_waitcnt lgkmcnt(4)
    v_mfma_f32_16x16x32_bf16 v[92:95], v[164:167], v[180:183], v[92:95]
    buffer_load_dwordx4 v67, s[36:39], s28 offen offset:2048 lds
    ds_read_b64_tr_b16 v[206:207], v251 offset:25608
    v_mfma_f32_16x16x32_bf16 v[112:115], v[168:171], v[180:183], v[112:115]
    ds_read_b128 v[212:215], v55 offset:4096
    v_mfma_f32_16x16x32_bf16 v[96:99], v[164:167], v[184:187], v[96:99]
    ds_read_b128 v[216:219], v55 offset:8192
    v_mfma_f32_16x16x32_bf16 v[116:119], v[168:171], v[184:187], v[116:119]
    ds_read_b128 v[220:223], v55 offset:12288
    buffer_load_dwordx4 v68, s[36:39], s28 offen offset:3072 lds
    v_mfma_f32_16x16x32_bf16 v[100:103], v[164:167], v[188:191], v[100:103]
    ds_read_b128 v[224:227], v55 offset:16384
    v_mfma_f32_16x16x32_bf16 v[120:123], v[168:171], v[188:191], v[120:123]
    s_waitcnt lgkmcnt(0)
    s_waitcnt vmcnt(13)
    s_barrier
    v_add_u32 v250, 57344, v69
    v_add_u32 v48, 90112, v56
    v_add_u32 v49, 90112, v57
    v_add_u32 v50, 90112, v58
    v_add_u32 v51, 90112, v59
    v_mfma_f32_16x16x32_bf16 v[84:87], v[200:203], v[208:211], v[84:87]
    ds_read_b64_tr_b16 v[164:165], v250 offset:0
    v_mfma_f32_16x16x32_bf16 v[104:107], v[204:207], v[208:211], v[104:107]
    s_bfe_u32 s25, s92, 0x40000
    s_lshl_b32 s25, s25, 13
    v_mfma_f32_16x16x32_bf16 v[88:91], v[200:203], v[212:215], v[88:91]
    s_add_u32 s98, s25, 4096
    s_add_u32 m0, s24, 0
    v_mfma_f32_16x16x32_bf16 v[108:111], v[204:207], v[212:215], v[108:111]
    buffer_load_dwordx4 v20, s[12:15], s25 offen offset:0 lds
    ds_read_b64_tr_b16 v[166:167], v250 offset:1024
    v_mfma_f32_16x16x32_bf16 v[92:95], v[200:203], v[216:219], v[92:95]
    ds_read_b128 v[172:175], v48 offset:0
    ds_read_b64_tr_b16 v[168:169], v250 offset:8
    v_mfma_f32_16x16x32_bf16 v[112:115], v[204:207], v[216:219], v[112:115]
    ds_read_b64_tr_b16 v[170:171], v250 offset:1032
    ds_read_b128 v[176:179], v48 offset:4096
    v_mfma_f32_16x16x32_bf16 v[96:99], v[200:203], v[220:223], v[96:99]
    ds_read_b128 v[180:183], v48 offset:8192
    buffer_load_dwordx4 v21, s[12:15], s25 offen offset:1024 lds
    v_mfma_f32_16x16x32_bf16 v[116:119], v[204:207], v[220:223], v[116:119]
    ds_read_b128 v[184:187], v48 offset:12288
    v_mfma_f32_16x16x32_bf16 v[100:103], v[200:203], v[224:227], v[100:103]
    ds_read_b128 v[188:191], v48 offset:16384
    v_mfma_f32_16x16x32_bf16 v[120:123], v[204:207], v[224:227], v[120:123]
    buffer_load_dwordx4 v22, s[12:15], s25 offen offset:2048 lds
    s_waitcnt lgkmcnt(6)
    v_mfma_f32_16x16x32_bf16 v[84:87], v[164:167], v[172:175], v[84:87]
    ds_read_b64_tr_b16 v[200:201], v250 offset:8192
    s_waitcnt lgkmcnt(5)
    v_mfma_f32_16x16x32_bf16 v[104:107], v[168:171], v[172:175], v[104:107]
    ds_read_b64_tr_b16 v[202:203], v250 offset:9216
    s_waitcnt lgkmcnt(5)
    v_mfma_f32_16x16x32_bf16 v[88:91], v[164:167], v[176:179], v[88:91]
    ds_read_b128 v[208:211], v49 offset:0
    v_mfma_f32_16x16x32_bf16 v[108:111], v[168:171], v[176:179], v[108:111]
    buffer_load_dwordx4 v23, s[12:15], s25 offen offset:3072 lds
    ds_read_b64_tr_b16 v[204:205], v250 offset:8200
    s_waitcnt lgkmcnt(5)
    v_mfma_f32_16x16x32_bf16 v[92:95], v[164:167], v[180:183], v[92:95]
    ds_read_b64_tr_b16 v[206:207], v250 offset:9224
    v_mfma_f32_16x16x32_bf16 v[112:115], v[168:171], v[180:183], v[112:115]
    ds_read_b128 v[212:215], v49 offset:4096
    v_mfma_f32_16x16x32_bf16 v[96:99], v[164:167], v[184:187], v[96:99]
    ds_read_b128 v[216:219], v49 offset:8192
    v_mfma_f32_16x16x32_bf16 v[116:119], v[168:171], v[184:187], v[116:119]
    ds_read_b128 v[220:223], v49 offset:12288
    s_add_u32 m0, s24, 4096
    s_waitcnt lgkmcnt(6)
    v_mfma_f32_16x16x32_bf16 v[100:103], v[164:167], v[188:191], v[100:103]
    ds_read_b128 v[224:227], v49 offset:16384
    buffer_load_dwordx4 v20, s[12:15], s98 offen offset:0 lds
    v_mfma_f32_16x16x32_bf16 v[120:123], v[168:171], v[188:191], v[120:123]
    s_waitcnt lgkmcnt(5)
    v_mfma_f32_16x16x32_bf16 v[84:87], v[200:203], v[208:211], v[84:87]
    ds_read_b64_tr_b16 v[164:165], v250 offset:16384
    s_waitcnt lgkmcnt(5)
    v_mfma_f32_16x16x32_bf16 v[104:107], v[204:207], v[208:211], v[104:107]
    buffer_load_dwordx4 v21, s[12:15], s98 offen offset:1024 lds
    ds_read_b64_tr_b16 v[166:167], v250 offset:17408
    s_waitcnt lgkmcnt(5)
    v_mfma_f32_16x16x32_bf16 v[88:91], v[200:203], v[212:215], v[88:91]
    ds_read_b128 v[172:175], v50 offset:0
    v_mfma_f32_16x16x32_bf16 v[108:111], v[204:207], v[212:215], v[108:111]
    ds_read_b64_tr_b16 v[168:169], v250 offset:16392
    s_waitcnt lgkmcnt(5)
    v_mfma_f32_16x16x32_bf16 v[92:95], v[200:203], v[216:219], v[92:95]
    ds_read_b64_tr_b16 v[170:171], v250 offset:17416
    v_mfma_f32_16x16x32_bf16 v[112:115], v[204:207], v[216:219], v[112:115]
    ds_read_b128 v[176:179], v50 offset:4096
    buffer_load_dwordx4 v22, s[12:15], s98 offen offset:2048 lds
    v_mfma_f32_16x16x32_bf16 v[96:99], v[200:203], v[220:223], v[96:99]
    ds_read_b128 v[180:183], v50 offset:8192
    v_mfma_f32_16x16x32_bf16 v[116:119], v[204:207], v[220:223], v[116:119]
    ds_read_b128 v[184:187], v50 offset:12288
    s_waitcnt lgkmcnt(6)
    v_mfma_f32_16x16x32_bf16 v[100:103], v[200:203], v[224:227], v[100:103]
    ds_read_b128 v[188:191], v50 offset:16384
    v_mfma_f32_16x16x32_bf16 v[120:123], v[204:207], v[224:227], v[120:123]
    buffer_load_dwordx4 v23, s[12:15], s98 offen offset:3072 lds
    s_waitcnt lgkmcnt(5)
    v_mfma_f32_16x16x32_bf16 v[84:87], v[164:167], v[172:175], v[84:87]
    ds_read_b64_tr_b16 v[200:201], v250 offset:24576
    s_waitcnt lgkmcnt(5)
    v_mfma_f32_16x16x32_bf16 v[104:107], v[168:171], v[172:175], v[104:107]
    ds_read_b64_tr_b16 v[202:203], v250 offset:25600
    s_waitcnt lgkmcnt(5)
    v_mfma_f32_16x16x32_bf16 v[88:91], v[164:167], v[176:179], v[88:91]
    ds_read_b128 v[208:211], v51 offset:0
    v_mfma_f32_16x16x32_bf16 v[108:111], v[168:171], v[176:179], v[108:111]
    ds_read_b64_tr_b16 v[204:205], v250 offset:24584
    s_waitcnt lgkmcnt(5)
    v_mfma_f32_16x16x32_bf16 v[92:95], v[164:167], v[180:183], v[92:95]
    ds_read_b64_tr_b16 v[206:207], v250 offset:25608
    v_mfma_f32_16x16x32_bf16 v[112:115], v[168:171], v[180:183], v[112:115]
    ds_read_b128 v[212:215], v51 offset:4096
    v_mfma_f32_16x16x32_bf16 v[96:99], v[164:167], v[184:187], v[96:99]
    ds_read_b128 v[216:219], v51 offset:8192
    v_mfma_f32_16x16x32_bf16 v[116:119], v[168:171], v[184:187], v[116:119]
    ds_read_b128 v[220:223], v51 offset:12288
    s_waitcnt lgkmcnt(7)
    v_mfma_f32_16x16x32_bf16 v[100:103], v[164:167], v[188:191], v[100:103]
    ds_read_b128 v[224:227], v51 offset:16384
    v_mfma_f32_16x16x32_bf16 v[120:123], v[168:171], v[188:191], v[120:123]
    s_waitcnt lgkmcnt(0)
    s_waitcnt vmcnt(8)
    s_barrier
    v_add_u32 v251, 110592, v69
    v_add_u32 v52, 143360, v56
    v_add_u32 v53, 143360, v57
    v_add_u32 v54, 143360, v58
    v_add_u32 v55, 143360, v59
    v_mfma_f32_16x16x32_bf16 v[84:87], v[200:203], v[208:211], v[84:87]
    ds_read_b64_tr_b16 v[164:165], v251 offset:0
    v_mfma_f32_16x16x32_bf16 v[104:107], v[204:207], v[208:211], v[104:107]
    s_add_u32 m0, s24, 65536
    s_nop 0
    buffer_load_dwordx4 v24, s[16:19], s25 offen offset:0 lds
    v_mfma_f32_16x16x32_bf16 v[88:91], v[200:203], v[212:215], v[88:91]
    ds_read_b64_tr_b16 v[166:167], v251 offset:1024
    ds_read_b128 v[172:175], v52 offset:0
    v_mfma_f32_16x16x32_bf16 v[108:111], v[204:207], v[212:215], v[108:111]
    ds_read_b64_tr_b16 v[168:169], v251 offset:8
    v_mfma_f32_16x16x32_bf16 v[92:95], v[200:203], v[216:219], v[92:95]
    ds_read_b64_tr_b16 v[170:171], v251 offset:1032
    v_mfma_f32_16x16x32_bf16 v[112:115], v[204:207], v[216:219], v[112:115]
    ds_read_b128 v[176:179], v52 offset:4096
    v_mfma_f32_16x16x32_bf16 v[96:99], v[200:203], v[220:223], v[96:99]
    ds_read_b128 v[180:183], v52 offset:8192
    buffer_load_dwordx4 v25, s[16:19], s25 offen offset:1024 lds
    v_mfma_f32_16x16x32_bf16 v[116:119], v[204:207], v[220:223], v[116:119]
    ds_read_b128 v[184:187], v52 offset:12288
    v_mfma_f32_16x16x32_bf16 v[100:103], v[200:203], v[224:227], v[100:103]
    ds_read_b128 v[188:191], v52 offset:16384
    v_mfma_f32_16x16x32_bf16 v[120:123], v[204:207], v[224:227], v[120:123]
    s_waitcnt lgkmcnt(6)
    v_mfma_f32_16x16x32_bf16 v[84:87], v[164:167], v[172:175], v[84:87]
    ds_read_b64_tr_b16 v[200:201], v251 offset:8192
    s_waitcnt lgkmcnt(5)
    v_mfma_f32_16x16x32_bf16 v[104:107], v[168:171], v[172:175], v[104:107]
    buffer_load_dwordx4 v24, s[16:19], s25 offen offset:2048 lds
    ds_read_b64_tr_b16 v[202:203], v251 offset:9216
    s_waitcnt lgkmcnt(5)
    v_mfma_f32_16x16x32_bf16 v[88:91], v[164:167], v[176:179], v[88:91]
    ds_read_b128 v[208:211], v53 offset:0
    v_mfma_f32_16x16x32_bf16 v[108:111], v[168:171], v[176:179], v[108:111]
    ds_read_b64_tr_b16 v[204:205], v251 offset:8200
    s_waitcnt lgkmcnt(5)
    v_mfma_f32_16x16x32_bf16 v[92:95], v[164:167], v[180:183], v[92:95]
    ds_read_b64_tr_b16 v[206:207], v251 offset:9224
    v_mfma_f32_16x16x32_bf16 v[112:115], v[168:171], v[180:183], v[112:115]
    ds_read_b128 v[212:215], v53 offset:4096
    v_mfma_f32_16x16x32_bf16 v[96:99], v[164:167], v[184:187], v[96:99]
    ds_read_b128 v[216:219], v53 offset:8192
    buffer_load_dwordx4 v25, s[16:19], s25 offen offset:3072 lds
    v_mfma_f32_16x16x32_bf16 v[116:119], v[168:171], v[184:187], v[116:119]
    ds_read_b128 v[220:223], v53 offset:12288
    s_waitcnt lgkmcnt(6)
    v_mfma_f32_16x16x32_bf16 v[100:103], v[164:167], v[188:191], v[100:103]
    ds_read_b128 v[224:227], v53 offset:16384
    v_mfma_f32_16x16x32_bf16 v[120:123], v[168:171], v[188:191], v[120:123]
    s_waitcnt lgkmcnt(6)
    v_mfma_f32_16x16x32_bf16 v[84:87], v[200:203], v[208:211], v[84:87]
    ds_read_b64_tr_b16 v[164:165], v251 offset:16384
    s_waitcnt lgkmcnt(5)
    v_mfma_f32_16x16x32_bf16 v[104:107], v[204:207], v[208:211], v[104:107]
    s_add_u32 m0, s24, 69632
    s_nop 0
    buffer_load_dwordx4 v24, s[16:19], s98 offen offset:0 lds
    s_waitcnt lgkmcnt(4)
    v_mfma_f32_16x16x32_bf16 v[88:91], v[200:203], v[212:215], v[88:91]
    ds_read_b64_tr_b16 v[166:167], v251 offset:17408
    ds_read_b128 v[172:175], v54 offset:0
    v_mfma_f32_16x16x32_bf16 v[108:111], v[204:207], v[212:215], v[108:111]
    ds_read_b64_tr_b16 v[168:169], v251 offset:16392
    s_waitcnt lgkmcnt(5)
    v_mfma_f32_16x16x32_bf16 v[92:95], v[200:203], v[216:219], v[92:95]
    ds_read_b64_tr_b16 v[170:171], v251 offset:17416
    v_mfma_f32_16x16x32_bf16 v[112:115], v[204:207], v[216:219], v[112:115]
    ds_read_b128 v[176:179], v54 offset:4096
    v_mfma_f32_16x16x32_bf16 v[96:99], v[200:203], v[220:223], v[96:99]
    ds_read_b128 v[180:183], v54 offset:8192
    buffer_load_dwordx4 v25, s[16:19], s98 offen offset:1024 lds
    v_mfma_f32_16x16x32_bf16 v[116:119], v[204:207], v[220:223], v[116:119]
    ds_read_b128 v[184:187], v54 offset:12288
    s_waitcnt lgkmcnt(7)
    v_mfma_f32_16x16x32_bf16 v[100:103], v[200:203], v[224:227], v[100:103]
    ds_read_b128 v[188:191], v54 offset:16384
    v_mfma_f32_16x16x32_bf16 v[120:123], v[204:207], v[224:227], v[120:123]
    s_waitcnt lgkmcnt(6)
    v_mfma_f32_16x16x32_bf16 v[84:87], v[164:167], v[172:175], v[84:87]
    ds_read_b64_tr_b16 v[200:201], v251 offset:24576
    s_waitcnt lgkmcnt(5)
    v_mfma_f32_16x16x32_bf16 v[104:107], v[168:171], v[172:175], v[104:107]
    buffer_load_dwordx4 v24, s[16:19], s98 offen offset:2048 lds
    ds_read_b64_tr_b16 v[202:203], v251 offset:25600
    s_waitcnt lgkmcnt(5)
    v_mfma_f32_16x16x32_bf16 v[88:91], v[164:167], v[176:179], v[88:91]
    ds_read_b128 v[208:211], v55 offset:0
    v_mfma_f32_16x16x32_bf16 v[108:111], v[168:171], v[176:179], v[108:111]
    ds_read_b64_tr_b16 v[204:205], v251 offset:24584
    s_waitcnt lgkmcnt(5)
    v_mfma_f32_16x16x32_bf16 v[92:95], v[164:167], v[180:183], v[92:95]
    ds_read_b64_tr_b16 v[206:207], v251 offset:25608
    v_mfma_f32_16x16x32_bf16 v[112:115], v[168:171], v[180:183], v[112:115]
    ds_read_b128 v[212:215], v55 offset:4096
    v_mfma_f32_16x16x32_bf16 v[96:99], v[164:167], v[184:187], v[96:99]
    ds_read_b128 v[216:219], v55 offset:8192
    buffer_load_dwordx4 v25, s[16:19], s98 offen offset:3072 lds
    v_mfma_f32_16x16x32_bf16 v[116:119], v[168:171], v[184:187], v[116:119]
    ds_read_b128 v[220:223], v55 offset:12288
    s_waitcnt lgkmcnt(6)
    v_mfma_f32_16x16x32_bf16 v[100:103], v[164:167], v[188:191], v[100:103]
    ds_read_b128 v[224:227], v55 offset:16384
    v_mfma_f32_16x16x32_bf16 v[120:123], v[168:171], v[188:191], v[120:123]
    s_waitcnt lgkmcnt(6)
    v_mfma_f32_16x16x32_bf16 v[84:87], v[200:203], v[208:211], v[84:87]
    s_waitcnt lgkmcnt(4)
    v_mfma_f32_16x16x32_bf16 v[104:107], v[204:207], v[208:211], v[104:107]
    s_waitcnt lgkmcnt(3)
    v_mfma_f32_16x16x32_bf16 v[88:91], v[200:203], v[212:215], v[88:91]
    v_mfma_f32_16x16x32_bf16 v[108:111], v[204:207], v[212:215], v[108:111]
    s_waitcnt lgkmcnt(2)
    v_mfma_f32_16x16x32_bf16 v[92:95], v[200:203], v[216:219], v[92:95]
    v_mfma_f32_16x16x32_bf16 v[112:115], v[204:207], v[216:219], v[112:115]
    s_waitcnt lgkmcnt(1)
    v_mfma_f32_16x16x32_bf16 v[96:99], v[200:203], v[220:223], v[96:99]
    v_mfma_f32_16x16x32_bf16 v[116:119], v[204:207], v[220:223], v[116:119]
    s_waitcnt lgkmcnt(0)
    v_mfma_f32_16x16x32_bf16 v[100:103], v[200:203], v[224:227], v[100:103]
    v_mfma_f32_16x16x32_bf16 v[120:123], v[204:207], v[224:227], v[120:123]
    s_waitcnt lgkmcnt(0)
    s_barrier
    s_mov_b32 s29, 0x3e0293ee
    s_lshl_b32 s28, s20, 10
    v_add_u32 v4, s28, v252
    v_add_u32 v4, 131072, v4
    v_mul_f32 v84, s29, v84
    v_mul_f32 v104, s29, v104
    v_mul_f32 v85, s29, v85
    v_mul_f32 v105, s29, v105
    v_mul_f32 v86, s29, v86
    v_mul_f32 v106, s29, v106
    v_mul_f32 v87, s29, v87
    v_mul_f32 v107, s29, v107
    v_cvt_pk_bf16_f32 v164, v84, v85
    v_cvt_pk_bf16_f32 v165, v86, v87
    v_cvt_pk_bf16_f32 v166, v104, v105
    v_cvt_pk_bf16_f32 v167, v106, v107
    ds_write_b128 v4, v[164:167] offset:0
    v_mul_f32 v88, s29, v88
    v_mul_f32 v108, s29, v108
    v_mul_f32 v89, s29, v89
    v_mul_f32 v109, s29, v109
    v_mul_f32 v90, s29, v90
    v_mul_f32 v110, s29, v110
    v_mul_f32 v91, s29, v91
    v_mul_f32 v111, s29, v111
    v_cvt_pk_bf16_f32 v168, v88, v89
    v_cvt_pk_bf16_f32 v169, v90, v91
    v_cvt_pk_bf16_f32 v170, v108, v109
    v_cvt_pk_bf16_f32 v171, v110, v111
    ds_write_b128 v4, v[168:171] offset:4096
    v_mul_f32 v92, s29, v92
    v_mul_f32 v112, s29, v112
    v_mul_f32 v93, s29, v93
    v_mul_f32 v113, s29, v113
    v_mul_f32 v94, s29, v94
    v_mul_f32 v114, s29, v114
    v_mul_f32 v95, s29, v95
    v_mul_f32 v115, s29, v115
    v_cvt_pk_bf16_f32 v172, v92, v93
    v_cvt_pk_bf16_f32 v173, v94, v95
    v_cvt_pk_bf16_f32 v174, v112, v113
    v_cvt_pk_bf16_f32 v175, v114, v115
    ds_write_b128 v4, v[172:175] offset:8192
    v_mul_f32 v96, s29, v96
    v_mul_f32 v116, s29, v116
    v_mul_f32 v97, s29, v97
    v_mul_f32 v117, s29, v117
    v_mul_f32 v98, s29, v98
    v_mul_f32 v118, s29, v118
    v_mul_f32 v99, s29, v99
    v_mul_f32 v119, s29, v119
    v_cvt_pk_bf16_f32 v176, v96, v97
    v_cvt_pk_bf16_f32 v177, v98, v99
    v_cvt_pk_bf16_f32 v178, v116, v117
    v_cvt_pk_bf16_f32 v179, v118, v119
    ds_write_b128 v4, v[176:179] offset:12288
    v_mul_f32 v100, s29, v100
    v_mul_f32 v120, s29, v120
    v_mul_f32 v101, s29, v101
    v_mul_f32 v121, s29, v121
    v_mul_f32 v102, s29, v102
    v_mul_f32 v122, s29, v122
    v_mul_f32 v103, s29, v103
    v_mul_f32 v123, s29, v123
    v_cvt_pk_bf16_f32 v180, v100, v101
    v_cvt_pk_bf16_f32 v181, v102, v103
    v_cvt_pk_bf16_f32 v182, v120, v121
    v_cvt_pk_bf16_f32 v183, v122, v123
    ds_write_b128 v4, v[180:183] offset:16384
    s_waitcnt lgkmcnt(0)
    s_barrier
    v_add_u32 v4, 131072, v252
    ds_read_b128 a[0:3], v4 offset:0
    ds_read_b128 a[4:7], v4 offset:1024
    ds_read_b128 a[8:11], v4 offset:2048
    ds_read_b128 a[12:15], v4 offset:3072
    ds_read_b128 a[16:19], v4 offset:4096
    ds_read_b128 a[20:23], v4 offset:5120
    ds_read_b128 a[24:27], v4 offset:6144
    ds_read_b128 a[28:31], v4 offset:7168
    ds_read_b128 a[32:35], v4 offset:8192
    ds_read_b128 a[36:39], v4 offset:9216
    ds_read_b128 a[40:43], v4 offset:10240
    ds_read_b128 a[44:47], v4 offset:11264
    ds_read_b128 a[48:51], v4 offset:12288
    ds_read_b128 a[52:55], v4 offset:13312
    ds_read_b128 a[56:59], v4 offset:14336
    ds_read_b128 a[60:63], v4 offset:15360
    ds_read_b128 a[64:67], v4 offset:16384
    ds_read_b128 a[68:71], v4 offset:17408
    ds_read_b128 a[72:75], v4 offset:18432
    ds_read_b128 a[76:79], v4 offset:19456
    s_bfe_u32 s25, s92, 0x40004
    s_lshl_b32 s25, s25, 13
    s_add_u32 s98, s25, 4096
    s_add_u32 m0, s24, 32768
    s_nop 0
    buffer_load_dwordx4 v20, s[12:15], s25 offen offset:0 lds
    buffer_load_dwordx4 v21, s[12:15], s25 offen offset:1024 lds
    buffer_load_dwordx4 v22, s[12:15], s25 offen offset:2048 lds
    buffer_load_dwordx4 v23, s[12:15], s25 offen offset:3072 lds
    s_add_u32 m0, s24, 36864
    s_nop 0
    buffer_load_dwordx4 v20, s[12:15], s98 offen offset:0 lds
    buffer_load_dwordx4 v21, s[12:15], s98 offen offset:1024 lds
    buffer_load_dwordx4 v22, s[12:15], s98 offen offset:2048 lds
    buffer_load_dwordx4 v23, s[12:15], s98 offen offset:3072 lds
    s_add_u32 m0, s24, 98304
    s_nop 0
    buffer_load_dwordx4 v24, s[16:19], s25 offen offset:0 lds
    buffer_load_dwordx4 v25, s[16:19], s25 offen offset:1024 lds
    buffer_load_dwordx4 v24, s[16:19], s25 offen offset:2048 lds
    buffer_load_dwordx4 v25, s[16:19], s25 offen offset:3072 lds
    s_add_u32 m0, s24, 102400
    s_nop 0
    buffer_load_dwordx4 v24, s[16:19], s98 offen offset:0 lds
    buffer_load_dwordx4 v25, s[16:19], s98 offen offset:1024 lds
    buffer_load_dwordx4 v24, s[16:19], s98 offen offset:2048 lds
    buffer_load_dwordx4 v25, s[16:19], s98 offen offset:3072 lds
    s_cmp_eq_u32 s27, 0
    s_cbranch_scc1 L_attn
    s_waitcnt vmcnt(0) lgkmcnt(0)
    s_barrier
    v_mov_b32 v76, 0xff800000
    v_mov_b32 v77, 0xff800000
    v_mov_b32 v78, 0xff800000
    v_mov_b32 v79, 0xff800000
    v_mov_b32 v80, 0xff800000
    s_mov_b32 s90, 0
L_maxloop:
    s_lshl_b32 s25, s90, 13
    s_add_u32 s98, s25, 4096
    s_add_u32 m0, s24, 0
    s_nop 0
    buffer_load_dwordx4 v20, s[12:15], s25 offen offset:0 lds
    buffer_load_dwordx4 v21, s[12:15], s25 offen offset:1024 lds
    buffer_load_dwordx4 v22, s[12:15], s25 offen offset:2048 lds
    buffer_load_dwordx4 v23, s[12:15], s25 offen offset:3072 lds
    s_add_u32 m0, s24, 4096
    s_nop 0
    buffer_load_dwordx4 v20, s[12:15], s98 offen offset:0 lds
    buffer_load_dwordx4 v21, s[12:15], s98 offen offset:1024 lds
    buffer_load_dwordx4 v22, s[12:15], s98 offen offset:2048 lds
    buffer_load_dwordx4 v23, s[12:15], s98 offen offset:3072 lds
    s_waitcnt vmcnt(0)
    ds_read_b128 a[80:83], v8 offset:0
    ds_read_b128 a[84:87], v9 offset:0
    ds_read_b128 a[88:91], v10 offset:0
    ds_read_b128 a[92:95], v11 offset:0
    ds_read_b128 a[96:99], v8 offset:4096
    ds_read_b128 a[100:103], v9 offset:4096
    ds_read_b128 a[104:107], v10 offset:4096
    ds_read_b128 a[108:111], v11 offset:4096
    s_waitcnt lgkmcnt(0)
    v_mfma_f32_16x16x32_bf16 v[48:51], a[80:83], a[0:3], 0
    v_mfma_f32_16x16x32_bf16 v[48:51], a[84:87], a[4:7], v[48:51]
    v_mfma_f32_16x16x32_bf16 v[48:51], a[88:91], a[8:11], v[48:51]
    v_mfma_f32_16x16x32_bf16 v[48:51], a[92:95], a[12:15], v[48:51]
    v_mfma_f32_16x16x32_bf16 v[52:55], a[96:99], a[0:3], 0
    v_mfma_f32_16x16x32_bf16 v[52:55], a[100:103], a[4:7], v[52:55]
    v_mfma_f32_16x16x32_bf16 v[52:55], a[104:107], a[8:11], v[52:55]
    v_mfma_f32_16x16x32_bf16 v[52:55], a[108:111], a[12:15], v[52:55]
    s_nop 3
    v_max3_f32 v76, v48, v49, v76
    v_max3_f32 v76, v50, v51, v76
    s_nop 1
    v_max3_f32 v76, v52, v53, v76
    v_max3_f32 v76, v54, v55, v76
    v_mfma_f32_16x16x32_bf16 v[48:51], a[80:83], a[16:19], 0
    v_mfma_f32_16x16x32_bf16 v[48:51], a[84:87], a[20:23], v[48:51]
    v_mfma_f32_16x16x32_bf16 v[48:51], a[88:91], a[24:27], v[48:51]
    v_mfma_f32_16x16x32_bf16 v[48:51], a[92:95], a[28:31], v[48:51]
    v_mfma_f32_16x16x32_bf16 v[52:55], a[96:99], a[16:19], 0
    v_mfma_f32_16x16x32_bf16 v[52:55], a[100:103], a[20:23], v[52:55]
    v_mfma_f32_16x16x32_bf16 v[52:55], a[104:107], a[24:27], v[52:55]
    v_mfma_f32_16x16x32_bf16 v[52:55], a[108:111], a[28:31], v[52:55]
    s_nop 3
    v_max3_f32 v77, v48, v49, v77
    v_max3_f32 v77, v50, v51, v77
    s_nop 1
    v_max3_f32 v77, v52, v53, v77
    v_max3_f32 v77, v54, v55, v77
    v_mfma_f32_16x16x32_bf16 v[48:51], a[80:83], a[32:35], 0
    v_mfma_f32_16x16x32_bf16 v[48:51], a[84:87], a[36:39], v[48:51]
    v_mfma_f32_16x16x32_bf16 v[48:51], a[88:91], a[40:43], v[48:51]
    v_mfma_f32_16x16x32_bf16 v[48:51], a[92:95], a[44:47], v[48:51]
    v_mfma_f32_16x16x32_bf16 v[52:55], a[96:99], a[32:35], 0
    v_mfma_f32_16x16x32_bf16 v[52:55], a[100:103], a[36:39], v[52:55]
    v_mfma_f32_16x16x32_bf16 v[52:55], a[104:107], a[40:43], v[52:55]
    v_mfma_f32_16x16x32_bf16 v[52:55], a[108:111], a[44:47], v[52:55]
    s_nop 3
    v_max3_f32 v78, v48, v49, v78
    v_max3_f32 v78, v50, v51, v78
    s_nop 1
    v_max3_f32 v78, v52, v53, v78
    v_max3_f32 v78, v54, v55, v78
    v_mfma_f32_16x16x32_bf16 v[48:51], a[80:83], a[48:51], 0
    v_mfma_f32_16x16x32_bf16 v[48:51], a[84:87], a[52:55], v[48:51]
    v_mfma_f32_16x16x32_bf16 v[48:51], a[88:91], a[56:59], v[48:51]
    v_mfma_f32_16x16x32_bf16 v[48:51], a[92:95], a[60:63], v[48:51]
    v_mfma_f32_16x16x32_bf16 v[52:55], a[96:99], a[48:51], 0
    v_mfma_f32_16x16x32_bf16 v[52:55], a[100:103], a[52:55], v[52:55]
    v_mfma_f32_16x16x32_bf16 v[52:55], a[104:107], a[56:59], v[52:55]
    v_mfma_f32_16x16x32_bf16 v[52:55], a[108:111], a[60:63], v[52:55]
    s_nop 3
    v_max3_f32 v79, v48, v49, v79
    v_max3_f32 v79, v50, v51, v79
    s_nop 1
    v_max3_f32 v79, v52, v53, v79
    v_max3_f32 v79, v54, v55, v79
    v_mfma_f32_16x16x32_bf16 v[48:51], a[80:83], a[64:67], 0
    v_mfma_f32_16x16x32_bf16 v[48:51], a[84:87], a[68:71], v[48:51]
    v_mfma_f32_16x16x32_bf16 v[48:51], a[88:91], a[72:75], v[48:51]
    v_mfma_f32_16x16x32_bf16 v[48:51], a[92:95], a[76:79], v[48:51]
    v_mfma_f32_16x16x32_bf16 v[52:55], a[96:99], a[64:67], 0
    v_mfma_f32_16x16x32_bf16 v[52:55], a[100:103], a[68:71], v[52:55]
    v_mfma_f32_16x16x32_bf16 v[52:55], a[104:107], a[72:75], v[52:55]
    v_mfma_f32_16x16x32_bf16 v[52:55], a[108:111], a[76:79], v[52:55]
    s_nop 3
    v_max3_f32 v80, v48, v49, v80
    v_max3_f32 v80, v50, v51, v80
    s_nop 1
    v_max3_f32 v80, v52, v53, v80
    v_max3_f32 v80, v54, v55, v80
    s_add_u32 s90, s90, 1
    s_cmp_lt_u32 s90, 16
    s_cbranch_scc1 L_maxloop
    v_mov_b32 v4, v76
    s_nop 1
    v_permlane16_swap_b32 v4, v76
    v_max_f32 v76, v4, v76
    v_mov_b32 v4, v76
    s_nop 1
    v_permlane32_swap_b32 v4, v76
    v_max_f32 v76, v4, v76
    v_mov_b32 v4, v77
    s_nop 1
    v_permlane16_swap_b32 v4, v77
    v_max_f32 v77, v4, v77
    v_mov_b32 v4, v77
    s_nop 1
    v_permlane32_swap_b32 v4, v77
    v_max_f32 v77, v4, v77
    v_mov_b32 v4, v78
    s_nop 1
    v_permlane16_swap_b32 v4, v78
    v_max_f32 v78, v4, v78
    v_mov_b32 v4, v78
    s_nop 1
    v_permlane32_swap_b32 v4, v78
    v_max_f32 v78, v4, v78
    v_mov_b32 v4, v79
    s_nop 1
    v_permlane16_swap_b32 v4, v79
    v_max_f32 v79, v4, v79
    v_mov_b32 v4, v79
    s_nop 1
    v_permlane32_swap_b32 v4, v79
    v_max_f32 v79, v4, v79
    v_mov_b32 v4, v80
    s_nop 1
    v_permlane16_swap_b32 v4, v80
    v_max_f32 v80, v4, v80
    v_mov_b32 v4, v80
    s_nop 1
    v_permlane32_swap_b32 v4, v80
    v_max_f32 v80, v4, v80
    v_lshlrev_b32 v4, 2, v0
    s_mul_i32 s29, s20, 1280
    v_add_u32 v5, s29, v4
    v_add_u32 v5, 155648, v5
    v_add_u32 v4, 155648, v4
    ds_write_b32 v5, v76 offset:0
    ds_write_b32 v5, v77 offset:256
    ds_write_b32 v5, v78 offset:512
    ds_write_b32 v5, v79 offset:768
    ds_write_b32 v5, v80 offset:1024
    s_waitcnt lgkmcnt(0)
    s_barrier
    ds_read_b32 v48, v4 offset:0
    ds_read_b32 v49, v4 offset:1280
    ds_read_b32 v50, v4 offset:2560
    ds_read_b32 v51, v4 offset:3840
    s_waitcnt lgkmcnt(0)
    v_max3_f32 v5, v48, v49, v50
    v_max_f32 v5, v5, v51
    v_sub_f32 v28, 0, v5
    v_sub_f32 v29, 0, v5
    v_sub_f32 v30, 0, v5
    v_sub_f32 v31, 0, v5
    ds_read_b32 v48, v4 offset:256
    ds_read_b32 v49, v4 offset:1536
    ds_read_b32 v50, v4 offset:2816
    ds_read_b32 v51, v4 offset:4096
    s_waitcnt lgkmcnt(0)
    v_max3_f32 v5, v48, v49, v50
    v_max_f32 v5, v5, v51
    v_sub_f32 v32, 0, v5
    v_sub_f32 v33, 0, v5
    v_sub_f32 v34, 0, v5
    v_sub_f32 v35, 0, v5
    ds_read_b32 v48, v4 offset:512
    ds_read_b32 v49, v4 offset:1792
    ds_read_b32 v50, v4 offset:3072
    ds_read_b32 v51, v4 offset:4352
    s_waitcnt lgkmcnt(0)
    v_max3_f32 v5, v48, v49, v50
    v_max_f32 v5, v5, v51
    v_sub_f32 v36, 0, v5
    v_sub_f32 v37, 0, v5
    v_sub_f32 v38, 0, v5
    v_sub_f32 v39, 0, v5
    ds_read_b32 v48, v4 offset:768
    ds_read_b32 v49, v4 offset:2048
    ds_read_b32 v50, v4 offset:3328
    ds_read_b32 v51, v4 offset:4608
    s_waitcnt lgkmcnt(0)
    v_max3_f32 v5, v48, v49, v50
    v_max_f32 v5, v5, v51
    v_sub_f32 v40, 0, v5
    v_sub_f32 v41, 0, v5
    v_sub_f32 v42, 0, v5
    v_sub_f32 v43, 0, v5
    ds_read_b32 v48, v4 offset:1024
    ds_read_b32 v49, v4 offset:2304
    ds_read_b32 v50, v4 offset:3584
    ds_read_b32 v51, v4 offset:4864
    s_waitcnt lgkmcnt(0)
    v_max3_f32 v5, v48, v49, v50
    v_max_f32 v5, v5, v51
    v_sub_f32 v44, 0, v5
    v_sub_f32 v45, 0, v5
    v_sub_f32 v46, 0, v5
    v_sub_f32 v47, 0, v5
    s_bfe_u32 s25, s92, 0x40000
    s_lshl_b32 s25, s25, 13
    s_add_u32 s98, s25, 4096
    s_add_u32 m0, s24, 0
    s_nop 0
    buffer_load_dwordx4 v20, s[12:15], s25 offen offset:0 lds
    buffer_load_dwordx4 v21, s[12:15], s25 offen offset:1024 lds
    buffer_load_dwordx4 v22, s[12:15], s25 offen offset:2048 lds
    buffer_load_dwordx4 v23, s[12:15], s25 offen offset:3072 lds
    s_add_u32 m0, s24, 4096
    s_nop 0
    buffer_load_dwordx4 v20, s[12:15], s98 offen offset:0 lds
    buffer_load_dwordx4 v21, s[12:15], s98 offen offset:1024 lds
    buffer_load_dwordx4 v22, s[12:15], s98 offen offset:2048 lds
    buffer_load_dwordx4 v23, s[12:15], s98 offen offset:3072 lds
    s_add_u32 m0, s24, 65536
    s_nop 0
    buffer_load_dwordx4 v24, s[16:19], s25 offen offset:0 lds
    buffer_load_dwordx4 v25, s[16:19], s25 offen offset:1024 lds
    buffer_load_dwordx4 v24, s[16:19], s25 offen offset:2048 lds
    buffer_load_dwordx4 v25, s[16:19], s25 offen offset:3072 lds
    s_add_u32 m0, s24, 69632
    s_nop 0
    buffer_load_dwordx4 v24, s[16:19], s98 offen offset:0 lds
    buffer_load_dwordx4 v25, s[16:19], s98 offen offset:1024 lds
    buffer_load_dwordx4 v24, s[16:19], s98 offen offset:2048 lds
    buffer_load_dwordx4 v25, s[16:19], s98 offen offset:3072 lds
    s_bfe_u32 s25, s92, 0x40004
    s_lshl_b32 s25, s25, 13
    s_add_u32 s98, s25, 4096
    s_add_u32 m0, s24, 32768
    s_nop 0
    buffer_load_dwordx4 v20, s[12:15], s25 offen offset:0 lds
    buffer_load_dwordx4 v21, s[12:15], s25 offen offset:1024 lds
    buffer_load_dwordx4 v22, s[12:15], s25 offen offset:2048 lds
    buffer_load_dwordx4 v23, s[12:15], s25 offen offset:3072 lds
    s_add_u32 m0, s24, 36864
    s_nop 0
    buffer_load_dwordx4 v20, s[12:15], s98 offen offset:0 lds
    buffer_load_dwordx4 v21, s[12:15], s98 offen offset:1024 lds
    buffer_load_dwordx4 v22, s[12:15], s98 offen offset:2048 lds
    buffer_load_dwordx4 v23, s[12:15], s98 offen offset:3072 lds
    s_add_u32 m0, s24, 98304
    s_nop 0
    buffer_load_dwordx4 v24, s[16:19], s25 offen offset:0 lds
    buffer_load_dwordx4 v25, s[16:19], s25 offen offset:1024 lds
    buffer_load_dwordx4 v24, s[16:19], s25 offen offset:2048 lds
    buffer_load_dwordx4 v25, s[16:19], s25 offen offset:3072 lds
    s_add_u32 m0, s24, 102400
    s_nop 0
    buffer_load_dwordx4 v24, s[16:19], s98 offen offset:0 lds
    buffer_load_dwordx4 v25, s[16:19], s98 offen offset:1024 lds
    buffer_load_dwordx4 v24, s[16:19], s98 offen offset:2048 lds
    buffer_load_dwordx4 v25, s[16:19], s98 offen offset:3072 lds
L_attn:
    v_add_u32 v253, s24, v252
    v_lshlrev_b32 v4, 2, v0
    s_add_u32 s28, s24, 69632
    v_add_u32 v254, s28, v4
    s_waitcnt vmcnt(24)
    ds_read_b128 a[80:83], v8 offset:0
    ds_read_b128 a[84:87], v9 offset:0
    ds_read_b128 a[88:91], v10 offset:0
    ds_read_b128 a[92:95], v11 offset:0
    ds_read_b128 a[96:99], v8 offset:4096
    ds_read_b128 a[100:103], v9 offset:4096
    ds_read_b128 a[104:107], v10 offset:4096
    ds_read_b128 a[108:111], v11 offset:4096
    s_waitcnt lgkmcnt(7)
    v_mfma_f32_16x16x32_bf16 v[48:51], a[80:83], a[0:3], v[28:31]
    s_waitcnt lgkmcnt(6)
    v_mfma_f32_16x16x32_bf16 v[48:51], a[84:87], a[4:7], v[48:51]
    s_waitcnt lgkmcnt(5)
    v_mfma_f32_16x16x32_bf16 v[48:51], a[88:91], a[8:11], v[48:51]
    s_waitcnt vmcnt(16)
    ds_read_b64_tr_b16 a[112:113], v12 offset:0
    ds_read_b64_tr_b16 a[114:115], v12 offset:4096
    s_waitcnt lgkmcnt(6)
    v_mfma_f32_16x16x32_bf16 v[48:51], a[92:95], a[12:15], v[48:51]
    ds_read_b64_tr_b16 a[116:117], v13 offset:0
    ds_read_b64_tr_b16 a[118:119], v13 offset:4096
    s_waitcnt lgkmcnt(7)
    v_mfma_f32_16x16x32_bf16 v[52:55], a[96:99], a[0:3], v[28:31]
    ds_read_b64_tr_b16 a[120:121], v14 offset:0
    ds_read_b64_tr_b16 a[122:123], v14 offset:4096
    s_waitcnt lgkmcnt(7)
    v_mfma_f32_16x16x32_bf16 v[52:55], a[100:103], a[4:7], v[52:55]
    ds_read_b64_tr_b16 a[124:125], v15 offset:0
    ds_read_b64_tr_b16 a[126:127], v15 offset:4096
    v_mfma_f32_16x16x32_bf16 v[52:55], a[104:107], a[8:11], v[52:55]
    ds_read_b64_tr_b16 a[128:129], v16 offset:0
    ds_read_b64_tr_b16 a[130:131], v16 offset:4096
    s_waitcnt lgkmcnt(10)
    v_mfma_f32_16x16x32_bf16 v[52:55], a[108:111], a[12:15], v[52:55]
    ds_read_b64_tr_b16 a[132:133], v17 offset:0
    ds_read_b64_tr_b16 a[134:135], v17 offset:4096
    v_mfma_f32_16x16x32_bf16 v[56:59], a[80:83], a[16:19], v[32:35]
    s_bfe_u32 s25, s92, 0x40008
    s_lshl_b32 s25, s25, 13
    v_mfma_f32_16x16x32_bf16 v[56:59], a[84:87], a[20:23], v[56:59]
    s_add_u32 s98, s25, 4096
    s_add_u32 m0, s24, 0
    v_mfma_f32_16x16x32_bf16 v[56:59], a[88:91], a[24:27], v[56:59]
    buffer_load_dwordx4 v20, s[12:15], s25 offen offset:0 lds
    ds_read_b64_tr_b16 a[136:137], v18 offset:0
    v_mfma_f32_16x16x32_bf16 v[56:59], a[92:95], a[28:31], v[56:59]
    ds_read_b64_tr_b16 a[138:139], v18 offset:4096
    ds_read_b64_tr_b16 a[140:141], v19 offset:0
    v_mfma_f32_16x16x32_bf16 v[60:63], a[96:99], a[16:19], v[32:35]
    buffer_load_dwordx4 v21, s[12:15], s25 offen offset:1024 lds
    ds_read_b64_tr_b16 a[142:143], v19 offset:4096
    v_mfma_f32_16x16x32_bf16 v[60:63], a[100:103], a[20:23], v[60:63]
    v_exp_f32 v48, v48
    v_mfma_f32_16x16x32_bf16 v[60:63], a[104:107], a[24:27], v[60:63]
    v_exp_f32 v49, v49
    v_mfma_f32_16x16x32_bf16 v[60:63], a[108:111], a[28:31], v[60:63]
    v_exp_f32 v50, v50
    v_mfma_f32_16x16x32_bf16 v[64:67], a[80:83], a[32:35], v[36:39]
    buffer_load_dwordx4 v22, s[12:15], s25 offen offset:2048 lds
    v_cvt_pk_bf16_f32 v72, v48, v49
    v_mfma_f32_16x16x32_bf16 v[64:67], a[84:87], a[36:39], v[64:67]
    v_exp_f32 v51, v51
    v_mfma_f32_16x16x32_bf16 v[64:67], a[88:91], a[40:43], v[64:67]
    v_exp_f32 v52, v52
    v_mfma_f32_16x16x32_bf16 v[64:67], a[92:95], a[44:47], v[64:67]
    v_cvt_pk_bf16_f32 v73, v50, v51
    v_mfma_f32_16x16x32_bf16 v[68:71], a[96:99], a[32:35], v[36:39]
    v_exp_f32 v53, v53
    v_mfma_f32_16x16x32_bf16 v[68:71], a[100:103], a[36:39], v[68:71]
    v_exp_f32 v54, v54
    v_mfma_f32_16x16x32_bf16 v[68:71], a[104:107], a[40:43], v[68:71]
    v_cvt_pk_bf16_f32 v74, v52, v53
    v_exp_f32 v55, v55
    s_nop 0
    v_cvt_pk_bf16_f32 v75, v54, v55
    v_mfma_f32_16x16x32_bf16 v[68:71], a[108:111], a[44:47], v[68:71]
    buffer_load_dwordx4 v23, s[12:15], s25 offen offset:3072 lds
    s_waitcnt lgkmcnt(0)
    v_mfma_f32_16x16x32_bf16 v[84:87], a[112:115], v[72:75], 0
    s_add_u32 m0, s24, 4096
    s_nop 0
    buffer_load_dwordx4 v20, s[12:15], s98 offen offset:0 lds
    v_mfma_f32_16x16x32_bf16 v[104:107], a[116:119], v[72:75], 0
    v_exp_f32 v56, v56
    v_mfma_f32_16x16x32_bf16 v[124:127], a[120:123], v[72:75], 0
    v_exp_f32 v57, v57
    v_mfma_f32_16x16x32_bf16 v[144:147], a[124:127], v[72:75], 0
    v_exp_f32 v58, v58
    v_mfma_f32_16x16x32_bf16 v[164:167], a[128:131], v[72:75], 0
    buffer_load_dwordx4 v21, s[12:15], s98 offen offset:1024 lds
    v_cvt_pk_bf16_f32 v76, v56, v57
    v_mfma_f32_16x16x32_bf16 v[184:187], a[132:135], v[72:75], 0
    v_exp_f32 v59, v59
    v_mfma_f32_16x16x32_bf16 v[204:207], a[136:139], v[72:75], 0
    v_exp_f32 v60, v60
    v_mfma_f32_16x16x32_bf16 v[224:227], a[140:143], v[72:75], 0
    v_cvt_pk_bf16_f32 v77, v58, v59
    v_mfma_f32_16x16x32_bf16 a[144:147], a[164:167], v[72:75], 0
    buffer_load_dwordx4 v22, s[12:15], s98 offen offset:2048 lds
    v_mfma_f32_16x16x32_bf16 v[48:51], a[80:83], a[48:51], v[40:43]
    v_exp_f32 v61, v61
    v_mfma_f32_16x16x32_bf16 v[48:51], a[84:87], a[52:55], v[48:51]
    v_exp_f32 v62, v62
    v_mfma_f32_16x16x32_bf16 v[48:51], a[88:91], a[56:59], v[48:51]
    v_cvt_pk_bf16_f32 v78, v60, v61
    v_mfma_f32_16x16x32_bf16 v[48:51], a[92:95], a[60:63], v[48:51]
    v_exp_f32 v63, v63
    v_mfma_f32_16x16x32_bf16 v[52:55], a[96:99], a[48:51], v[40:43]
    v_cvt_pk_bf16_f32 v79, v62, v63
    buffer_load_dwordx4 v23, s[12:15], s98 offen offset:3072 lds
    s_add_u32 m0, s24, 65536
    s_nop 0
    buffer_load_dwordx4 v24, s[16:19], s25 offen offset:0 lds
    v_mfma_f32_16x16x32_bf16 v[52:55], a[100:103], a[52:55], v[52:55]
    buffer_load_dwordx4 v25, s[16:19], s25 offen offset:1024 lds
    v_mfma_f32_16x16x32_bf16 v[52:55], a[104:107], a[56:59], v[52:55]
    v_exp_f32 v64, v64
    v_mfma_f32_16x16x32_bf16 v[52:55], a[108:111], a[60:63], v[52:55]
    v_exp_f32 v65, v65
    v_mfma_f32_16x16x32_bf16 v[88:91], a[112:115], v[76:79], 0
    buffer_load_dwordx4 v24, s[16:19], s25 offen offset:2048 lds
    v_mfma_f32_16x16x32_bf16 v[108:111], a[116:119], v[76:79], 0
    v_exp_f32 v66, v66
    v_mfma_f32_16x16x32_bf16 v[128:131], a[120:123], v[76:79], 0
    v_cvt_pk_bf16_f32 v80, v64, v65
    v_mfma_f32_16x16x32_bf16 v[148:151], a[124:127], v[76:79], 0
    v_exp_f32 v67, v67
    v_mfma_f32_16x16x32_bf16 v[168:171], a[128:131], v[76:79], 0
    buffer_load_dwordx4 v25, s[16:19], s25 offen offset:3072 lds
    v_mfma_f32_16x16x32_bf16 v[188:191], a[132:135], v[76:79], 0
    v_exp_f32 v68, v68
    v_mfma_f32_16x16x32_bf16 v[208:211], a[136:139], v[76:79], 0
    v_cvt_pk_bf16_f32 v81, v66, v67
    v_mfma_f32_16x16x32_bf16 v[228:231], a[140:143], v[76:79], 0
    v_exp_f32 v69, v69
    v_mfma_f32_16x16x32_bf16 a[148:151], a[164:167], v[76:79], 0
    s_add_u32 m0, s24, 69632
    s_nop 0
    buffer_load_dwordx4 v24, s[16:19], s98 offen offset:0 lds
    v_mfma_f32_16x16x32_bf16 v[56:59], a[80:83], a[64:67], v[44:47]
    v_exp_f32 v70, v70
    v_mfma_f32_16x16x32_bf16 v[56:59], a[84:87], a[68:71], v[56:59]
    v_cvt_pk_bf16_f32 v82, v68, v69
    s_waitcnt vmcnt(21)
    ds_read_b128 a[80:83], v8 offset:32768
    v_mfma_f32_16x16x32_bf16 v[56:59], a[88:91], a[72:75], v[56:59]
    v_exp_f32 v71, v71
    v_mfma_f32_16x16x32_bf16 v[56:59], a[92:95], a[76:79], v[56:59]
    v_cvt_pk_bf16_f32 v83, v70, v71
    buffer_load_dwordx4 v25, s[16:19], s98 offen offset:1024 lds
    v_mfma_f32_16x16x32_bf16 v[60:63], a[96:99], a[64:67], v[44:47]
    ds_read_b128 a[84:87], v9 offset:32768
    ds_read_b128 a[88:91], v10 offset:32768
    v_mfma_f32_16x16x32_bf16 v[60:63], a[100:103], a[68:71], v[60:63]
    ds_read_b128 a[92:95], v11 offset:32768
    ds_read_b128 a[96:99], v8 offset:36864
    v_mfma_f32_16x16x32_bf16 v[60:63], a[104:107], a[72:75], v[60:63]
    ds_read_b128 a[100:103], v9 offset:36864
    ds_read_b128 a[104:107], v10 offset:36864
    v_mfma_f32_16x16x32_bf16 v[60:63], a[108:111], a[76:79], v[60:63]
    buffer_load_dwordx4 v24, s[16:19], s98 offen offset:2048 lds
    ds_read_b128 a[108:111], v11 offset:36864
    v_mfma_f32_16x16x32_bf16 v[92:95], a[112:115], v[80:83], 0
    v_exp_f32 v48, v48
    v_mfma_f32_16x16x32_bf16 v[112:115], a[116:119], v[80:83], 0
    v_exp_f32 v49, v49
    v_mfma_f32_16x16x32_bf16 v[132:135], a[120:123], v[80:83], 0
    v_exp_f32 v50, v50
    v_mfma_f32_16x16x32_bf16 v[152:155], a[124:127], v[80:83], 0
    buffer_load_dwordx4 v25, s[16:19], s98 offen offset:3072 lds
    v_cvt_pk_bf16_f32 v72, v48, v49
    v_mfma_f32_16x16x32_bf16 v[172:175], a[128:131], v[80:83], 0
    v_exp_f32 v51, v51
    v_mfma_f32_16x16x32_bf16 v[192:195], a[132:135], v[80:83], 0
    v_exp_f32 v52, v52
    v_mfma_f32_16x16x32_bf16 v[212:215], a[136:139], v[80:83], 0
    v_cvt_pk_bf16_f32 v73, v50, v51
    v_mfma_f32_16x16x32_bf16 v[232:235], a[140:143], v[80:83], 0
    v_exp_f32 v53, v53
    v_mfma_f32_16x16x32_bf16 a[152:155], a[164:167], v[80:83], 0
    v_exp_f32 v54, v54
    s_waitcnt lgkmcnt(0)
    v_mfma_f32_16x16x32_bf16 v[64:67], a[80:83], a[0:3], v[28:31]
    v_cvt_pk_bf16_f32 v74, v52, v53
    v_mfma_f32_16x16x32_bf16 v[64:67], a[84:87], a[4:7], v[64:67]
    v_exp_f32 v55, v55
    v_mfma_f32_16x16x32_bf16 v[64:67], a[88:91], a[8:11], v[64:67]
    v_cvt_pk_bf16_f32 v75, v54, v55
    v_mfma_f32_16x16x32_bf16 v[64:67], a[92:95], a[12:15], v[64:67]
    v_exp_f32 v56, v56
    v_mfma_f32_16x16x32_bf16 v[68:71], a[96:99], a[0:3], v[28:31]
    v_exp_f32 v57, v57
    v_mfma_f32_16x16x32_bf16 v[68:71], a[100:103], a[4:7], v[68:71]
    v_exp_f32 v58, v58
    v_mfma_f32_16x16x32_bf16 v[68:71], a[104:107], a[8:11], v[68:71]
    v_cvt_pk_bf16_f32 v76, v56, v57
    v_mfma_f32_16x16x32_bf16 v[68:71], a[108:111], a[12:15], v[68:71]
    v_exp_f32 v59, v59
    v_mfma_f32_16x16x32_bf16 v[96:99], a[112:115], v[72:75], 0
    s_bfe_u32 s25, s92, 0x4000c
    s_lshl_b32 s25, s25, 13
    v_mfma_f32_16x16x32_bf16 v[116:119], a[116:119], v[72:75], 0
    s_add_u32 s98, s25, 4096
    s_add_u32 m0, s24, 32768
    v_mfma_f32_16x16x32_bf16 v[136:139], a[120:123], v[72:75], 0
    buffer_load_dwordx4 v20, s[12:15], s25 offen offset:0 lds
    v_mfma_f32_16x16x32_bf16 v[156:159], a[124:127], v[72:75], 0
    v_exp_f32 v60, v60
    v_mfma_f32_16x16x32_bf16 v[176:179], a[128:131], v[72:75], 0
    buffer_load_dwordx4 v21, s[12:15], s25 offen offset:1024 lds
    v_cvt_pk_bf16_f32 v77, v58, v59
    v_mfma_f32_16x16x32_bf16 v[196:199], a[132:135], v[72:75], 0
    v_exp_f32 v61, v61
    v_mfma_f32_16x16x32_bf16 v[216:219], a[136:139], v[72:75], 0
    v_exp_f32 v62, v62
    v_mfma_f32_16x16x32_bf16 v[236:239], a[140:143], v[72:75], 0
    v_cvt_pk_bf16_f32 v78, v60, v61
    v_mfma_f32_16x16x32_bf16 a[156:159], a[164:167], v[72:75], 0
    buffer_load_dwordx4 v22, s[12:15], s25 offen offset:2048 lds
    v_mfma_f32_16x16x32_bf16 v[48:51], a[80:83], a[16:19], v[32:35]
    v_exp_f32 v63, v63
    v_mfma_f32_16x16x32_bf16 v[48:51], a[84:87], a[20:23], v[48:51]
    v_cvt_pk_bf16_f32 v79, v62, v63
    v_mfma_f32_16x16x32_bf16 v[48:51], a[88:91], a[24:27], v[48:51]
    v_exp_f32 v64, v64
    v_mfma_f32_16x16x32_bf16 v[48:51], a[92:95], a[28:31], v[48:51]
    buffer_load_dwordx4 v23, s[12:15], s25 offen offset:3072 lds
    v_mfma_f32_16x16x32_bf16 v[52:55], a[96:99], a[16:19], v[32:35]
    v_exp_f32 v65, v65
    v_mfma_f32_16x16x32_bf16 v[52:55], a[100:103], a[20:23], v[52:55]
    v_exp_f32 v66, v66
    v_mfma_f32_16x16x32_bf16 v[52:55], a[104:107], a[24:27], v[52:55]
    v_cvt_pk_bf16_f32 v80, v64, v65
    v_mfma_f32_16x16x32_bf16 v[52:55], a[108:111], a[28:31], v[52:55]
    s_add_u32 m0, s24, 36864
    s_nop 0
    buffer_load_dwordx4 v20, s[12:15], s98 offen offset:0 lds
    v_mfma_f32_16x16x32_bf16 v[100:103], a[112:115], v[76:79], 0
    s_waitcnt vmcnt(21)
    ds_read_b64_tr_b16 a[112:113], v12 offset:32768
    ds_read_b64_tr_b16 a[114:115], v12 offset:36864
    v_mfma_f32_16x16x32_bf16 v[120:123], a[116:119], v[76:79], 0
    ds_read_b64_tr_b16 a[116:117], v13 offset:32768
    ds_read_b64_tr_b16 a[118:119], v13 offset:36864
    v_mfma_f32_16x16x32_bf16 v[140:143], a[120:123], v[76:79], 0
    v_exp_f32 v67, v67
    v_mfma_f32_16x16x32_bf16 v[160:163], a[124:127], v[76:79], 0
    buffer_load_dwordx4 v21, s[12:15], s98 offen offset:1024 lds
    ds_read_b64_tr_b16 a[120:121], v14 offset:32768
    v_mfma_f32_16x16x32_bf16 v[180:183], a[128:131], v[76:79], 0
    v_exp_f32 v68, v68
    v_mfma_f32_16x16x32_bf16 v[200:203], a[132:135], v[76:79], 0
    v_cvt_pk_bf16_f32 v81, v66, v67
    ds_read_b64_tr_b16 a[122:123], v14 offset:36864
    v_mfma_f32_16x16x32_bf16 v[220:223], a[136:139], v[76:79], 0
    v_exp_f32 v69, v69
    v_mfma_f32_16x16x32_bf16 v[240:243], a[140:143], v[76:79], 0
    buffer_load_dwordx4 v22, s[12:15], s98 offen offset:2048 lds
    ds_read_b64_tr_b16 a[124:125], v15 offset:32768
    v_mfma_f32_16x16x32_bf16 a[160:163], a[164:167], v[76:79], 0
    v_exp_f32 v70, v70
    v_mfma_f32_16x16x32_bf16 v[56:59], a[80:83], a[32:35], v[36:39]
    v_cvt_pk_bf16_f32 v82, v68, v69
    ds_read_b64_tr_b16 a[126:127], v15 offset:36864
    v_mfma_f32_16x16x32_bf16 v[56:59], a[84:87], a[36:39], v[56:59]
    v_exp_f32 v71, v71
    v_mfma_f32_16x16x32_bf16 v[56:59], a[88:91], a[40:43], v[56:59]
    v_cvt_pk_bf16_f32 v83, v70, v71
    buffer_load_dwordx4 v23, s[12:15], s98 offen offset:3072 lds
    v_mfma_f32_16x16x32_bf16 v[56:59], a[92:95], a[44:47], v[56:59]
    ds_read_b64_tr_b16 a[128:129], v16 offset:32768
    ds_read_b64_tr_b16 a[130:131], v16 offset:36864
    v_mfma_f32_16x16x32_bf16 v[60:63], a[96:99], a[32:35], v[36:39]
    ds_read_b64_tr_b16 a[132:133], v17 offset:32768
    ds_read_b64_tr_b16 a[134:135], v17 offset:36864
    v_mfma_f32_16x16x32_bf16 v[60:63], a[100:103], a[36:39], v[60:63]
    ds_read_b64_tr_b16 a[136:137], v18 offset:32768
    ds_read_b64_tr_b16 a[138:139], v18 offset:36864
    v_mfma_f32_16x16x32_bf16 v[60:63], a[104:107], a[40:43], v[60:63]
    ds_read_b64_tr_b16 a[140:141], v19 offset:32768
    ds_read_b64_tr_b16 a[142:143], v19 offset:36864
    v_mfma_f32_16x16x32_bf16 v[60:63], a[108:111], a[44:47], v[60:63]
    v_exp_f32 v48, v48
    s_waitcnt lgkmcnt(8)
    v_mfma_f32_16x16x32_bf16 v[84:87], a[112:115], v[80:83], v[84:87]
    v_exp_f32 v49, v49
    v_mfma_f32_16x16x32_bf16 v[104:107], a[116:119], v[80:83], v[104:107]
    v_exp_f32 v50, v50
    v_mfma_f32_16x16x32_bf16 v[124:127], a[120:123], v[80:83], v[124:127]
    v_cvt_pk_bf16_f32 v72, v48, v49
    v_mfma_f32_16x16x32_bf16 v[144:147], a[124:127], v[80:83], v[144:147]
    v_exp_f32 v51, v51
    s_waitcnt lgkmcnt(2)
    v_mfma_f32_16x16x32_bf16 v[164:167], a[128:131], v[80:83], v[164:167]
    v_exp_f32 v52, v52
    v_mfma_f32_16x16x32_bf16 v[184:187], a[132:135], v[80:83], v[184:187]
    v_cvt_pk_bf16_f32 v73, v50, v51
    v_mfma_f32_16x16x32_bf16 v[204:207], a[136:139], v[80:83], v[204:207]
    v_exp_f32 v53, v53
    s_waitcnt lgkmcnt(0)
    v_mfma_f32_16x16x32_bf16 v[224:227], a[140:143], v[80:83], v[224:227]
    v_exp_f32 v54, v54
    v_mfma_f32_16x16x32_bf16 a[144:147], a[164:167], v[80:83], a[144:147]
    v_cvt_pk_bf16_f32 v74, v52, v53
    v_mfma_f32_16x16x32_bf16 v[64:67], a[80:83], a[48:51], v[40:43]
    s_add_u32 m0, s24, 98304
    s_nop 0
    buffer_load_dwordx4 v24, s[16:19], s25 offen offset:0 lds
    v_mfma_f32_16x16x32_bf16 v[64:67], a[84:87], a[52:55], v[64:67]
    v_exp_f32 v55, v55
    v_mfma_f32_16x16x32_bf16 v[64:67], a[88:91], a[56:59], v[64:67]
    v_cvt_pk_bf16_f32 v75, v54, v55
    v_mfma_f32_16x16x32_bf16 v[64:67], a[92:95], a[60:63], v[64:67]
    v_exp_f32 v56, v56
    v_mfma_f32_16x16x32_bf16 v[68:71], a[96:99], a[48:51], v[40:43]
    buffer_load_dwordx4 v25, s[16:19], s25 offen offset:1024 lds
    v_mfma_f32_16x16x32_bf16 v[68:71], a[100:103], a[52:55], v[68:71]
    v_exp_f32 v57, v57
    v_mfma_f32_16x16x32_bf16 v[68:71], a[104:107], a[56:59], v[68:71]
    v_exp_f32 v58, v58
    v_mfma_f32_16x16x32_bf16 v[68:71], a[108:111], a[60:63], v[68:71]
    v_cvt_pk_bf16_f32 v76, v56, v57
    v_mfma_f32_16x16x32_bf16 v[88:91], a[112:115], v[72:75], v[88:91]
    buffer_load_dwordx4 v24, s[16:19], s25 offen offset:2048 lds
    v_mfma_f32_16x16x32_bf16 v[108:111], a[116:119], v[72:75], v[108:111]
    v_exp_f32 v59, v59
    v_mfma_f32_16x16x32_bf16 v[128:131], a[120:123], v[72:75], v[128:131]
    v_exp_f32 v60, v60
    v_mfma_f32_16x16x32_bf16 v[148:151], a[124:127], v[72:75], v[148:151]
    v_cvt_pk_bf16_f32 v77, v58, v59
    v_mfma_f32_16x16x32_bf16 v[168:171], a[128:131], v[72:75], v[168:171]
    buffer_load_dwordx4 v25, s[16:19], s25 offen offset:3072 lds
    v_mfma_f32_16x16x32_bf16 v[188:191], a[132:135], v[72:75], v[188:191]
    v_exp_f32 v61, v61
    v_mfma_f32_16x16x32_bf16 v[208:211], a[136:139], v[72:75], v[208:211]
    v_exp_f32 v62, v62
    v_mfma_f32_16x16x32_bf16 v[228:231], a[140:143], v[72:75], v[228:231]
    v_cvt_pk_bf16_f32 v78, v60, v61
    v_mfma_f32_16x16x32_bf16 a[148:151], a[164:167], v[72:75], a[148:151]
    s_add_u32 m0, s24, 102400
    s_nop 0
    buffer_load_dwordx4 v24, s[16:19], s98 offen offset:0 lds
    v_mfma_f32_16x16x32_bf16 v[48:51], a[80:83], a[64:67], v[44:47]
    v_exp_f32 v63, v63
    v_mfma_f32_16x16x32_bf16 v[48:51], a[84:87], a[68:71], v[48:51]
    v_cvt_pk_bf16_f32 v79, v62, v63
    s_waitcnt vmcnt(21)
    ds_read_b128 a[80:83], v8 offset:0
    v_mfma_f32_16x16x32_bf16 v[48:51], a[88:91], a[72:75], v[48:51]
    ds_read_b128 a[84:87], v9 offset:0
    ds_read_b128 a[88:91], v10 offset:0
    v_mfma_f32_16x16x32_bf16 v[48:51], a[92:95], a[76:79], v[48:51]
    buffer_load_dwordx4 v25, s[16:19], s98 offen offset:1024 lds
    ds_read_b128 a[92:95], v11 offset:0
    v_mfma_f32_16x16x32_bf16 v[52:55], a[96:99], a[64:67], v[44:47]
    ds_read_b128 a[96:99], v8 offset:4096
    v_mfma_f32_16x16x32_bf16 v[52:55], a[100:103], a[68:71], v[52:55]
    ds_read_b128 a[100:103], v9 offset:4096
    v_mfma_f32_16x16x32_bf16 v[52:55], a[104:107], a[72:75], v[52:55]
    ds_read_b128 a[104:107], v10 offset:4096
    v_mfma_f32_16x16x32_bf16 v[52:55], a[108:111], a[76:79], v[52:55]
    buffer_load_dwordx4 v24, s[16:19], s98 offen offset:2048 lds
    ds_read_b128 a[108:111], v11 offset:4096
    v_mfma_f32_16x16x32_bf16 v[92:95], a[112:115], v[76:79], v[92:95]
    v_exp_f32 v64, v64
    v_mfma_f32_16x16x32_bf16 v[112:115], a[116:119], v[76:79], v[112:115]
    v_exp_f32 v65, v65
    v_mfma_f32_16x16x32_bf16 v[132:135], a[120:123], v[76:79], v[132:135]
    v_exp_f32 v66, v66
    v_mfma_f32_16x16x32_bf16 v[152:155], a[124:127], v[76:79], v[152:155]
    buffer_load_dwordx4 v25, s[16:19], s98 offen offset:3072 lds
    v_cvt_pk_bf16_f32 v80, v64, v65
    v_mfma_f32_16x16x32_bf16 v[172:175], a[128:131], v[76:79], v[172:175]
    v_exp_f32 v67, v67
    v_mfma_f32_16x16x32_bf16 v[192:195], a[132:135], v[76:79], v[192:195]
    v_exp_f32 v68, v68
    v_mfma_f32_16x16x32_bf16 v[212:215], a[136:139], v[76:79], v[212:215]
    v_cvt_pk_bf16_f32 v81, v66, v67
    v_mfma_f32_16x16x32_bf16 v[232:235], a[140:143], v[76:79], v[232:235]
    v_exp_f32 v69, v69
    v_mfma_f32_16x16x32_bf16 a[152:155], a[164:167], v[76:79], a[152:155]
    v_exp_f32 v70, v70
    s_waitcnt lgkmcnt(0)
    v_mfma_f32_16x16x32_bf16 v[56:59], a[80:83], a[0:3], v[28:31]
    v_cvt_pk_bf16_f32 v82, v68, v69
    v_mfma_f32_16x16x32_bf16 v[56:59], a[84:87], a[4:7], v[56:59]
    v_exp_f32 v71, v71
    v_mfma_f32_16x16x32_bf16 v[56:59], a[88:91], a[8:11], v[56:59]
    v_cvt_pk_bf16_f32 v83, v70, v71
    v_mfma_f32_16x16x32_bf16 v[56:59], a[92:95], a[12:15], v[56:59]
    v_exp_f32 v48, v48
    v_mfma_f32_16x16x32_bf16 v[60:63], a[96:99], a[0:3], v[28:31]
    v_exp_f32 v49, v49
    v_mfma_f32_16x16x32_bf16 v[60:63], a[100:103], a[4:7], v[60:63]
    v_exp_f32 v50, v50
    v_mfma_f32_16x16x32_bf16 v[60:63], a[104:107], a[8:11], v[60:63]
    v_cvt_pk_bf16_f32 v72, v48, v49
    v_mfma_f32_16x16x32_bf16 v[60:63], a[108:111], a[12:15], v[60:63]
    v_exp_f32 v51, v51
    v_mfma_f32_16x16x32_bf16 v[96:99], a[112:115], v[80:83], v[96:99]
    s_bfe_u32 s25, s92, 0x40010
    s_lshl_b32 s25, s25, 13
    v_mfma_f32_16x16x32_bf16 v[116:119], a[116:119], v[80:83], v[116:119]
    s_add_u32 s98, s25, 4096
    s_add_u32 m0, s24, 0
    v_mfma_f32_16x16x32_bf16 v[136:139], a[120:123], v[80:83], v[136:139]
    buffer_load_dwordx4 v20, s[12:15], s25 offen offset:0 lds
    v_mfma_f32_16x16x32_bf16 v[156:159], a[124:127], v[80:83], v[156:159]
    v_exp_f32 v52, v52
    v_mfma_f32_16x16x32_bf16 v[176:179], a[128:131], v[80:83], v[176:179]
    buffer_load_dwordx4 v21, s[12:15], s25 offen offset:1024 lds
    v_cvt_pk_bf16_f32 v73, v50, v51
    v_mfma_f32_16x16x32_bf16 v[196:199], a[132:135], v[80:83], v[196:199]
    v_exp_f32 v53, v53
    v_mfma_f32_16x16x32_bf16 v[216:219], a[136:139], v[80:83], v[216:219]
    v_exp_f32 v54, v54
    v_mfma_f32_16x16x32_bf16 v[236:239], a[140:143], v[80:83], v[236:239]
    v_cvt_pk_bf16_f32 v74, v52, v53
    v_mfma_f32_16x16x32_bf16 a[156:159], a[164:167], v[80:83], a[156:159]
    buffer_load_dwordx4 v22, s[12:15], s25 offen offset:2048 lds
    v_mfma_f32_16x16x32_bf16 v[64:67], a[80:83], a[16:19], v[32:35]
    v_exp_f32 v55, v55
    v_mfma_f32_16x16x32_bf16 v[64:67], a[84:87], a[20:23], v[64:67]
    v_cvt_pk_bf16_f32 v75, v54, v55
    v_mfma_f32_16x16x32_bf16 v[64:67], a[88:91], a[24:27], v[64:67]
    v_exp_f32 v56, v56
    v_mfma_f32_16x16x32_bf16 v[64:67], a[92:95], a[28:31], v[64:67]
    buffer_load_dwordx4 v23, s[12:15], s25 offen offset:3072 lds
    v_mfma_f32_16x16x32_bf16 v[68:71], a[96:99], a[16:19], v[32:35]
    v_exp_f32 v57, v57
    v_mfma_f32_16x16x32_bf16 v[68:71], a[100:103], a[20:23], v[68:71]
    v_exp_f32 v58, v58
    v_mfma_f32_16x16x32_bf16 v[68:71], a[104:107], a[24:27], v[68:71]
    v_cvt_pk_bf16_f32 v76, v56, v57
    v_mfma_f32_16x16x32_bf16 v[68:71], a[108:111], a[28:31], v[68:71]
    s_add_u32 m0, s24, 4096
    s_nop 0
    buffer_load_dwordx4 v20, s[12:15], s98 offen offset:0 lds
    v_mfma_f32_16x16x32_bf16 v[100:103], a[112:115], v[72:75], v[100:103]
    s_waitcnt vmcnt(21)
    ds_read_b64_tr_b16 a[112:113], v12 offset:0
    ds_read_b64_tr_b16 a[114:115], v12 offset:4096
    v_mfma_f32_16x16x32_bf16 v[120:123], a[116:119], v[72:75], v[120:123]
    ds_read_b64_tr_b16 a[116:117], v13 offset:0
    ds_read_b64_tr_b16 a[118:119], v13 offset:4096
    v_mfma_f32_16x16x32_bf16 v[140:143], a[120:123], v[72:75], v[140:143]
    v_exp_f32 v59, v59
    v_mfma_f32_16x16x32_bf16 v[160:163], a[124:127], v[72:75], v[160:163]
    buffer_load_dwordx4 v21, s[12:15], s98 offen offset:1024 lds
    ds_read_b64_tr_b16 a[120:121], v14 offset:0
    v_mfma_f32_16x16x32_bf16 v[180:183], a[128:131], v[72:75], v[180:183]
    v_exp_f32 v60, v60
    v_mfma_f32_16x16x32_bf16 v[200:203], a[132:135], v[72:75], v[200:203]
    v_cvt_pk_bf16_f32 v77, v58, v59
    ds_read_b64_tr_b16 a[122:123], v14 offset:4096
    v_mfma_f32_16x16x32_bf16 v[220:223], a[136:139], v[72:75], v[220:223]
    v_exp_f32 v61, v61
    v_mfma_f32_16x16x32_bf16 v[240:243], a[140:143], v[72:75], v[240:243]
    buffer_load_dwordx4 v22, s[12:15], s98 offen offset:2048 lds
    ds_read_b64_tr_b16 a[124:125], v15 offset:0
    v_mfma_f32_16x16x32_bf16 a[160:163], a[164:167], v[72:75], a[160:163]
    v_exp_f32 v62, v62
    v_mfma_f32_16x16x32_bf16 v[48:51], a[80:83], a[32:35], v[36:39]
    v_cvt_pk_bf16_f32 v78, v60, v61
    ds_read_b64_tr_b16 a[126:127], v15 offset:4096
    v_mfma_f32_16x16x32_bf16 v[48:51], a[84:87], a[36:39], v[48:51]
    v_exp_f32 v63, v63
    v_mfma_f32_16x16x32_bf16 v[48:51], a[88:91], a[40:43], v[48:51]
    v_cvt_pk_bf16_f32 v79, v62, v63
    buffer_load_dwordx4 v23, s[12:15], s98 offen offset:3072 lds
    v_mfma_f32_16x16x32_bf16 v[48:51], a[92:95], a[44:47], v[48:51]
    ds_read_b64_tr_b16 a[128:129], v16 offset:0
    ds_read_b64_tr_b16 a[130:131], v16 offset:4096
    v_mfma_f32_16x16x32_bf16 v[52:55], a[96:99], a[32:35], v[36:39]
    ds_read_b64_tr_b16 a[132:133], v17 offset:0
    ds_read_b64_tr_b16 a[134:135], v17 offset:4096
    v_mfma_f32_16x16x32_bf16 v[52:55], a[100:103], a[36:39], v[52:55]
    ds_read_b64_tr_b16 a[136:137], v18 offset:0
    ds_read_b64_tr_b16 a[138:139], v18 offset:4096
    v_mfma_f32_16x16x32_bf16 v[52:55], a[104:107], a[40:43], v[52:55]
    ds_read_b64_tr_b16 a[140:141], v19 offset:0
    ds_read_b64_tr_b16 a[142:143], v19 offset:4096
    v_mfma_f32_16x16x32_bf16 v[52:55], a[108:111], a[44:47], v[52:55]
    v_exp_f32 v64, v64
    s_waitcnt lgkmcnt(8)
    v_mfma_f32_16x16x32_bf16 v[84:87], a[112:115], v[76:79], v[84:87]
    v_exp_f32 v65, v65
    v_mfma_f32_16x16x32_bf16 v[104:107], a[116:119], v[76:79], v[104:107]
    v_exp_f32 v66, v66
    v_mfma_f32_16x16x32_bf16 v[124:127], a[120:123], v[76:79], v[124:127]
    v_cvt_pk_bf16_f32 v80, v64, v65
    v_mfma_f32_16x16x32_bf16 v[144:147], a[124:127], v[76:79], v[144:147]
    v_exp_f32 v67, v67
    s_waitcnt lgkmcnt(2)
    v_mfma_f32_16x16x32_bf16 v[164:167], a[128:131], v[76:79], v[164:167]
    v_exp_f32 v68, v68
    v_mfma_f32_16x16x32_bf16 v[184:187], a[132:135], v[76:79], v[184:187]
    v_cvt_pk_bf16_f32 v81, v66, v67
    v_mfma_f32_16x16x32_bf16 v[204:207], a[136:139], v[76:79], v[204:207]
    v_exp_f32 v69, v69
    s_waitcnt lgkmcnt(0)
    v_mfma_f32_16x16x32_bf16 v[224:227], a[140:143], v[76:79], v[224:227]
    v_exp_f32 v70, v70
    v_mfma_f32_16x16x32_bf16 a[144:147], a[164:167], v[76:79], a[144:147]
    v_cvt_pk_bf16_f32 v82, v68, v69
    v_mfma_f32_16x16x32_bf16 v[56:59], a[80:83], a[48:51], v[40:43]
    s_add_u32 m0, s24, 65536
    s_nop 0
    buffer_load_dwordx4 v24, s[16:19], s25 offen offset:0 lds
    v_mfma_f32_16x16x32_bf16 v[56:59], a[84:87], a[52:55], v[56:59]
    v_exp_f32 v71, v71
    v_mfma_f32_16x16x32_bf16 v[56:59], a[88:91], a[56:59], v[56:59]
    v_cvt_pk_bf16_f32 v83, v70, v71
    v_mfma_f32_16x16x32_bf16 v[56:59], a[92:95], a[60:63], v[56:59]
    v_exp_f32 v48, v48
    v_mfma_f32_16x16x32_bf16 v[60:63], a[96:99], a[48:51], v[40:43]
    buffer_load_dwordx4 v25, s[16:19], s25 offen offset:1024 lds
    v_mfma_f32_16x16x32_bf16 v[60:63], a[100:103], a[52:55], v[60:63]
    v_exp_f32 v49, v49
    v_mfma_f32_16x16x32_bf16 v[60:63], a[104:107], a[56:59], v[60:63]
    v_exp_f32 v50, v50
    v_mfma_f32_16x16x32_bf16 v[60:63], a[108:111], a[60:63], v[60:63]
    v_cvt_pk_bf16_f32 v72, v48, v49
    v_mfma_f32_16x16x32_bf16 v[88:91], a[112:115], v[80:83], v[88:91]
    buffer_load_dwordx4 v24, s[16:19], s25 offen offset:2048 lds
    v_mfma_f32_16x16x32_bf16 v[108:111], a[116:119], v[80:83], v[108:111]
    v_exp_f32 v51, v51
    v_mfma_f32_16x16x32_bf16 v[128:131], a[120:123], v[80:83], v[128:131]
    v_exp_f32 v52, v52
    v_mfma_f32_16x16x32_bf16 v[148:151], a[124:127], v[80:83], v[148:151]
    v_cvt_pk_bf16_f32 v73, v50, v51
    v_mfma_f32_16x16x32_bf16 v[168:171], a[128:131], v[80:83], v[168:171]
    buffer_load_dwordx4 v25, s[16:19], s25 offen offset:3072 lds
    v_mfma_f32_16x16x32_bf16 v[188:191], a[132:135], v[80:83], v[188:191]
    v_exp_f32 v53, v53
    v_mfma_f32_16x16x32_bf16 v[208:211], a[136:139], v[80:83], v[208:211]
    v_exp_f32 v54, v54
    v_mfma_f32_16x16x32_bf16 v[228:231], a[140:143], v[80:83], v[228:231]
    v_cvt_pk_bf16_f32 v74, v52, v53
    v_mfma_f32_16x16x32_bf16 a[148:151], a[164:167], v[80:83], a[148:151]
    s_add_u32 m0, s24, 69632
    s_nop 0
    buffer_load_dwordx4 v24, s[16:19], s98 offen offset:0 lds
    v_mfma_f32_16x16x32_bf16 v[64:67], a[80:83], a[64:67], v[44:47]
    v_exp_f32 v55, v55
    v_mfma_f32_16x16x32_bf16 v[64:67], a[84:87], a[68:71], v[64:67]
    v_cvt_pk_bf16_f32 v75, v54, v55
    s_waitcnt vmcnt(21)
    ds_read_b128 a[80:83], v8 offset:32768
    v_mfma_f32_16x16x32_bf16 v[64:67], a[88:91], a[72:75], v[64:67]
    ds_read_b128 a[84:87], v9 offset:32768
    ds_read_b128 a[88:91], v10 offset:32768
    v_mfma_f32_16x16x32_bf16 v[64:67], a[92:95], a[76:79], v[64:67]
    buffer_load_dwordx4 v25, s[16:19], s98 offen offset:1024 lds
    ds_read_b128 a[92:95], v11 offset:32768
    v_mfma_f32_16x16x32_bf16 v[68:71], a[96:99], a[64:67], v[44:47]
    ds_read_b128 a[96:99], v8 offset:36864
    v_mfma_f32_16x16x32_bf16 v[68:71], a[100:103], a[68:71], v[68:71]
    ds_read_b128 a[100:103], v9 offset:36864
    v_mfma_f32_16x16x32_bf16 v[68:71], a[104:107], a[72:75], v[68:71]
    ds_read_b128 a[104:107], v10 offset:36864
    v_mfma_f32_16x16x32_bf16 v[68:71], a[108:111], a[76:79], v[68:71]
    buffer_load_dwordx4 v24, s[16:19], s98 offen offset:2048 lds
    ds_read_b128 a[108:111], v11 offset:36864
    v_mfma_f32_16x16x32_bf16 v[92:95], a[112:115], v[72:75], v[92:95]
    v_exp_f32 v56, v56
    v_mfma_f32_16x16x32_bf16 v[112:115], a[116:119], v[72:75], v[112:115]
    v_exp_f32 v57, v57
    v_mfma_f32_16x16x32_bf16 v[132:135], a[120:123], v[72:75], v[132:135]
    v_exp_f32 v58, v58
    v_mfma_f32_16x16x32_bf16 v[152:155], a[124:127], v[72:75], v[152:155]
    buffer_load_dwordx4 v25, s[16:19], s98 offen offset:3072 lds
    v_cvt_pk_bf16_f32 v76, v56, v57
    v_mfma_f32_16x16x32_bf16 v[172:175], a[128:131], v[72:75], v[172:175]
    v_exp_f32 v59, v59
    v_mfma_f32_16x16x32_bf16 v[192:195], a[132:135], v[72:75], v[192:195]
    v_exp_f32 v60, v60
    v_mfma_f32_16x16x32_bf16 v[212:215], a[136:139], v[72:75], v[212:215]
    v_cvt_pk_bf16_f32 v77, v58, v59
    v_mfma_f32_16x16x32_bf16 v[232:235], a[140:143], v[72:75], v[232:235]
    v_exp_f32 v61, v61
    v_mfma_f32_16x16x32_bf16 a[152:155], a[164:167], v[72:75], a[152:155]
    v_exp_f32 v62, v62
    s_waitcnt lgkmcnt(0)
    v_mfma_f32_16x16x32_bf16 v[48:51], a[80:83], a[0:3], v[28:31]
    v_cvt_pk_bf16_f32 v78, v60, v61
    v_mfma_f32_16x16x32_bf16 v[48:51], a[84:87], a[4:7], v[48:51]
    v_exp_f32 v63, v63
    v_mfma_f32_16x16x32_bf16 v[48:51], a[88:91], a[8:11], v[48:51]
    v_cvt_pk_bf16_f32 v79, v62, v63
    v_mfma_f32_16x16x32_bf16 v[48:51], a[92:95], a[12:15], v[48:51]
    v_exp_f32 v64, v64
    v_mfma_f32_16x16x32_bf16 v[52:55], a[96:99], a[0:3], v[28:31]
    v_exp_f32 v65, v65
    v_mfma_f32_16x16x32_bf16 v[52:55], a[100:103], a[4:7], v[52:55]
    v_exp_f32 v66, v66
    v_mfma_f32_16x16x32_bf16 v[52:55], a[104:107], a[8:11], v[52:55]
    v_cvt_pk_bf16_f32 v80, v64, v65
    v_mfma_f32_16x16x32_bf16 v[52:55], a[108:111], a[12:15], v[52:55]
    v_exp_f32 v67, v67
    v_mfma_f32_16x16x32_bf16 v[96:99], a[112:115], v[76:79], v[96:99]
    s_bfe_u32 s25, s92, 0x40014
    s_lshl_b32 s25, s25, 13
    v_mfma_f32_16x16x32_bf16 v[116:119], a[116:119], v[76:79], v[116:119]
    s_add_u32 s98, s25, 4096
    s_add_u32 m0, s24, 32768
    v_mfma_f32_16x16x32_bf16 v[136:139], a[120:123], v[76:79], v[136:139]
    buffer_load_dwordx4 v20, s[12:15], s25 offen offset:0 lds
    v_mfma_f32_16x16x32_bf16 v[156:159], a[124:127], v[76:79], v[156:159]
    v_exp_f32 v68, v68
    v_mfma_f32_16x16x32_bf16 v[176:179], a[128:131], v[76:79], v[176:179]
    buffer_load_dwordx4 v21, s[12:15], s25 offen offset:1024 lds
    v_cvt_pk_bf16_f32 v81, v66, v67
    v_mfma_f32_16x16x32_bf16 v[196:199], a[132:135], v[76:79], v[196:199]
    v_exp_f32 v69, v69
    v_mfma_f32_16x16x32_bf16 v[216:219], a[136:139], v[76:79], v[216:219]
    v_exp_f32 v70, v70
    v_mfma_f32_16x16x32_bf16 v[236:239], a[140:143], v[76:79], v[236:239]
    v_cvt_pk_bf16_f32 v82, v68, v69
    v_mfma_f32_16x16x32_bf16 a[156:159], a[164:167], v[76:79], a[156:159]
    buffer_load_dwordx4 v22, s[12:15], s25 offen offset:2048 lds
    v_mfma_f32_16x16x32_bf16 v[56:59], a[80:83], a[16:19], v[32:35]
    v_exp_f32 v71, v71
    v_mfma_f32_16x16x32_bf16 v[56:59], a[84:87], a[20:23], v[56:59]
    v_cvt_pk_bf16_f32 v83, v70, v71
    v_mfma_f32_16x16x32_bf16 v[56:59], a[88:91], a[24:27], v[56:59]
    v_exp_f32 v48, v48
    v_mfma_f32_16x16x32_bf16 v[56:59], a[92:95], a[28:31], v[56:59]
    buffer_load_dwordx4 v23, s[12:15], s25 offen offset:3072 lds
    v_mfma_f32_16x16x32_bf16 v[60:63], a[96:99], a[16:19], v[32:35]
    v_exp_f32 v49, v49
    v_mfma_f32_16x16x32_bf16 v[60:63], a[100:103], a[20:23], v[60:63]
    v_exp_f32 v50, v50
    v_mfma_f32_16x16x32_bf16 v[60:63], a[104:107], a[24:27], v[60:63]
    v_cvt_pk_bf16_f32 v72, v48, v49
    v_mfma_f32_16x16x32_bf16 v[60:63], a[108:111], a[28:31], v[60:63]
    s_add_u32 m0, s24, 36864
    s_nop 0
    buffer_load_dwordx4 v20, s[12:15], s98 offen offset:0 lds
    v_mfma_f32_16x16x32_bf16 v[100:103], a[112:115], v[80:83], v[100:103]
    s_waitcnt vmcnt(21)
    ds_read_b64_tr_b16 a[112:113], v12 offset:32768
    ds_read_b64_tr_b16 a[114:115], v12 offset:36864
    v_mfma_f32_16x16x32_bf16 v[120:123], a[116:119], v[80:83], v[120:123]
    ds_read_b64_tr_b16 a[116:117], v13 offset:32768
    ds_read_b64_tr_b16 a[118:119], v13 offset:36864
    v_mfma_f32_16x16x32_bf16 v[140:143], a[120:123], v[80:83], v[140:143]
    v_exp_f32 v51, v51
    v_mfma_f32_16x16x32_bf16 v[160:163], a[124:127], v[80:83], v[160:163]
    buffer_load_dwordx4 v21, s[12:15], s98 offen offset:1024 lds
    ds_read_b64_tr_b16 a[120:121], v14 offset:32768
    v_mfma_f32_16x16x32_bf16 v[180:183], a[128:131], v[80:83], v[180:183]
    v_exp_f32 v52, v52
    v_mfma_f32_16x16x32_bf16 v[200:203], a[132:135], v[80:83], v[200:203]
    v_cvt_pk_bf16_f32 v73, v50, v51
    ds_read_b64_tr_b16 a[122:123], v14 offset:36864
    v_mfma_f32_16x16x32_bf16 v[220:223], a[136:139], v[80:83], v[220:223]
    v_exp_f32 v53, v53
    v_mfma_f32_16x16x32_bf16 v[240:243], a[140:143], v[80:83], v[240:243]
    buffer_load_dwordx4 v22, s[12:15], s98 offen offset:2048 lds
    ds_read_b64_tr_b16 a[124:125], v15 offset:32768
    v_mfma_f32_16x16x32_bf16 a[160:163], a[164:167], v[80:83], a[160:163]
    v_exp_f32 v54, v54
    v_mfma_f32_16x16x32_bf16 v[64:67], a[80:83], a[32:35], v[36:39]
    v_cvt_pk_bf16_f32 v74, v52, v53
    ds_read_b64_tr_b16 a[126:127], v15 offset:36864
    v_mfma_f32_16x16x32_bf16 v[64:67], a[84:87], a[36:39], v[64:67]
    v_exp_f32 v55, v55
    v_mfma_f32_16x16x32_bf16 v[64:67], a[88:91], a[40:43], v[64:67]
    v_cvt_pk_bf16_f32 v75, v54, v55
    buffer_load_dwordx4 v23, s[12:15], s98 offen offset:3072 lds
    v_mfma_f32_16x16x32_bf16 v[64:67], a[92:95], a[44:47], v[64:67]
    ds_read_b64_tr_b16 a[128:129], v16 offset:32768
    ds_read_b64_tr_b16 a[130:131], v16 offset:36864
    v_mfma_f32_16x16x32_bf16 v[68:71], a[96:99], a[32:35], v[36:39]
    ds_read_b64_tr_b16 a[132:133], v17 offset:32768
    ds_read_b64_tr_b16 a[134:135], v17 offset:36864
    v_mfma_f32_16x16x32_bf16 v[68:71], a[100:103], a[36:39], v[68:71]
    ds_read_b64_tr_b16 a[136:137], v18 offset:32768
    ds_read_b64_tr_b16 a[138:139], v18 offset:36864
    v_mfma_f32_16x16x32_bf16 v[68:71], a[104:107], a[40:43], v[68:71]
    ds_read_b64_tr_b16 a[140:141], v19 offset:32768
    ds_read_b64_tr_b16 a[142:143], v19 offset:36864
    v_mfma_f32_16x16x32_bf16 v[68:71], a[108:111], a[44:47], v[68:71]
    v_exp_f32 v56, v56
    s_waitcnt lgkmcnt(8)
    v_mfma_f32_16x16x32_bf16 v[84:87], a[112:115], v[72:75], v[84:87]
    v_exp_f32 v57, v57
    v_mfma_f32_16x16x32_bf16 v[104:107], a[116:119], v[72:75], v[104:107]
    v_exp_f32 v58, v58
    v_mfma_f32_16x16x32_bf16 v[124:127], a[120:123], v[72:75], v[124:127]
    v_cvt_pk_bf16_f32 v76, v56, v57
    v_mfma_f32_16x16x32_bf16 v[144:147], a[124:127], v[72:75], v[144:147]
    v_exp_f32 v59, v59
    s_waitcnt lgkmcnt(2)
    v_mfma_f32_16x16x32_bf16 v[164:167], a[128:131], v[72:75], v[164:167]
    v_exp_f32 v60, v60
    v_mfma_f32_16x16x32_bf16 v[184:187], a[132:135], v[72:75], v[184:187]
    v_cvt_pk_bf16_f32 v77, v58, v59
    v_mfma_f32_16x16x32_bf16 v[204:207], a[136:139], v[72:75], v[204:207]
    v_exp_f32 v61, v61
    s_waitcnt lgkmcnt(0)
    v_mfma_f32_16x16x32_bf16 v[224:227], a[140:143], v[72:75], v[224:227]
    v_exp_f32 v62, v62
    v_mfma_f32_16x16x32_bf16 a[144:147], a[164:167], v[72:75], a[144:147]
    v_cvt_pk_bf16_f32 v78, v60, v61
    v_mfma_f32_16x16x32_bf16 v[48:51], a[80:83], a[48:51], v[40:43]
    s_add_u32 m0, s24, 98304
    s_nop 0
    buffer_load_dwordx4 v24, s[16:19], s25 offen offset:0 lds
    v_mfma_f32_16x16x32_bf16 v[48:51], a[84:87], a[52:55], v[48:51]
    v_exp_f32 v63, v63
    v_mfma_f32_16x16x32_bf16 v[48:51], a[88:91], a[56:59], v[48:51]
    v_cvt_pk_bf16_f32 v79, v62, v63
    v_mfma_f32_16x16x32_bf16 v[48:51], a[92:95], a[60:63], v[48:51]
    v_exp_f32 v64, v64
    v_mfma_f32_16x16x32_bf16 v[52:55], a[96:99], a[48:51], v[40:43]
    buffer_load_dwordx4 v25, s[16:19], s25 offen offset:1024 lds
    v_mfma_f32_16x16x32_bf16 v[52:55], a[100:103], a[52:55], v[52:55]
    v_exp_f32 v65, v65
    v_mfma_f32_16x16x32_bf16 v[52:55], a[104:107], a[56:59], v[52:55]
    v_exp_f32 v66, v66
    v_mfma_f32_16x16x32_bf16 v[52:55], a[108:111], a[60:63], v[52:55]
    v_cvt_pk_bf16_f32 v80, v64, v65
    v_mfma_f32_16x16x32_bf16 v[88:91], a[112:115], v[76:79], v[88:91]
    buffer_load_dwordx4 v24, s[16:19], s25 offen offset:2048 lds
    v_mfma_f32_16x16x32_bf16 v[108:111], a[116:119], v[76:79], v[108:111]
    v_exp_f32 v67, v67
    v_mfma_f32_16x16x32_bf16 v[128:131], a[120:123], v[76:79], v[128:131]
    v_exp_f32 v68, v68
    v_mfma_f32_16x16x32_bf16 v[148:151], a[124:127], v[76:79], v[148:151]
    v_cvt_pk_bf16_f32 v81, v66, v67
    v_mfma_f32_16x16x32_bf16 v[168:171], a[128:131], v[76:79], v[168:171]
    buffer_load_dwordx4 v25, s[16:19], s25 offen offset:3072 lds
    v_mfma_f32_16x16x32_bf16 v[188:191], a[132:135], v[76:79], v[188:191]
    v_exp_f32 v69, v69
    v_mfma_f32_16x16x32_bf16 v[208:211], a[136:139], v[76:79], v[208:211]
    v_exp_f32 v70, v70
    v_mfma_f32_16x16x32_bf16 v[228:231], a[140:143], v[76:79], v[228:231]
    v_cvt_pk_bf16_f32 v82, v68, v69
    v_mfma_f32_16x16x32_bf16 a[148:151], a[164:167], v[76:79], a[148:151]
    s_add_u32 m0, s24, 102400
    s_nop 0
    buffer_load_dwordx4 v24, s[16:19], s98 offen offset:0 lds
    v_mfma_f32_16x16x32_bf16 v[56:59], a[80:83], a[64:67], v[44:47]
    v_exp_f32 v71, v71
    v_mfma_f32_16x16x32_bf16 v[56:59], a[84:87], a[68:71], v[56:59]
    v_cvt_pk_bf16_f32 v83, v70, v71
    s_waitcnt vmcnt(21)
    ds_read_b128 a[80:83], v8 offset:0
    v_mfma_f32_16x16x32_bf16 v[56:59], a[88:91], a[72:75], v[56:59]
    ds_read_b128 a[84:87], v9 offset:0
    ds_read_b128 a[88:91], v10 offset:0
    v_mfma_f32_16x16x32_bf16 v[56:59], a[92:95], a[76:79], v[56:59]
    buffer_load_dwordx4 v25, s[16:19], s98 offen offset:1024 lds
    ds_read_b128 a[92:95], v11 offset:0
    v_mfma_f32_16x16x32_bf16 v[60:63], a[96:99], a[64:67], v[44:47]
    ds_read_b128 a[96:99], v8 offset:4096
    v_mfma_f32_16x16x32_bf16 v[60:63], a[100:103], a[68:71], v[60:63]
    ds_read_b128 a[100:103], v9 offset:4096
    v_mfma_f32_16x16x32_bf16 v[60:63], a[104:107], a[72:75], v[60:63]
    ds_read_b128 a[104:107], v10 offset:4096
    v_mfma_f32_16x16x32_bf16 v[60:63], a[108:111], a[76:79], v[60:63]
    buffer_load_dwordx4 v24, s[16:19], s98 offen offset:2048 lds
    ds_read_b128 a[108:111], v11 offset:4096
    v_mfma_f32_16x16x32_bf16 v[92:95], a[112:115], v[80:83], v[92:95]
    v_exp_f32 v48, v48
    v_mfma_f32_16x16x32_bf16 v[112:115], a[116:119], v[80:83], v[112:115]
    v_exp_f32 v49, v49
    v_mfma_f32_16x16x32_bf16 v[132:135], a[120:123], v[80:83], v[132:135]
    v_exp_f32 v50, v50
    v_mfma_f32_16x16x32_bf16 v[152:155], a[124:127], v[80:83], v[152:155]
    buffer_load_dwordx4 v25, s[16:19], s98 offen offset:3072 lds
    v_cvt_pk_bf16_f32 v72, v48, v49
    v_mfma_f32_16x16x32_bf16 v[172:175], a[128:131], v[80:83], v[172:175]
    v_exp_f32 v51, v51
    v_mfma_f32_16x16x32_bf16 v[192:195], a[132:135], v[80:83], v[192:195]
    v_exp_f32 v52, v52
    v_mfma_f32_16x16x32_bf16 v[212:215], a[136:139], v[80:83], v[212:215]
    v_cvt_pk_bf16_f32 v73, v50, v51
    v_mfma_f32_16x16x32_bf16 v[232:235], a[140:143], v[80:83], v[232:235]
    v_exp_f32 v53, v53
    v_mfma_f32_16x16x32_bf16 a[152:155], a[164:167], v[80:83], a[152:155]
    v_exp_f32 v54, v54
    s_waitcnt lgkmcnt(0)
    v_mfma_f32_16x16x32_bf16 v[64:67], a[80:83], a[0:3], v[28:31]
    v_cvt_pk_bf16_f32 v74, v52, v53
    v_mfma_f32_16x16x32_bf16 v[64:67], a[84:87], a[4:7], v[64:67]
    v_exp_f32 v55, v55
    v_mfma_f32_16x16x32_bf16 v[64:67], a[88:91], a[8:11], v[64:67]
    v_cvt_pk_bf16_f32 v75, v54, v55
    v_mfma_f32_16x16x32_bf16 v[64:67], a[92:95], a[12:15], v[64:67]
    v_exp_f32 v56, v56
    v_mfma_f32_16x16x32_bf16 v[68:71], a[96:99], a[0:3], v[28:31]
    v_exp_f32 v57, v57
    v_mfma_f32_16x16x32_bf16 v[68:71], a[100:103], a[4:7], v[68:71]
    v_exp_f32 v58, v58
    v_mfma_f32_16x16x32_bf16 v[68:71], a[104:107], a[8:11], v[68:71]
    v_cvt_pk_bf16_f32 v76, v56, v57
    v_mfma_f32_16x16x32_bf16 v[68:71], a[108:111], a[12:15], v[68:71]
    v_exp_f32 v59, v59
    v_mfma_f32_16x16x32_bf16 v[96:99], a[112:115], v[72:75], v[96:99]
    s_bfe_u32 s25, s92, 0x40018
    s_lshl_b32 s25, s25, 13
    v_mfma_f32_16x16x32_bf16 v[116:119], a[116:119], v[72:75], v[116:119]
    s_add_u32 s98, s25, 4096
    s_add_u32 m0, s24, 0
    v_mfma_f32_16x16x32_bf16 v[136:139], a[120:123], v[72:75], v[136:139]
    buffer_load_dwordx4 v20, s[12:15], s25 offen offset:0 lds
    v_mfma_f32_16x16x32_bf16 v[156:159], a[124:127], v[72:75], v[156:159]
    v_exp_f32 v60, v60
    v_mfma_f32_16x16x32_bf16 v[176:179], a[128:131], v[72:75], v[176:179]
    buffer_load_dwordx4 v21, s[12:15], s25 offen offset:1024 lds
    v_cvt_pk_bf16_f32 v77, v58, v59
    v_mfma_f32_16x16x32_bf16 v[196:199], a[132:135], v[72:75], v[196:199]
    v_exp_f32 v61, v61
    v_mfma_f32_16x16x32_bf16 v[216:219], a[136:139], v[72:75], v[216:219]
    v_exp_f32 v62, v62
    v_mfma_f32_16x16x32_bf16 v[236:239], a[140:143], v[72:75], v[236:239]
    v_cvt_pk_bf16_f32 v78, v60, v61
    v_mfma_f32_16x16x32_bf16 a[156:159], a[164:167], v[72:75], a[156:159]
    buffer_load_dwordx4 v22, s[12:15], s25 offen offset:2048 lds
    v_mfma_f32_16x16x32_bf16 v[48:51], a[80:83], a[16:19], v[32:35]
    v_exp_f32 v63, v63
    v_mfma_f32_16x16x32_bf16 v[48:51], a[84:87], a[20:23], v[48:51]
    v_cvt_pk_bf16_f32 v79, v62, v63
    v_mfma_f32_16x16x32_bf16 v[48:51], a[88:91], a[24:27], v[48:51]
    v_exp_f32 v64, v64
    v_mfma_f32_16x16x32_bf16 v[48:51], a[92:95], a[28:31], v[48:51]
    buffer_load_dwordx4 v23, s[12:15], s25 offen offset:3072 lds
    v_mfma_f32_16x16x32_bf16 v[52:55], a[96:99], a[16:19], v[32:35]
    v_exp_f32 v65, v65
    v_mfma_f32_16x16x32_bf16 v[52:55], a[100:103], a[20:23], v[52:55]
    v_exp_f32 v66, v66
    v_mfma_f32_16x16x32_bf16 v[52:55], a[104:107], a[24:27], v[52:55]
    v_cvt_pk_bf16_f32 v80, v64, v65
    v_mfma_f32_16x16x32_bf16 v[52:55], a[108:111], a[28:31], v[52:55]
    s_add_u32 m0, s24, 4096
    s_nop 0
    buffer_load_dwordx4 v20, s[12:15], s98 offen offset:0 lds
    v_mfma_f32_16x16x32_bf16 v[100:103], a[112:115], v[76:79], v[100:103]
    s_waitcnt vmcnt(21)
    ds_read_b64_tr_b16 a[112:113], v12 offset:0
    ds_read_b64_tr_b16 a[114:115], v12 offset:4096
    v_mfma_f32_16x16x32_bf16 v[120:123], a[116:119], v[76:79], v[120:123]
    ds_read_b64_tr_b16 a[116:117], v13 offset:0
    ds_read_b64_tr_b16 a[118:119], v13 offset:4096
    v_mfma_f32_16x16x32_bf16 v[140:143], a[120:123], v[76:79], v[140:143]
    v_exp_f32 v67, v67
    v_mfma_f32_16x16x32_bf16 v[160:163], a[124:127], v[76:79], v[160:163]
    buffer_load_dwordx4 v21, s[12:15], s98 offen offset:1024 lds
    ds_read_b64_tr_b16 a[120:121], v14 offset:0
    v_mfma_f32_16x16x32_bf16 v[180:183], a[128:131], v[76:79], v[180:183]
    v_exp_f32 v68, v68
    v_mfma_f32_16x16x32_bf16 v[200:203], a[132:135], v[76:79], v[200:203]
    v_cvt_pk_bf16_f32 v81, v66, v67
    ds_read_b64_tr_b16 a[122:123], v14 offset:4096
    v_mfma_f32_16x16x32_bf16 v[220:223], a[136:139], v[76:79], v[220:223]
    v_exp_f32 v69, v69
    v_mfma_f32_16x16x32_bf16 v[240:243], a[140:143], v[76:79], v[240:243]
    buffer_load_dwordx4 v22, s[12:15], s98 offen offset:2048 lds
    ds_read_b64_tr_b16 a[124:125], v15 offset:0
    v_mfma_f32_16x16x32_bf16 a[160:163], a[164:167], v[76:79], a[160:163]
    v_exp_f32 v70, v70
    v_mfma_f32_16x16x32_bf16 v[56:59], a[80:83], a[32:35], v[36:39]
    v_cvt_pk_bf16_f32 v82, v68, v69
    ds_read_b64_tr_b16 a[126:127], v15 offset:4096
    v_mfma_f32_16x16x32_bf16 v[56:59], a[84:87], a[36:39], v[56:59]
    v_exp_f32 v71, v71
    v_mfma_f32_16x16x32_bf16 v[56:59], a[88:91], a[40:43], v[56:59]
    v_cvt_pk_bf16_f32 v83, v70, v71
    buffer_load_dwordx4 v23, s[12:15], s98 offen offset:3072 lds
    v_mfma_f32_16x16x32_bf16 v[56:59], a[92:95], a[44:47], v[56:59]
    ds_read_b64_tr_b16 a[128:129], v16 offset:0
    ds_read_b64_tr_b16 a[130:131], v16 offset:4096
    v_mfma_f32_16x16x32_bf16 v[60:63], a[96:99], a[32:35], v[36:39]
    ds_read_b64_tr_b16 a[132:133], v17 offset:0
    ds_read_b64_tr_b16 a[134:135], v17 offset:4096
    v_mfma_f32_16x16x32_bf16 v[60:63], a[100:103], a[36:39], v[60:63]
    ds_read_b64_tr_b16 a[136:137], v18 offset:0
    ds_read_b64_tr_b16 a[138:139], v18 offset:4096
    v_mfma_f32_16x16x32_bf16 v[60:63], a[104:107], a[40:43], v[60:63]
    ds_read_b64_tr_b16 a[140:141], v19 offset:0
    ds_read_b64_tr_b16 a[142:143], v19 offset:4096
    v_mfma_f32_16x16x32_bf16 v[60:63], a[108:111], a[44:47], v[60:63]
    v_exp_f32 v48, v48
    s_waitcnt lgkmcnt(8)
    v_mfma_f32_16x16x32_bf16 v[84:87], a[112:115], v[80:83], v[84:87]
    v_exp_f32 v49, v49
    v_mfma_f32_16x16x32_bf16 v[104:107], a[116:119], v[80:83], v[104:107]
    v_exp_f32 v50, v50
    v_mfma_f32_16x16x32_bf16 v[124:127], a[120:123], v[80:83], v[124:127]
    v_cvt_pk_bf16_f32 v72, v48, v49
    v_mfma_f32_16x16x32_bf16 v[144:147], a[124:127], v[80:83], v[144:147]
    v_exp_f32 v51, v51
    s_waitcnt lgkmcnt(2)
    v_mfma_f32_16x16x32_bf16 v[164:167], a[128:131], v[80:83], v[164:167]
    v_exp_f32 v52, v52
    v_mfma_f32_16x16x32_bf16 v[184:187], a[132:135], v[80:83], v[184:187]
    v_cvt_pk_bf16_f32 v73, v50, v51
    v_mfma_f32_16x16x32_bf16 v[204:207], a[136:139], v[80:83], v[204:207]
    v_exp_f32 v53, v53
    s_waitcnt lgkmcnt(0)
    v_mfma_f32_16x16x32_bf16 v[224:227], a[140:143], v[80:83], v[224:227]
    v_exp_f32 v54, v54
    v_mfma_f32_16x16x32_bf16 a[144:147], a[164:167], v[80:83], a[144:147]
    v_cvt_pk_bf16_f32 v74, v52, v53
    v_mfma_f32_16x16x32_bf16 v[64:67], a[80:83], a[48:51], v[40:43]
    s_add_u32 m0, s24, 65536
    s_nop 0
    buffer_load_dwordx4 v24, s[16:19], s25 offen offset:0 lds
    v_mfma_f32_16x16x32_bf16 v[64:67], a[84:87], a[52:55], v[64:67]
    v_exp_f32 v55, v55
    v_mfma_f32_16x16x32_bf16 v[64:67], a[88:91], a[56:59], v[64:67]
    v_cvt_pk_bf16_f32 v75, v54, v55
    v_mfma_f32_16x16x32_bf16 v[64:67], a[92:95], a[60:63], v[64:67]
    v_exp_f32 v56, v56
    v_mfma_f32_16x16x32_bf16 v[68:71], a[96:99], a[48:51], v[40:43]
    buffer_load_dwordx4 v25, s[16:19], s25 offen offset:1024 lds
    v_mfma_f32_16x16x32_bf16 v[68:71], a[100:103], a[52:55], v[68:71]
    v_exp_f32 v57, v57
    v_mfma_f32_16x16x32_bf16 v[68:71], a[104:107], a[56:59], v[68:71]
    v_exp_f32 v58, v58
    v_mfma_f32_16x16x32_bf16 v[68:71], a[108:111], a[60:63], v[68:71]
    v_cvt_pk_bf16_f32 v76, v56, v57
    v_mfma_f32_16x16x32_bf16 v[88:91], a[112:115], v[72:75], v[88:91]
    buffer_load_dwordx4 v24, s[16:19], s25 offen offset:2048 lds
    v_mfma_f32_16x16x32_bf16 v[108:111], a[116:119], v[72:75], v[108:111]
    v_exp_f32 v59, v59
    v_mfma_f32_16x16x32_bf16 v[128:131], a[120:123], v[72:75], v[128:131]
    v_exp_f32 v60, v60
    v_mfma_f32_16x16x32_bf16 v[148:151], a[124:127], v[72:75], v[148:151]
    v_cvt_pk_bf16_f32 v77, v58, v59
    v_mfma_f32_16x16x32_bf16 v[168:171], a[128:131], v[72:75], v[168:171]
    buffer_load_dwordx4 v25, s[16:19], s25 offen offset:3072 lds
    v_mfma_f32_16x16x32_bf16 v[188:191], a[132:135], v[72:75], v[188:191]
    v_exp_f32 v61, v61
    v_mfma_f32_16x16x32_bf16 v[208:211], a[136:139], v[72:75], v[208:211]
    v_exp_f32 v62, v62
    v_mfma_f32_16x16x32_bf16 v[228:231], a[140:143], v[72:75], v[228:231]
    v_cvt_pk_bf16_f32 v78, v60, v61
    v_mfma_f32_16x16x32_bf16 a[148:151], a[164:167], v[72:75], a[148:151]
    s_add_u32 m0, s24, 69632
    s_nop 0
    buffer_load_dwordx4 v24, s[16:19], s98 offen offset:0 lds
    v_mfma_f32_16x16x32_bf16 v[48:51], a[80:83], a[64:67], v[44:47]
    v_exp_f32 v63, v63
    v_mfma_f32_16x16x32_bf16 v[48:51], a[84:87], a[68:71], v[48:51]
    v_cvt_pk_bf16_f32 v79, v62, v63
    s_waitcnt vmcnt(21)
    ds_read_b128 a[80:83], v8 offset:32768
    v_mfma_f32_16x16x32_bf16 v[48:51], a[88:91], a[72:75], v[48:51]
    ds_read_b128 a[84:87], v9 offset:32768
    ds_read_b128 a[88:91], v10 offset:32768
    v_mfma_f32_16x16x32_bf16 v[48:51], a[92:95], a[76:79], v[48:51]
    buffer_load_dwordx4 v25, s[16:19], s98 offen offset:1024 lds
    ds_read_b128 a[92:95], v11 offset:32768
    v_mfma_f32_16x16x32_bf16 v[52:55], a[96:99], a[64:67], v[44:47]
    ds_read_b128 a[96:99], v8 offset:36864
    v_mfma_f32_16x16x32_bf16 v[52:55], a[100:103], a[68:71], v[52:55]
    ds_read_b128 a[100:103], v9 offset:36864
    v_mfma_f32_16x16x32_bf16 v[52:55], a[104:107], a[72:75], v[52:55]
    ds_read_b128 a[104:107], v10 offset:36864
    v_mfma_f32_16x16x32_bf16 v[52:55], a[108:111], a[76:79], v[52:55]
    buffer_load_dwordx4 v24, s[16:19], s98 offen offset:2048 lds
    ds_read_b128 a[108:111], v11 offset:36864
    v_mfma_f32_16x16x32_bf16 v[92:95], a[112:115], v[76:79], v[92:95]
    v_exp_f32 v64, v64
    v_mfma_f32_16x16x32_bf16 v[112:115], a[116:119], v[76:79], v[112:115]
    v_exp_f32 v65, v65
    v_mfma_f32_16x16x32_bf16 v[132:135], a[120:123], v[76:79], v[132:135]
    v_exp_f32 v66, v66
    v_mfma_f32_16x16x32_bf16 v[152:155], a[124:127], v[76:79], v[152:155]
    buffer_load_dwordx4 v25, s[16:19], s98 offen offset:3072 lds
    v_cvt_pk_bf16_f32 v80, v64, v65
    v_mfma_f32_16x16x32_bf16 v[172:175], a[128:131], v[76:79], v[172:175]
    v_exp_f32 v67, v67
    v_mfma_f32_16x16x32_bf16 v[192:195], a[132:135], v[76:79], v[192:195]
    v_exp_f32 v68, v68
    v_mfma_f32_16x16x32_bf16 v[212:215], a[136:139], v[76:79], v[212:215]
    v_cvt_pk_bf16_f32 v81, v66, v67
    v_mfma_f32_16x16x32_bf16 v[232:235], a[140:143], v[76:79], v[232:235]
    v_exp_f32 v69, v69
    v_mfma_f32_16x16x32_bf16 a[152:155], a[164:167], v[76:79], a[152:155]
    v_exp_f32 v70, v70
    s_waitcnt lgkmcnt(0)
    v_mfma_f32_16x16x32_bf16 v[56:59], a[80:83], a[0:3], v[28:31]
    v_cvt_pk_bf16_f32 v82, v68, v69
    v_mfma_f32_16x16x32_bf16 v[56:59], a[84:87], a[4:7], v[56:59]
    v_exp_f32 v71, v71
    v_mfma_f32_16x16x32_bf16 v[56:59], a[88:91], a[8:11], v[56:59]
    v_cvt_pk_bf16_f32 v83, v70, v71
    v_mfma_f32_16x16x32_bf16 v[56:59], a[92:95], a[12:15], v[56:59]
    v_exp_f32 v48, v48
    v_mfma_f32_16x16x32_bf16 v[60:63], a[96:99], a[0:3], v[28:31]
    v_exp_f32 v49, v49
    v_mfma_f32_16x16x32_bf16 v[60:63], a[100:103], a[4:7], v[60:63]
    v_exp_f32 v50, v50
    v_mfma_f32_16x16x32_bf16 v[60:63], a[104:107], a[8:11], v[60:63]
    v_cvt_pk_bf16_f32 v72, v48, v49
    v_mfma_f32_16x16x32_bf16 v[60:63], a[108:111], a[12:15], v[60:63]
    v_exp_f32 v51, v51
    v_mfma_f32_16x16x32_bf16 v[96:99], a[112:115], v[80:83], v[96:99]
    s_bfe_u32 s25, s92, 0x4001c
    s_lshl_b32 s25, s25, 13
    v_mfma_f32_16x16x32_bf16 v[116:119], a[116:119], v[80:83], v[116:119]
    s_add_u32 s98, s25, 4096
    s_add_u32 m0, s24, 32768
    v_mfma_f32_16x16x32_bf16 v[136:139], a[120:123], v[80:83], v[136:139]
    buffer_load_dwordx4 v20, s[12:15], s25 offen offset:0 lds
    v_mfma_f32_16x16x32_bf16 v[156:159], a[124:127], v[80:83], v[156:159]
    v_exp_f32 v52, v52
    v_mfma_f32_16x16x32_bf16 v[176:179], a[128:131], v[80:83], v[176:179]
    buffer_load_dwordx4 v21, s[12:15], s25 offen offset:1024 lds
    v_cvt_pk_bf16_f32 v73, v50, v51
    v_mfma_f32_16x16x32_bf16 v[196:199], a[132:135], v[80:83], v[196:199]
    v_exp_f32 v53, v53
    v_mfma_f32_16x16x32_bf16 v[216:219], a[136:139], v[80:83], v[216:219]
    v_exp_f32 v54, v54
    v_mfma_f32_16x16x32_bf16 v[236:239], a[140:143], v[80:83], v[236:239]
    v_cvt_pk_bf16_f32 v74, v52, v53
    v_mfma_f32_16x16x32_bf16 a[156:159], a[164:167], v[80:83], a[156:159]
    buffer_load_dwordx4 v22, s[12:15], s25 offen offset:2048 lds
    v_mfma_f32_16x16x32_bf16 v[64:67], a[80:83], a[16:19], v[32:35]
    v_exp_f32 v55, v55
    v_mfma_f32_16x16x32_bf16 v[64:67], a[84:87], a[20:23], v[64:67]
    v_cvt_pk_bf16_f32 v75, v54, v55
    v_mfma_f32_16x16x32_bf16 v[64:67], a[88:91], a[24:27], v[64:67]
    v_exp_f32 v56, v56
    v_mfma_f32_16x16x32_bf16 v[64:67], a[92:95], a[28:31], v[64:67]
    buffer_load_dwordx4 v23, s[12:15], s25 offen offset:3072 lds
    v_mfma_f32_16x16x32_bf16 v[68:71], a[96:99], a[16:19], v[32:35]
    v_exp_f32 v57, v57
    v_mfma_f32_16x16x32_bf16 v[68:71], a[100:103], a[20:23], v[68:71]
    v_exp_f32 v58, v58
    v_mfma_f32_16x16x32_bf16 v[68:71], a[104:107], a[24:27], v[68:71]
    v_cvt_pk_bf16_f32 v76, v56, v57
    v_mfma_f32_16x16x32_bf16 v[68:71], a[108:111], a[28:31], v[68:71]
    s_add_u32 m0, s24, 36864
    s_nop 0
    buffer_load_dwordx4 v20, s[12:15], s98 offen offset:0 lds
    v_mfma_f32_16x16x32_bf16 v[100:103], a[112:115], v[72:75], v[100:103]
    s_waitcnt vmcnt(21)
    ds_read_b64_tr_b16 a[112:113], v12 offset:32768
    ds_read_b64_tr_b16 a[114:115], v12 offset:36864
    v_mfma_f32_16x16x32_bf16 v[120:123], a[116:119], v[72:75], v[120:123]
    ds_read_b64_tr_b16 a[116:117], v13 offset:32768
    ds_read_b64_tr_b16 a[118:119], v13 offset:36864
    v_mfma_f32_16x16x32_bf16 v[140:143], a[120:123], v[72:75], v[140:143]
    v_exp_f32 v59, v59
    v_mfma_f32_16x16x32_bf16 v[160:163], a[124:127], v[72:75], v[160:163]
    buffer_load_dwordx4 v21, s[12:15], s98 offen offset:1024 lds
    ds_read_b64_tr_b16 a[120:121], v14 offset:32768
    v_mfma_f32_16x16x32_bf16 v[180:183], a[128:131], v[72:75], v[180:183]
    v_exp_f32 v60, v60
    v_mfma_f32_16x16x32_bf16 v[200:203], a[132:135], v[72:75], v[200:203]
    v_cvt_pk_bf16_f32 v77, v58, v59
    ds_read_b64_tr_b16 a[122:123], v14 offset:36864
    v_mfma_f32_16x16x32_bf16 v[220:223], a[136:139], v[72:75], v[220:223]
    v_exp_f32 v61, v61
    v_mfma_f32_16x16x32_bf16 v[240:243], a[140:143], v[72:75], v[240:243]
    buffer_load_dwordx4 v22, s[12:15], s98 offen offset:2048 lds
    ds_read_b64_tr_b16 a[124:125], v15 offset:32768
    v_mfma_f32_16x16x32_bf16 a[160:163], a[164:167], v[72:75], a[160:163]
    v_exp_f32 v62, v62
    v_mfma_f32_16x16x32_bf16 v[48:51], a[80:83], a[32:35], v[36:39]
    v_cvt_pk_bf16_f32 v78, v60, v61
    ds_read_b64_tr_b16 a[126:127], v15 offset:36864
    v_mfma_f32_16x16x32_bf16 v[48:51], a[84:87], a[36:39], v[48:51]
    v_exp_f32 v63, v63
    v_mfma_f32_16x16x32_bf16 v[48:51], a[88:91], a[40:43], v[48:51]
    v_cvt_pk_bf16_f32 v79, v62, v63
    buffer_load_dwordx4 v23, s[12:15], s98 offen offset:3072 lds
    v_mfma_f32_16x16x32_bf16 v[48:51], a[92:95], a[44:47], v[48:51]
    ds_read_b64_tr_b16 a[128:129], v16 offset:32768
    ds_read_b64_tr_b16 a[130:131], v16 offset:36864
    v_mfma_f32_16x16x32_bf16 v[52:55], a[96:99], a[32:35], v[36:39]
    ds_read_b64_tr_b16 a[132:133], v17 offset:32768
    ds_read_b64_tr_b16 a[134:135], v17 offset:36864
    v_mfma_f32_16x16x32_bf16 v[52:55], a[100:103], a[36:39], v[52:55]
    ds_read_b64_tr_b16 a[136:137], v18 offset:32768
    ds_read_b64_tr_b16 a[138:139], v18 offset:36864
    v_mfma_f32_16x16x32_bf16 v[52:55], a[104:107], a[40:43], v[52:55]
    ds_read_b64_tr_b16 a[140:141], v19 offset:32768
    ds_read_b64_tr_b16 a[142:143], v19 offset:36864
    v_mfma_f32_16x16x32_bf16 v[52:55], a[108:111], a[44:47], v[52:55]
    v_exp_f32 v64, v64
    s_waitcnt lgkmcnt(8)
    v_mfma_f32_16x16x32_bf16 v[84:87], a[112:115], v[76:79], v[84:87]
    v_exp_f32 v65, v65
    v_mfma_f32_16x16x32_bf16 v[104:107], a[116:119], v[76:79], v[104:107]
    v_exp_f32 v66, v66
    v_mfma_f32_16x16x32_bf16 v[124:127], a[120:123], v[76:79], v[124:127]
    v_cvt_pk_bf16_f32 v80, v64, v65
    v_mfma_f32_16x16x32_bf16 v[144:147], a[124:127], v[76:79], v[144:147]
    v_exp_f32 v67, v67
    s_waitcnt lgkmcnt(2)
    v_mfma_f32_16x16x32_bf16 v[164:167], a[128:131], v[76:79], v[164:167]
    v_exp_f32 v68, v68
    v_mfma_f32_16x16x32_bf16 v[184:187], a[132:135], v[76:79], v[184:187]
    v_cvt_pk_bf16_f32 v81, v66, v67
    v_mfma_f32_16x16x32_bf16 v[204:207], a[136:139], v[76:79], v[204:207]
    v_exp_f32 v69, v69
    s_waitcnt lgkmcnt(0)
    v_mfma_f32_16x16x32_bf16 v[224:227], a[140:143], v[76:79], v[224:227]
    v_exp_f32 v70, v70
    v_mfma_f32_16x16x32_bf16 a[144:147], a[164:167], v[76:79], a[144:147]
    v_cvt_pk_bf16_f32 v82, v68, v69
    v_mfma_f32_16x16x32_bf16 v[56:59], a[80:83], a[48:51], v[40:43]
    s_add_u32 m0, s24, 98304
    s_nop 0
    buffer_load_dwordx4 v24, s[16:19], s25 offen offset:0 lds
    v_mfma_f32_16x16x32_bf16 v[56:59], a[84:87], a[52:55], v[56:59]
    v_exp_f32 v71, v71
    v_mfma_f32_16x16x32_bf16 v[56:59], a[88:91], a[56:59], v[56:59]
    v_cvt_pk_bf16_f32 v83, v70, v71
    v_mfma_f32_16x16x32_bf16 v[56:59], a[92:95], a[60:63], v[56:59]
    v_exp_f32 v48, v48
    v_mfma_f32_16x16x32_bf16 v[60:63], a[96:99], a[48:51], v[40:43]
    buffer_load_dwordx4 v25, s[16:19], s25 offen offset:1024 lds
    v_mfma_f32_16x16x32_bf16 v[60:63], a[100:103], a[52:55], v[60:63]
    v_exp_f32 v49, v49
    v_mfma_f32_16x16x32_bf16 v[60:63], a[104:107], a[56:59], v[60:63]
    v_exp_f32 v50, v50
    v_mfma_f32_16x16x32_bf16 v[60:63], a[108:111], a[60:63], v[60:63]
    v_cvt_pk_bf16_f32 v72, v48, v49
    v_mfma_f32_16x16x32_bf16 v[88:91], a[112:115], v[80:83], v[88:91]
    buffer_load_dwordx4 v24, s[16:19], s25 offen offset:2048 lds
    v_mfma_f32_16x16x32_bf16 v[108:111], a[116:119], v[80:83], v[108:111]
    v_exp_f32 v51, v51
    v_mfma_f32_16x16x32_bf16 v[128:131], a[120:123], v[80:83], v[128:131]
    v_exp_f32 v52, v52
    v_mfma_f32_16x16x32_bf16 v[148:151], a[124:127], v[80:83], v[148:151]
    v_cvt_pk_bf16_f32 v73, v50, v51
    v_mfma_f32_16x16x32_bf16 v[168:171], a[128:131], v[80:83], v[168:171]
    buffer_load_dwordx4 v25, s[16:19], s25 offen offset:3072 lds
    v_mfma_f32_16x16x32_bf16 v[188:191], a[132:135], v[80:83], v[188:191]
    v_exp_f32 v53, v53
    v_mfma_f32_16x16x32_bf16 v[208:211], a[136:139], v[80:83], v[208:211]
    v_exp_f32 v54, v54
    v_mfma_f32_16x16x32_bf16 v[228:231], a[140:143], v[80:83], v[228:231]
    v_cvt_pk_bf16_f32 v74, v52, v53
    v_mfma_f32_16x16x32_bf16 a[148:151], a[164:167], v[80:83], a[148:151]
    s_add_u32 m0, s24, 102400
    s_nop 0
    buffer_load_dwordx4 v24, s[16:19], s98 offen offset:0 lds
    v_mfma_f32_16x16x32_bf16 v[64:67], a[80:83], a[64:67], v[44:47]
    v_exp_f32 v55, v55
    v_mfma_f32_16x16x32_bf16 v[64:67], a[84:87], a[68:71], v[64:67]
    v_cvt_pk_bf16_f32 v75, v54, v55
    s_waitcnt vmcnt(21)
    ds_read_b128 a[80:83], v8 offset:0
    v_mfma_f32_16x16x32_bf16 v[64:67], a[88:91], a[72:75], v[64:67]
    ds_read_b128 a[84:87], v9 offset:0
    ds_read_b128 a[88:91], v10 offset:0
    v_mfma_f32_16x16x32_bf16 v[64:67], a[92:95], a[76:79], v[64:67]
    buffer_load_dwordx4 v25, s[16:19], s98 offen offset:1024 lds
    ds_read_b128 a[92:95], v11 offset:0
    v_mfma_f32_16x16x32_bf16 v[68:71], a[96:99], a[64:67], v[44:47]
    ds_read_b128 a[96:99], v8 offset:4096
    v_mfma_f32_16x16x32_bf16 v[68:71], a[100:103], a[68:71], v[68:71]
    ds_read_b128 a[100:103], v9 offset:4096
    v_mfma_f32_16x16x32_bf16 v[68:71], a[104:107], a[72:75], v[68:71]
    ds_read_b128 a[104:107], v10 offset:4096
    v_mfma_f32_16x16x32_bf16 v[68:71], a[108:111], a[76:79], v[68:71]
    buffer_load_dwordx4 v24, s[16:19], s98 offen offset:2048 lds
    ds_read_b128 a[108:111], v11 offset:4096
    v_mfma_f32_16x16x32_bf16 v[92:95], a[112:115], v[72:75], v[92:95]
    v_exp_f32 v56, v56
    v_mfma_f32_16x16x32_bf16 v[112:115], a[116:119], v[72:75], v[112:115]
    v_exp_f32 v57, v57
    v_mfma_f32_16x16x32_bf16 v[132:135], a[120:123], v[72:75], v[132:135]
    v_exp_f32 v58, v58
    v_mfma_f32_16x16x32_bf16 v[152:155], a[124:127], v[72:75], v[152:155]
    buffer_load_dwordx4 v25, s[16:19], s98 offen offset:3072 lds
    v_cvt_pk_bf16_f32 v76, v56, v57
    v_mfma_f32_16x16x32_bf16 v[172:175], a[128:131], v[72:75], v[172:175]
    v_exp_f32 v59, v59
    v_mfma_f32_16x16x32_bf16 v[192:195], a[132:135], v[72:75], v[192:195]
    v_exp_f32 v60, v60
    v_mfma_f32_16x16x32_bf16 v[212:215], a[136:139], v[72:75], v[212:215]
    v_cvt_pk_bf16_f32 v77, v58, v59
    v_mfma_f32_16x16x32_bf16 v[232:235], a[140:143], v[72:75], v[232:235]
    v_exp_f32 v61, v61
    v_mfma_f32_16x16x32_bf16 a[152:155], a[164:167], v[72:75], a[152:155]
    v_exp_f32 v62, v62
    s_waitcnt lgkmcnt(0)
    v_mfma_f32_16x16x32_bf16 v[48:51], a[80:83], a[0:3], v[28:31]
    v_cvt_pk_bf16_f32 v78, v60, v61
    v_mfma_f32_16x16x32_bf16 v[48:51], a[84:87], a[4:7], v[48:51]
    v_exp_f32 v63, v63
    v_mfma_f32_16x16x32_bf16 v[48:51], a[88:91], a[8:11], v[48:51]
    v_cvt_pk_bf16_f32 v79, v62, v63
    v_mfma_f32_16x16x32_bf16 v[48:51], a[92:95], a[12:15], v[48:51]
    v_exp_f32 v64, v64
    v_mfma_f32_16x16x32_bf16 v[52:55], a[96:99], a[0:3], v[28:31]
    v_exp_f32 v65, v65
    v_mfma_f32_16x16x32_bf16 v[52:55], a[100:103], a[4:7], v[52:55]
    v_exp_f32 v66, v66
    v_mfma_f32_16x16x32_bf16 v[52:55], a[104:107], a[8:11], v[52:55]
    v_cvt_pk_bf16_f32 v80, v64, v65
    v_mfma_f32_16x16x32_bf16 v[52:55], a[108:111], a[12:15], v[52:55]
    v_exp_f32 v67, v67
    v_mfma_f32_16x16x32_bf16 v[96:99], a[112:115], v[76:79], v[96:99]
    s_bfe_u32 s25, s93, 0x40000
    s_lshl_b32 s25, s25, 13
    v_mfma_f32_16x16x32_bf16 v[116:119], a[116:119], v[76:79], v[116:119]
    s_add_u32 s98, s25, 4096
    s_add_u32 m0, s24, 0
    v_mfma_f32_16x16x32_bf16 v[136:139], a[120:123], v[76:79], v[136:139]
    buffer_load_dwordx4 v20, s[12:15], s25 offen offset:0 lds
    v_mfma_f32_16x16x32_bf16 v[156:159], a[124:127], v[76:79], v[156:159]
    v_exp_f32 v68, v68
    v_mfma_f32_16x16x32_bf16 v[176:179], a[128:131], v[76:79], v[176:179]
    buffer_load_dwordx4 v21, s[12:15], s25 offen offset:1024 lds
    v_cvt_pk_bf16_f32 v81, v66, v67
    v_mfma_f32_16x16x32_bf16 v[196:199], a[132:135], v[76:79], v[196:199]
    v_exp_f32 v69, v69
    v_mfma_f32_16x16x32_bf16 v[216:219], a[136:139], v[76:79], v[216:219]
    v_exp_f32 v70, v70
    v_mfma_f32_16x16x32_bf16 v[236:239], a[140:143], v[76:79], v[236:239]
    v_cvt_pk_bf16_f32 v82, v68, v69
    v_mfma_f32_16x16x32_bf16 a[156:159], a[164:167], v[76:79], a[156:159]
    buffer_load_dwordx4 v22, s[12:15], s25 offen offset:2048 lds
    v_mfma_f32_16x16x32_bf16 v[56:59], a[80:83], a[16:19], v[32:35]
    v_exp_f32 v71, v71
    v_mfma_f32_16x16x32_bf16 v[56:59], a[84:87], a[20:23], v[56:59]
    v_cvt_pk_bf16_f32 v83, v70, v71
    v_mfma_f32_16x16x32_bf16 v[56:59], a[88:91], a[24:27], v[56:59]
    v_exp_f32 v48, v48
    v_mfma_f32_16x16x32_bf16 v[56:59], a[92:95], a[28:31], v[56:59]
    buffer_load_dwordx4 v23, s[12:15], s25 offen offset:3072 lds
    v_mfma_f32_16x16x32_bf16 v[60:63], a[96:99], a[16:19], v[32:35]
    v_exp_f32 v49, v49
    v_mfma_f32_16x16x32_bf16 v[60:63], a[100:103], a[20:23], v[60:63]
    v_exp_f32 v50, v50
    v_mfma_f32_16x16x32_bf16 v[60:63], a[104:107], a[24:27], v[60:63]
    v_cvt_pk_bf16_f32 v72, v48, v49
    v_mfma_f32_16x16x32_bf16 v[60:63], a[108:111], a[28:31], v[60:63]
    s_add_u32 m0, s24, 4096
    s_nop 0
    buffer_load_dwordx4 v20, s[12:15], s98 offen offset:0 lds
    v_mfma_f32_16x16x32_bf16 v[100:103], a[112:115], v[80:83], v[100:103]
    s_waitcnt vmcnt(21)
    ds_read_b64_tr_b16 a[112:113], v12 offset:0
    ds_read_b64_tr_b16 a[114:115], v12 offset:4096
    v_mfma_f32_16x16x32_bf16 v[120:123], a[116:119], v[80:83], v[120:123]
    ds_read_b64_tr_b16 a[116:117], v13 offset:0
    ds_read_b64_tr_b16 a[118:119], v13 offset:4096
    v_mfma_f32_16x16x32_bf16 v[140:143], a[120:123], v[80:83], v[140:143]
    v_exp_f32 v51, v51
    v_mfma_f32_16x16x32_bf16 v[160:163], a[124:127], v[80:83], v[160:163]
    buffer_load_dwordx4 v21, s[12:15], s98 offen offset:1024 lds
    ds_read_b64_tr_b16 a[120:121], v14 offset:0
    v_mfma_f32_16x16x32_bf16 v[180:183], a[128:131], v[80:83], v[180:183]
    v_exp_f32 v52, v52
    v_mfma_f32_16x16x32_bf16 v[200:203], a[132:135], v[80:83], v[200:203]
    v_cvt_pk_bf16_f32 v73, v50, v51
    ds_read_b64_tr_b16 a[122:123], v14 offset:4096
    v_mfma_f32_16x16x32_bf16 v[220:223], a[136:139], v[80:83], v[220:223]
    v_exp_f32 v53, v53
    v_mfma_f32_16x16x32_bf16 v[240:243], a[140:143], v[80:83], v[240:243]
    buffer_load_dwordx4 v22, s[12:15], s98 offen offset:2048 lds
    ds_read_b64_tr_b16 a[124:125], v15 offset:0
    v_mfma_f32_16x16x32_bf16 a[160:163], a[164:167], v[80:83], a[160:163]
    v_exp_f32 v54, v54
    v_mfma_f32_16x16x32_bf16 v[64:67], a[80:83], a[32:35], v[36:39]
    v_cvt_pk_bf16_f32 v74, v52, v53
    ds_read_b64_tr_b16 a[126:127], v15 offset:4096
    v_mfma_f32_16x16x32_bf16 v[64:67], a[84:87], a[36:39], v[64:67]
    v_exp_f32 v55, v55
    v_mfma_f32_16x16x32_bf16 v[64:67], a[88:91], a[40:43], v[64:67]
    v_cvt_pk_bf16_f32 v75, v54, v55
    buffer_load_dwordx4 v23, s[12:15], s98 offen offset:3072 lds
    v_mfma_f32_16x16x32_bf16 v[64:67], a[92:95], a[44:47], v[64:67]
    ds_read_b64_tr_b16 a[128:129], v16 offset:0
    ds_read_b64_tr_b16 a[130:131], v16 offset:4096
    v_mfma_f32_16x16x32_bf16 v[68:71], a[96:99], a[32:35], v[36:39]
    ds_read_b64_tr_b16 a[132:133], v17 offset:0
    ds_read_b64_tr_b16 a[134:135], v17 offset:4096
    v_mfma_f32_16x16x32_bf16 v[68:71], a[100:103], a[36:39], v[68:71]
    ds_read_b64_tr_b16 a[136:137], v18 offset:0
    ds_read_b64_tr_b16 a[138:139], v18 offset:4096
    v_mfma_f32_16x16x32_bf16 v[68:71], a[104:107], a[40:43], v[68:71]
    ds_read_b64_tr_b16 a[140:141], v19 offset:0
    ds_read_b64_tr_b16 a[142:143], v19 offset:4096
    v_mfma_f32_16x16x32_bf16 v[68:71], a[108:111], a[44:47], v[68:71]
    v_exp_f32 v56, v56
    s_waitcnt lgkmcnt(8)
    v_mfma_f32_16x16x32_bf16 v[84:87], a[112:115], v[72:75], v[84:87]
    v_exp_f32 v57, v57
    v_mfma_f32_16x16x32_bf16 v[104:107], a[116:119], v[72:75], v[104:107]
    v_exp_f32 v58, v58
    v_mfma_f32_16x16x32_bf16 v[124:127], a[120:123], v[72:75], v[124:127]
    v_cvt_pk_bf16_f32 v76, v56, v57
    v_mfma_f32_16x16x32_bf16 v[144:147], a[124:127], v[72:75], v[144:147]
    v_exp_f32 v59, v59
    s_waitcnt lgkmcnt(2)
    v_mfma_f32_16x16x32_bf16 v[164:167], a[128:131], v[72:75], v[164:167]
    v_exp_f32 v60, v60
    v_mfma_f32_16x16x32_bf16 v[184:187], a[132:135], v[72:75], v[184:187]
    v_cvt_pk_bf16_f32 v77, v58, v59
    v_mfma_f32_16x16x32_bf16 v[204:207], a[136:139], v[72:75], v[204:207]
    v_exp_f32 v61, v61
    s_waitcnt lgkmcnt(0)
    v_mfma_f32_16x16x32_bf16 v[224:227], a[140:143], v[72:75], v[224:227]
    v_exp_f32 v62, v62
    v_mfma_f32_16x16x32_bf16 a[144:147], a[164:167], v[72:75], a[144:147]
    v_cvt_pk_bf16_f32 v78, v60, v61
    v_mfma_f32_16x16x32_bf16 v[48:51], a[80:83], a[48:51], v[40:43]
    s_add_u32 m0, s24, 65536
    s_nop 0
    buffer_load_dwordx4 v24, s[16:19], s25 offen offset:0 lds
    v_mfma_f32_16x16x32_bf16 v[48:51], a[84:87], a[52:55], v[48:51]
    v_exp_f32 v63, v63
    v_mfma_f32_16x16x32_bf16 v[48:51], a[88:91], a[56:59], v[48:51]
    v_cvt_pk_bf16_f32 v79, v62, v63
    v_mfma_f32_16x16x32_bf16 v[48:51], a[92:95], a[60:63], v[48:51]
    v_exp_f32 v64, v64
    v_mfma_f32_16x16x32_bf16 v[52:55], a[96:99], a[48:51], v[40:43]
    buffer_load_dwordx4 v25, s[16:19], s25 offen offset:1024 lds
    v_mfma_f32_16x16x32_bf16 v[52:55], a[100:103], a[52:55], v[52:55]
    v_exp_f32 v65, v65
    v_mfma_f32_16x16x32_bf16 v[52:55], a[104:107], a[56:59], v[52:55]
    v_exp_f32 v66, v66
    v_mfma_f32_16x16x32_bf16 v[52:55], a[108:111], a[60:63], v[52:55]
    v_cvt_pk_bf16_f32 v80, v64, v65
    v_mfma_f32_16x16x32_bf16 v[88:91], a[112:115], v[76:79], v[88:91]
    buffer_load_dwordx4 v24, s[16:19], s25 offen offset:2048 lds
    v_mfma_f32_16x16x32_bf16 v[108:111], a[116:119], v[76:79], v[108:111]
    v_exp_f32 v67, v67
    v_mfma_f32_16x16x32_bf16 v[128:131], a[120:123], v[76:79], v[128:131]
    v_exp_f32 v68, v68
    v_mfma_f32_16x16x32_bf16 v[148:151], a[124:127], v[76:79], v[148:151]
    v_cvt_pk_bf16_f32 v81, v66, v67
    v_mfma_f32_16x16x32_bf16 v[168:171], a[128:131], v[76:79], v[168:171]
    buffer_load_dwordx4 v25, s[16:19], s25 offen offset:3072 lds
    v_mfma_f32_16x16x32_bf16 v[188:191], a[132:135], v[76:79], v[188:191]
    v_exp_f32 v69, v69
    v_mfma_f32_16x16x32_bf16 v[208:211], a[136:139], v[76:79], v[208:211]
    v_exp_f32 v70, v70
    v_mfma_f32_16x16x32_bf16 v[228:231], a[140:143], v[76:79], v[228:231]
    v_cvt_pk_bf16_f32 v82, v68, v69
    v_mfma_f32_16x16x32_bf16 a[148:151], a[164:167], v[76:79], a[148:151]
    s_add_u32 m0, s24, 69632
    s_nop 0
    buffer_load_dwordx4 v24, s[16:19], s98 offen offset:0 lds
    v_mfma_f32_16x16x32_bf16 v[56:59], a[80:83], a[64:67], v[44:47]
    v_exp_f32 v71, v71
    v_mfma_f32_16x16x32_bf16 v[56:59], a[84:87], a[68:71], v[56:59]
    v_cvt_pk_bf16_f32 v83, v70, v71
    s_waitcnt vmcnt(21)
    ds_read_b128 a[80:83], v8 offset:32768
    v_mfma_f32_16x16x32_bf16 v[56:59], a[88:91], a[72:75], v[56:59]
    ds_read_b128 a[84:87], v9 offset:32768
    ds_read_b128 a[88:91], v10 offset:32768
    v_mfma_f32_16x16x32_bf16 v[56:59], a[92:95], a[76:79], v[56:59]
    buffer_load_dwordx4 v25, s[16:19], s98 offen offset:1024 lds
    ds_read_b128 a[92:95], v11 offset:32768
    v_mfma_f32_16x16x32_bf16 v[60:63], a[96:99], a[64:67], v[44:47]
    ds_read_b128 a[96:99], v8 offset:36864
    v_mfma_f32_16x16x32_bf16 v[60:63], a[100:103], a[68:71], v[60:63]
    ds_read_b128 a[100:103], v9 offset:36864
    v_mfma_f32_16x16x32_bf16 v[60:63], a[104:107], a[72:75], v[60:63]
    ds_read_b128 a[104:107], v10 offset:36864
    v_mfma_f32_16x16x32_bf16 v[60:63], a[108:111], a[76:79], v[60:63]
    buffer_load_dwordx4 v24, s[16:19], s98 offen offset:2048 lds
    ds_read_b128 a[108:111], v11 offset:36864
    v_mfma_f32_16x16x32_bf16 v[92:95], a[112:115], v[80:83], v[92:95]
    v_exp_f32 v48, v48
    v_mfma_f32_16x16x32_bf16 v[112:115], a[116:119], v[80:83], v[112:115]
    v_exp_f32 v49, v49
    v_mfma_f32_16x16x32_bf16 v[132:135], a[120:123], v[80:83], v[132:135]
    v_exp_f32 v50, v50
    v_mfma_f32_16x16x32_bf16 v[152:155], a[124:127], v[80:83], v[152:155]
    buffer_load_dwordx4 v25, s[16:19], s98 offen offset:3072 lds
    v_cvt_pk_bf16_f32 v72, v48, v49
    v_mfma_f32_16x16x32_bf16 v[172:175], a[128:131], v[80:83], v[172:175]
    v_exp_f32 v51, v51
    v_mfma_f32_16x16x32_bf16 v[192:195], a[132:135], v[80:83], v[192:195]
    v_exp_f32 v52, v52
    v_mfma_f32_16x16x32_bf16 v[212:215], a[136:139], v[80:83], v[212:215]
    v_cvt_pk_bf16_f32 v73, v50, v51
    v_mfma_f32_16x16x32_bf16 v[232:235], a[140:143], v[80:83], v[232:235]
    v_exp_f32 v53, v53
    v_mfma_f32_16x16x32_bf16 a[152:155], a[164:167], v[80:83], a[152:155]
    v_exp_f32 v54, v54
    s_waitcnt lgkmcnt(0)
    v_mfma_f32_16x16x32_bf16 v[64:67], a[80:83], a[0:3], v[28:31]
    v_cvt_pk_bf16_f32 v74, v52, v53
    v_mfma_f32_16x16x32_bf16 v[64:67], a[84:87], a[4:7], v[64:67]
    v_exp_f32 v55, v55
    v_mfma_f32_16x16x32_bf16 v[64:67], a[88:91], a[8:11], v[64:67]
    v_cvt_pk_bf16_f32 v75, v54, v55
    v_mfma_f32_16x16x32_bf16 v[64:67], a[92:95], a[12:15], v[64:67]
    v_exp_f32 v56, v56
    v_mfma_f32_16x16x32_bf16 v[68:71], a[96:99], a[0:3], v[28:31]
    v_exp_f32 v57, v57
    v_mfma_f32_16x16x32_bf16 v[68:71], a[100:103], a[4:7], v[68:71]
    v_exp_f32 v58, v58
    v_mfma_f32_16x16x32_bf16 v[68:71], a[104:107], a[8:11], v[68:71]
    v_cvt_pk_bf16_f32 v76, v56, v57
    v_mfma_f32_16x16x32_bf16 v[68:71], a[108:111], a[12:15], v[68:71]
    v_exp_f32 v59, v59
    v_mfma_f32_16x16x32_bf16 v[96:99], a[112:115], v[72:75], v[96:99]
    s_bfe_u32 s25, s93, 0x40004
    s_lshl_b32 s25, s25, 13
    v_mfma_f32_16x16x32_bf16 v[116:119], a[116:119], v[72:75], v[116:119]
    s_add_u32 s98, s25, 4096
    s_add_u32 m0, s24, 32768
    v_mfma_f32_16x16x32_bf16 v[136:139], a[120:123], v[72:75], v[136:139]
    buffer_load_dwordx4 v20, s[12:15], s25 offen offset:0 lds
    v_mfma_f32_16x16x32_bf16 v[156:159], a[124:127], v[72:75], v[156:159]
    v_exp_f32 v60, v60
    v_mfma_f32_16x16x32_bf16 v[176:179], a[128:131], v[72:75], v[176:179]
    buffer_load_dwordx4 v21, s[12:15], s25 offen offset:1024 lds
    v_cvt_pk_bf16_f32 v77, v58, v59
    v_mfma_f32_16x16x32_bf16 v[196:199], a[132:135], v[72:75], v[196:199]
    v_exp_f32 v61, v61
    v_mfma_f32_16x16x32_bf16 v[216:219], a[136:139], v[72:75], v[216:219]
    v_exp_f32 v62, v62
    v_mfma_f32_16x16x32_bf16 v[236:239], a[140:143], v[72:75], v[236:239]
    v_cvt_pk_bf16_f32 v78, v60, v61
    v_mfma_f32_16x16x32_bf16 a[156:159], a[164:167], v[72:75], a[156:159]
    buffer_load_dwordx4 v22, s[12:15], s25 offen offset:2048 lds
    v_mfma_f32_16x16x32_bf16 v[48:51], a[80:83], a[16:19], v[32:35]
    v_exp_f32 v63, v63
    v_mfma_f32_16x16x32_bf16 v[48:51], a[84:87], a[20:23], v[48:51]
    v_cvt_pk_bf16_f32 v79, v62, v63
    v_mfma_f32_16x16x32_bf16 v[48:51], a[88:91], a[24:27], v[48:51]
    v_exp_f32 v64, v64
    v_mfma_f32_16x16x32_bf16 v[48:51], a[92:95], a[28:31], v[48:51]
    buffer_load_dwordx4 v23, s[12:15], s25 offen offset:3072 lds
    v_mfma_f32_16x16x32_bf16 v[52:55], a[96:99], a[16:19], v[32:35]
    v_exp_f32 v65, v65
    v_mfma_f32_16x16x32_bf16 v[52:55], a[100:103], a[20:23], v[52:55]
    v_exp_f32 v66, v66
    v_mfma_f32_16x16x32_bf16 v[52:55], a[104:107], a[24:27], v[52:55]
    v_cvt_pk_bf16_f32 v80, v64, v65
    v_mfma_f32_16x16x32_bf16 v[52:55], a[108:111], a[28:31], v[52:55]
    s_add_u32 m0, s24, 36864
    s_nop 0
    buffer_load_dwordx4 v20, s[12:15], s98 offen offset:0 lds
    v_mfma_f32_16x16x32_bf16 v[100:103], a[112:115], v[76:79], v[100:103]
    s_waitcnt vmcnt(21)
    ds_read_b64_tr_b16 a[112:113], v12 offset:32768
    ds_read_b64_tr_b16 a[114:115], v12 offset:36864
    v_mfma_f32_16x16x32_bf16 v[120:123], a[116:119], v[76:79], v[120:123]
    ds_read_b64_tr_b16 a[116:117], v13 offset:32768
    ds_read_b64_tr_b16 a[118:119], v13 offset:36864
    v_mfma_f32_16x16x32_bf16 v[140:143], a[120:123], v[76:79], v[140:143]
    v_exp_f32 v67, v67
    v_mfma_f32_16x16x32_bf16 v[160:163], a[124:127], v[76:79], v[160:163]
    buffer_load_dwordx4 v21, s[12:15], s98 offen offset:1024 lds
    ds_read_b64_tr_b16 a[120:121], v14 offset:32768
    v_mfma_f32_16x16x32_bf16 v[180:183], a[128:131], v[76:79], v[180:183]
    v_exp_f32 v68, v68
    v_mfma_f32_16x16x32_bf16 v[200:203], a[132:135], v[76:79], v[200:203]
    v_cvt_pk_bf16_f32 v81, v66, v67
    ds_read_b64_tr_b16 a[122:123], v14 offset:36864
    v_mfma_f32_16x16x32_bf16 v[220:223], a[136:139], v[76:79], v[220:223]
    v_exp_f32 v69, v69
    v_mfma_f32_16x16x32_bf16 v[240:243], a[140:143], v[76:79], v[240:243]
    buffer_load_dwordx4 v22, s[12:15], s98 offen offset:2048 lds
    ds_read_b64_tr_b16 a[124:125], v15 offset:32768
    v_mfma_f32_16x16x32_bf16 a[160:163], a[164:167], v[76:79], a[160:163]
    v_exp_f32 v70, v70
    v_mfma_f32_16x16x32_bf16 v[56:59], a[80:83], a[32:35], v[36:39]
    v_cvt_pk_bf16_f32 v82, v68, v69
    ds_read_b64_tr_b16 a[126:127], v15 offset:36864
    v_mfma_f32_16x16x32_bf16 v[56:59], a[84:87], a[36:39], v[56:59]
    v_exp_f32 v71, v71
    v_mfma_f32_16x16x32_bf16 v[56:59], a[88:91], a[40:43], v[56:59]
    v_cvt_pk_bf16_f32 v83, v70, v71
    buffer_load_dwordx4 v23, s[12:15], s98 offen offset:3072 lds
    v_mfma_f32_16x16x32_bf16 v[56:59], a[92:95], a[44:47], v[56:59]
    ds_read_b64_tr_b16 a[128:129], v16 offset:32768
    ds_read_b64_tr_b16 a[130:131], v16 offset:36864
    v_mfma_f32_16x16x32_bf16 v[60:63], a[96:99], a[32:35], v[36:39]
    ds_read_b64_tr_b16 a[132:133], v17 offset:32768
    ds_read_b64_tr_b16 a[134:135], v17 offset:36864
    v_mfma_f32_16x16x32_bf16 v[60:63], a[100:103], a[36:39], v[60:63]
    ds_read_b64_tr_b16 a[136:137], v18 offset:32768
    ds_read_b64_tr_b16 a[138:139], v18 offset:36864
    v_mfma_f32_16x16x32_bf16 v[60:63], a[104:107], a[40:43], v[60:63]
    ds_read_b64_tr_b16 a[140:141], v19 offset:32768
    ds_read_b64_tr_b16 a[142:143], v19 offset:36864
    v_mfma_f32_16x16x32_bf16 v[60:63], a[108:111], a[44:47], v[60:63]
    v_exp_f32 v48, v48
    s_waitcnt lgkmcnt(8)
    v_mfma_f32_16x16x32_bf16 v[84:87], a[112:115], v[80:83], v[84:87]
    v_exp_f32 v49, v49
    v_mfma_f32_16x16x32_bf16 v[104:107], a[116:119], v[80:83], v[104:107]
    v_exp_f32 v50, v50
    v_mfma_f32_16x16x32_bf16 v[124:127], a[120:123], v[80:83], v[124:127]
    v_cvt_pk_bf16_f32 v72, v48, v49
    v_mfma_f32_16x16x32_bf16 v[144:147], a[124:127], v[80:83], v[144:147]
    v_exp_f32 v51, v51
    s_waitcnt lgkmcnt(2)
    v_mfma_f32_16x16x32_bf16 v[164:167], a[128:131], v[80:83], v[164:167]
    v_exp_f32 v52, v52
    v_mfma_f32_16x16x32_bf16 v[184:187], a[132:135], v[80:83], v[184:187]
    v_cvt_pk_bf16_f32 v73, v50, v51
    v_mfma_f32_16x16x32_bf16 v[204:207], a[136:139], v[80:83], v[204:207]
    v_exp_f32 v53, v53
    s_waitcnt lgkmcnt(0)
    v_mfma_f32_16x16x32_bf16 v[224:227], a[140:143], v[80:83], v[224:227]
    v_exp_f32 v54, v54
    v_mfma_f32_16x16x32_bf16 a[144:147], a[164:167], v[80:83], a[144:147]
    v_cvt_pk_bf16_f32 v74, v52, v53
    v_mfma_f32_16x16x32_bf16 v[64:67], a[80:83], a[48:51], v[40:43]
    s_add_u32 m0, s24, 98304
    s_nop 0
    buffer_load_dwordx4 v24, s[16:19], s25 offen offset:0 lds
    v_mfma_f32_16x16x32_bf16 v[64:67], a[84:87], a[52:55], v[64:67]
    v_exp_f32 v55, v55
    v_mfma_f32_16x16x32_bf16 v[64:67], a[88:91], a[56:59], v[64:67]
    v_cvt_pk_bf16_f32 v75, v54, v55
    v_mfma_f32_16x16x32_bf16 v[64:67], a[92:95], a[60:63], v[64:67]
    v_exp_f32 v56, v56
    v_mfma_f32_16x16x32_bf16 v[68:71], a[96:99], a[48:51], v[40:43]
    buffer_load_dwordx4 v25, s[16:19], s25 offen offset:1024 lds
    v_mfma_f32_16x16x32_bf16 v[68:71], a[100:103], a[52:55], v[68:71]
    v_exp_f32 v57, v57
    v_mfma_f32_16x16x32_bf16 v[68:71], a[104:107], a[56:59], v[68:71]
    v_exp_f32 v58, v58
    v_mfma_f32_16x16x32_bf16 v[68:71], a[108:111], a[60:63], v[68:71]
    v_cvt_pk_bf16_f32 v76, v56, v57
    v_mfma_f32_16x16x32_bf16 v[88:91], a[112:115], v[72:75], v[88:91]
    buffer_load_dwordx4 v24, s[16:19], s25 offen offset:2048 lds
    v_mfma_f32_16x16x32_bf16 v[108:111], a[116:119], v[72:75], v[108:111]
    v_exp_f32 v59, v59
    v_mfma_f32_16x16x32_bf16 v[128:131], a[120:123], v[72:75], v[128:131]
    v_exp_f32 v60, v60
    v_mfma_f32_16x16x32_bf16 v[148:151], a[124:127], v[72:75], v[148:151]
    v_cvt_pk_bf16_f32 v77, v58, v59
    v_mfma_f32_16x16x32_bf16 v[168:171], a[128:131], v[72:75], v[168:171]
    buffer_load_dwordx4 v25, s[16:19], s25 offen offset:3072 lds
    v_mfma_f32_16x16x32_bf16 v[188:191], a[132:135], v[72:75], v[188:191]
    v_exp_f32 v61, v61
    v_mfma_f32_16x16x32_bf16 v[208:211], a[136:139], v[72:75], v[208:211]
    v_exp_f32 v62, v62
    v_mfma_f32_16x16x32_bf16 v[228:231], a[140:143], v[72:75], v[228:231]
    v_cvt_pk_bf16_f32 v78, v60, v61
    v_mfma_f32_16x16x32_bf16 a[148:151], a[164:167], v[72:75], a[148:151]
    s_add_u32 m0, s24, 102400
    s_nop 0
    buffer_load_dwordx4 v24, s[16:19], s98 offen offset:0 lds
    v_mfma_f32_16x16x32_bf16 v[48:51], a[80:83], a[64:67], v[44:47]
    v_exp_f32 v63, v63
    v_mfma_f32_16x16x32_bf16 v[48:51], a[84:87], a[68:71], v[48:51]
    v_cvt_pk_bf16_f32 v79, v62, v63
    s_waitcnt vmcnt(21)
    ds_read_b128 a[80:83], v8 offset:0
    v_mfma_f32_16x16x32_bf16 v[48:51], a[88:91], a[72:75], v[48:51]
    ds_read_b128 a[84:87], v9 offset:0
    ds_read_b128 a[88:91], v10 offset:0
    v_mfma_f32_16x16x32_bf16 v[48:51], a[92:95], a[76:79], v[48:51]
    buffer_load_dwordx4 v25, s[16:19], s98 offen offset:1024 lds
    ds_read_b128 a[92:95], v11 offset:0
    v_mfma_f32_16x16x32_bf16 v[52:55], a[96:99], a[64:67], v[44:47]
    ds_read_b128 a[96:99], v8 offset:4096
    v_mfma_f32_16x16x32_bf16 v[52:55], a[100:103], a[68:71], v[52:55]
    ds_read_b128 a[100:103], v9 offset:4096
    v_mfma_f32_16x16x32_bf16 v[52:55], a[104:107], a[72:75], v[52:55]
    ds_read_b128 a[104:107], v10 offset:4096
    v_mfma_f32_16x16x32_bf16 v[52:55], a[108:111], a[76:79], v[52:55]
    buffer_load_dwordx4 v24, s[16:19], s98 offen offset:2048 lds
    ds_read_b128 a[108:111], v11 offset:4096
    v_mfma_f32_16x16x32_bf16 v[92:95], a[112:115], v[76:79], v[92:95]
    v_exp_f32 v64, v64
    v_mfma_f32_16x16x32_bf16 v[112:115], a[116:119], v[76:79], v[112:115]
    v_exp_f32 v65, v65
    v_mfma_f32_16x16x32_bf16 v[132:135], a[120:123], v[76:79], v[132:135]
    v_exp_f32 v66, v66
    v_mfma_f32_16x16x32_bf16 v[152:155], a[124:127], v[76:79], v[152:155]
    buffer_load_dwordx4 v25, s[16:19], s98 offen offset:3072 lds
    v_cvt_pk_bf16_f32 v80, v64, v65
    v_mfma_f32_16x16x32_bf16 v[172:175], a[128:131], v[76:79], v[172:175]
    v_exp_f32 v67, v67
    v_mfma_f32_16x16x32_bf16 v[192:195], a[132:135], v[76:79], v[192:195]
    v_exp_f32 v68, v68
    v_mfma_f32_16x16x32_bf16 v[212:215], a[136:139], v[76:79], v[212:215]
    v_cvt_pk_bf16_f32 v81, v66, v67
    v_mfma_f32_16x16x32_bf16 v[232:235], a[140:143], v[76:79], v[232:235]
    v_exp_f32 v69, v69
    v_mfma_f32_16x16x32_bf16 a[152:155], a[164:167], v[76:79], a[152:155]
    v_exp_f32 v70, v70
    s_waitcnt lgkmcnt(0)
    v_mfma_f32_16x16x32_bf16 v[56:59], a[80:83], a[0:3], v[28:31]
    v_cvt_pk_bf16_f32 v82, v68, v69
    v_mfma_f32_16x16x32_bf16 v[56:59], a[84:87], a[4:7], v[56:59]
    v_exp_f32 v71, v71
    v_mfma_f32_16x16x32_bf16 v[56:59], a[88:91], a[8:11], v[56:59]
    v_cvt_pk_bf16_f32 v83, v70, v71
    v_mfma_f32_16x16x32_bf16 v[56:59], a[92:95], a[12:15], v[56:59]
    v_exp_f32 v48, v48
    v_mfma_f32_16x16x32_bf16 v[60:63], a[96:99], a[0:3], v[28:31]
    v_exp_f32 v49, v49
    v_mfma_f32_16x16x32_bf16 v[60:63], a[100:103], a[4:7], v[60:63]
    v_exp_f32 v50, v50
    v_mfma_f32_16x16x32_bf16 v[60:63], a[104:107], a[8:11], v[60:63]
    v_cvt_pk_bf16_f32 v72, v48, v49
    v_mfma_f32_16x16x32_bf16 v[60:63], a[108:111], a[12:15], v[60:63]
    v_exp_f32 v51, v51
    v_mfma_f32_16x16x32_bf16 v[96:99], a[112:115], v[80:83], v[96:99]
    s_bfe_u32 s25, s93, 0x40008
    s_lshl_b32 s25, s25, 13
    v_mfma_f32_16x16x32_bf16 v[116:119], a[116:119], v[80:83], v[116:119]
    s_add_u32 s98, s25, 4096
    s_add_u32 m0, s24, 0
    v_mfma_f32_16x16x32_bf16 v[136:139], a[120:123], v[80:83], v[136:139]
    buffer_load_dwordx4 v20, s[12:15], s25 offen offset:0 lds
    v_mfma_f32_16x16x32_bf16 v[156:159], a[124:127], v[80:83], v[156:159]
    v_exp_f32 v52, v52
    v_mfma_f32_16x16x32_bf16 v[176:179], a[128:131], v[80:83], v[176:179]
    buffer_load_dwordx4 v21, s[12:15], s25 offen offset:1024 lds
    v_cvt_pk_bf16_f32 v73, v50, v51
    v_mfma_f32_16x16x32_bf16 v[196:199], a[132:135], v[80:83], v[196:199]
    v_exp_f32 v53, v53
    v_mfma_f32_16x16x32_bf16 v[216:219], a[136:139], v[80:83], v[216:219]
    v_exp_f32 v54, v54
    v_mfma_f32_16x16x32_bf16 v[236:239], a[140:143], v[80:83], v[236:239]
    v_cvt_pk_bf16_f32 v74, v52, v53
    v_mfma_f32_16x16x32_bf16 a[156:159], a[164:167], v[80:83], a[156:159]
    buffer_load_dwordx4 v22, s[12:15], s25 offen offset:2048 lds
    v_mfma_f32_16x16x32_bf16 v[64:67], a[80:83], a[16:19], v[32:35]
    v_exp_f32 v55, v55
    v_mfma_f32_16x16x32_bf16 v[64:67], a[84:87], a[20:23], v[64:67]
    v_cvt_pk_bf16_f32 v75, v54, v55
    v_mfma_f32_16x16x32_bf16 v[64:67], a[88:91], a[24:27], v[64:67]
    v_exp_f32 v56, v56
    v_mfma_f32_16x16x32_bf16 v[64:67], a[92:95], a[28:31], v[64:67]
    buffer_load_dwordx4 v23, s[12:15], s25 offen offset:3072 lds
    v_mfma_f32_16x16x32_bf16 v[68:71], a[96:99], a[16:19], v[32:35]
    v_exp_f32 v57, v57
    v_mfma_f32_16x16x32_bf16 v[68:71], a[100:103], a[20:23], v[68:71]
    v_exp_f32 v58, v58
    v_mfma_f32_16x16x32_bf16 v[68:71], a[104:107], a[24:27], v[68:71]
    v_cvt_pk_bf16_f32 v76, v56, v57
    v_mfma_f32_16x16x32_bf16 v[68:71], a[108:111], a[28:31], v[68:71]
    s_add_u32 m0, s24, 4096
    s_nop 0
    buffer_load_dwordx4 v20, s[12:15], s98 offen offset:0 lds
    v_mfma_f32_16x16x32_bf16 v[100:103], a[112:115], v[72:75], v[100:103]
    s_waitcnt vmcnt(21)
    ds_read_b64_tr_b16 a[112:113], v12 offset:0
    ds_read_b64_tr_b16 a[114:115], v12 offset:4096
    v_mfma_f32_16x16x32_bf16 v[120:123], a[116:119], v[72:75], v[120:123]
    ds_read_b64_tr_b16 a[116:117], v13 offset:0
    ds_read_b64_tr_b16 a[118:119], v13 offset:4096
    v_mfma_f32_16x16x32_bf16 v[140:143], a[120:123], v[72:75], v[140:143]
    v_exp_f32 v59, v59
    v_mfma_f32_16x16x32_bf16 v[160:163], a[124:127], v[72:75], v[160:163]
    buffer_load_dwordx4 v21, s[12:15], s98 offen offset:1024 lds
    ds_read_b64_tr_b16 a[120:121], v14 offset:0
    v_mfma_f32_16x16x32_bf16 v[180:183], a[128:131], v[72:75], v[180:183]
    v_exp_f32 v60, v60
    v_mfma_f32_16x16x32_bf16 v[200:203], a[132:135], v[72:75], v[200:203]
    v_cvt_pk_bf16_f32 v77, v58, v59
    ds_read_b64_tr_b16 a[122:123], v14 offset:4096
    v_mfma_f32_16x16x32_bf16 v[220:223], a[136:139], v[72:75], v[220:223]
    v_exp_f32 v61, v61
    v_mfma_f32_16x16x32_bf16 v[240:243], a[140:143], v[72:75], v[240:243]
    buffer_load_dwordx4 v22, s[12:15], s98 offen offset:2048 lds
    ds_read_b64_tr_b16 a[124:125], v15 offset:0
    v_mfma_f32_16x16x32_bf16 a[160:163], a[164:167], v[72:75], a[160:163]
    v_exp_f32 v62, v62
    v_mfma_f32_16x16x32_bf16 v[48:51], a[80:83], a[32:35], v[36:39]
    v_cvt_pk_bf16_f32 v78, v60, v61
    ds_read_b64_tr_b16 a[126:127], v15 offset:4096
    v_mfma_f32_16x16x32_bf16 v[48:51], a[84:87], a[36:39], v[48:51]
    v_exp_f32 v63, v63
    v_mfma_f32_16x16x32_bf16 v[48:51], a[88:91], a[40:43], v[48:51]
    v_cvt_pk_bf16_f32 v79, v62, v63
    buffer_load_dwordx4 v23, s[12:15], s98 offen offset:3072 lds
    v_mfma_f32_16x16x32_bf16 v[48:51], a[92:95], a[44:47], v[48:51]
    ds_read_b64_tr_b16 a[128:129], v16 offset:0
    ds_read_b64_tr_b16 a[130:131], v16 offset:4096
    v_mfma_f32_16x16x32_bf16 v[52:55], a[96:99], a[32:35], v[36:39]
    ds_read_b64_tr_b16 a[132:133], v17 offset:0
    ds_read_b64_tr_b16 a[134:135], v17 offset:4096
    v_mfma_f32_16x16x32_bf16 v[52:55], a[100:103], a[36:39], v[52:55]
    ds_read_b64_tr_b16 a[136:137], v18 offset:0
    ds_read_b64_tr_b16 a[138:139], v18 offset:4096
    v_mfma_f32_16x16x32_bf16 v[52:55], a[104:107], a[40:43], v[52:55]
    ds_read_b64_tr_b16 a[140:141], v19 offset:0
    ds_read_b64_tr_b16 a[142:143], v19 offset:4096
    v_mfma_f32_16x16x32_bf16 v[52:55], a[108:111], a[44:47], v[52:55]
    v_exp_f32 v64, v64
    s_waitcnt lgkmcnt(8)
    v_mfma_f32_16x16x32_bf16 v[84:87], a[112:115], v[76:79], v[84:87]
    v_exp_f32 v65, v65
    v_mfma_f32_16x16x32_bf16 v[104:107], a[116:119], v[76:79], v[104:107]
    v_exp_f32 v66, v66
    v_mfma_f32_16x16x32_bf16 v[124:127], a[120:123], v[76:79], v[124:127]
    v_cvt_pk_bf16_f32 v80, v64, v65
    v_mfma_f32_16x16x32_bf16 v[144:147], a[124:127], v[76:79], v[144:147]
    v_exp_f32 v67, v67
    s_waitcnt lgkmcnt(2)
    v_mfma_f32_16x16x32_bf16 v[164:167], a[128:131], v[76:79], v[164:167]
    v_exp_f32 v68, v68
    v_mfma_f32_16x16x32_bf16 v[184:187], a[132:135], v[76:79], v[184:187]
    v_cvt_pk_bf16_f32 v81, v66, v67
    v_mfma_f32_16x16x32_bf16 v[204:207], a[136:139], v[76:79], v[204:207]
    v_exp_f32 v69, v69
    s_waitcnt lgkmcnt(0)
    v_mfma_f32_16x16x32_bf16 v[224:227], a[140:143], v[76:79], v[224:227]
    v_exp_f32 v70, v70
    v_mfma_f32_16x16x32_bf16 a[144:147], a[164:167], v[76:79], a[144:147]
    v_cvt_pk_bf16_f32 v82, v68, v69
    v_mfma_f32_16x16x32_bf16 v[56:59], a[80:83], a[48:51], v[40:43]
    s_add_u32 m0, s24, 65536
    s_nop 0
    buffer_load_dwordx4 v24, s[16:19], s25 offen offset:0 lds
    v_mfma_f32_16x16x32_bf16 v[56:59], a[84:87], a[52:55], v[56:59]
    v_exp_f32 v71, v71
    v_mfma_f32_16x16x32_bf16 v[56:59], a[88:91], a[56:59], v[56:59]
    v_cvt_pk_bf16_f32 v83, v70, v71
    v_mfma_f32_16x16x32_bf16 v[56:59], a[92:95], a[60:63], v[56:59]
    v_exp_f32 v48, v48
    v_mfma_f32_16x16x32_bf16 v[60:63], a[96:99], a[48:51], v[40:43]
    buffer_load_dwordx4 v25, s[16:19], s25 offen offset:1024 lds
    v_mfma_f32_16x16x32_bf16 v[60:63], a[100:103], a[52:55], v[60:63]
    v_exp_f32 v49, v49
    v_mfma_f32_16x16x32_bf16 v[60:63], a[104:107], a[56:59], v[60:63]
    v_exp_f32 v50, v50
    v_mfma_f32_16x16x32_bf16 v[60:63], a[108:111], a[60:63], v[60:63]
    v_cvt_pk_bf16_f32 v72, v48, v49
    v_mfma_f32_16x16x32_bf16 v[88:91], a[112:115], v[80:83], v[88:91]
    buffer_load_dwordx4 v24, s[16:19], s25 offen offset:2048 lds
    v_mfma_f32_16x16x32_bf16 v[108:111], a[116:119], v[80:83], v[108:111]
    v_exp_f32 v51, v51
    v_mfma_f32_16x16x32_bf16 v[128:131], a[120:123], v[80:83], v[128:131]
    v_exp_f32 v52, v52
    v_mfma_f32_16x16x32_bf16 v[148:151], a[124:127], v[80:83], v[148:151]
    v_cvt_pk_bf16_f32 v73, v50, v51
    v_mfma_f32_16x16x32_bf16 v[168:171], a[128:131], v[80:83], v[168:171]
    buffer_load_dwordx4 v25, s[16:19], s25 offen offset:3072 lds
    v_mfma_f32_16x16x32_bf16 v[188:191], a[132:135], v[80:83], v[188:191]
    v_exp_f32 v53, v53
    v_mfma_f32_16x16x32_bf16 v[208:211], a[136:139], v[80:83], v[208:211]
    v_exp_f32 v54, v54
    v_mfma_f32_16x16x32_bf16 v[228:231], a[140:143], v[80:83], v[228:231]
    v_cvt_pk_bf16_f32 v74, v52, v53
    v_mfma_f32_16x16x32_bf16 a[148:151], a[164:167], v[80:83], a[148:151]
    s_add_u32 m0, s24, 69632
    s_nop 0
    buffer_load_dwordx4 v24, s[16:19], s98 offen offset:0 lds
    v_mfma_f32_16x16x32_bf16 v[64:67], a[80:83], a[64:67], v[44:47]
    v_exp_f32 v55, v55
    v_mfma_f32_16x16x32_bf16 v[64:67], a[84:87], a[68:71], v[64:67]
    v_cvt_pk_bf16_f32 v75, v54, v55
    s_waitcnt vmcnt(21)
    ds_read_b128 a[80:83], v8 offset:32768
    v_mfma_f32_16x16x32_bf16 v[64:67], a[88:91], a[72:75], v[64:67]
    ds_read_b128 a[84:87], v9 offset:32768
    ds_read_b128 a[88:91], v10 offset:32768
    v_mfma_f32_16x16x32_bf16 v[64:67], a[92:95], a[76:79], v[64:67]
    buffer_load_dwordx4 v25, s[16:19], s98 offen offset:1024 lds
    ds_read_b128 a[92:95], v11 offset:32768
    v_mfma_f32_16x16x32_bf16 v[68:71], a[96:99], a[64:67], v[44:47]
    ds_read_b128 a[96:99], v8 offset:36864
    v_mfma_f32_16x16x32_bf16 v[68:71], a[100:103], a[68:71], v[68:71]
    ds_read_b128 a[100:103], v9 offset:36864
    v_mfma_f32_16x16x32_bf16 v[68:71], a[104:107], a[72:75], v[68:71]
    ds_read_b128 a[104:107], v10 offset:36864
    v_mfma_f32_16x16x32_bf16 v[68:71], a[108:111], a[76:79], v[68:71]
    buffer_load_dwordx4 v24, s[16:19], s98 offen offset:2048 lds
    ds_read_b128 a[108:111], v11 offset:36864
    v_mfma_f32_16x16x32_bf16 v[92:95], a[112:115], v[72:75], v[92:95]
    v_exp_f32 v56, v56
    v_mfma_f32_16x16x32_bf16 v[112:115], a[116:119], v[72:75], v[112:115]
    v_exp_f32 v57, v57
    v_mfma_f32_16x16x32_bf16 v[132:135], a[120:123], v[72:75], v[132:135]
    v_exp_f32 v58, v58
    v_mfma_f32_16x16x32_bf16 v[152:155], a[124:127], v[72:75], v[152:155]
    buffer_load_dwordx4 v25, s[16:19], s98 offen offset:3072 lds
    v_cvt_pk_bf16_f32 v76, v56, v57
    v_mfma_f32_16x16x32_bf16 v[172:175], a[128:131], v[72:75], v[172:175]
    v_exp_f32 v59, v59
    v_mfma_f32_16x16x32_bf16 v[192:195], a[132:135], v[72:75], v[192:195]
    v_exp_f32 v60, v60
    v_mfma_f32_16x16x32_bf16 v[212:215], a[136:139], v[72:75], v[212:215]
    v_cvt_pk_bf16_f32 v77, v58, v59
    v_mfma_f32_16x16x32_bf16 v[232:235], a[140:143], v[72:75], v[232:235]
    v_exp_f32 v61, v61
    v_mfma_f32_16x16x32_bf16 a[152:155], a[164:167], v[72:75], a[152:155]
    v_exp_f32 v62, v62
    s_waitcnt lgkmcnt(0)
    v_mfma_f32_16x16x32_bf16 v[48:51], a[80:83], a[0:3], v[28:31]
    v_cvt_pk_bf16_f32 v78, v60, v61
    v_mfma_f32_16x16x32_bf16 v[48:51], a[84:87], a[4:7], v[48:51]
    v_exp_f32 v63, v63
    v_mfma_f32_16x16x32_bf16 v[48:51], a[88:91], a[8:11], v[48:51]
    v_cvt_pk_bf16_f32 v79, v62, v63
    v_mfma_f32_16x16x32_bf16 v[48:51], a[92:95], a[12:15], v[48:51]
    v_exp_f32 v64, v64
    v_mfma_f32_16x16x32_bf16 v[52:55], a[96:99], a[0:3], v[28:31]
    v_exp_f32 v65, v65
    v_mfma_f32_16x16x32_bf16 v[52:55], a[100:103], a[4:7], v[52:55]
    v_exp_f32 v66, v66
    v_mfma_f32_16x16x32_bf16 v[52:55], a[104:107], a[8:11], v[52:55]
    v_cvt_pk_bf16_f32 v80, v64, v65
    v_mfma_f32_16x16x32_bf16 v[52:55], a[108:111], a[12:15], v[52:55]
    v_exp_f32 v67, v67
    v_mfma_f32_16x16x32_bf16 v[96:99], a[112:115], v[76:79], v[96:99]
    s_bfe_u32 s25, s93, 0x4000c
    s_lshl_b32 s25, s25, 13
    v_mfma_f32_16x16x32_bf16 v[116:119], a[116:119], v[76:79], v[116:119]
    s_add_u32 s98, s25, 4096
    s_add_u32 m0, s24, 32768
    v_mfma_f32_16x16x32_bf16 v[136:139], a[120:123], v[76:79], v[136:139]
    buffer_load_dwordx4 v20, s[12:15], s25 offen offset:0 lds
    v_mfma_f32_16x16x32_bf16 v[156:159], a[124:127], v[76:79], v[156:159]
    v_exp_f32 v68, v68
    v_mfma_f32_16x16x32_bf16 v[176:179], a[128:131], v[76:79], v[176:179]
    buffer_load_dwordx4 v21, s[12:15], s25 offen offset:1024 lds
    v_cvt_pk_bf16_f32 v81, v66, v67
    v_mfma_f32_16x16x32_bf16 v[196:199], a[132:135], v[76:79], v[196:199]
    v_exp_f32 v69, v69
    v_mfma_f32_16x16x32_bf16 v[216:219], a[136:139], v[76:79], v[216:219]
    v_exp_f32 v70, v70
    v_mfma_f32_16x16x32_bf16 v[236:239], a[140:143], v[76:79], v[236:239]
    v_cvt_pk_bf16_f32 v82, v68, v69
    v_mfma_f32_16x16x32_bf16 a[156:159], a[164:167], v[76:79], a[156:159]
    buffer_load_dwordx4 v22, s[12:15], s25 offen offset:2048 lds
    v_mfma_f32_16x16x32_bf16 v[56:59], a[80:83], a[16:19], v[32:35]
    v_exp_f32 v71, v71
    v_mfma_f32_16x16x32_bf16 v[56:59], a[84:87], a[20:23], v[56:59]
    v_cvt_pk_bf16_f32 v83, v70, v71
    v_mfma_f32_16x16x32_bf16 v[56:59], a[88:91], a[24:27], v[56:59]
    v_exp_f32 v48, v48
    v_mfma_f32_16x16x32_bf16 v[56:59], a[92:95], a[28:31], v[56:59]
    buffer_load_dwordx4 v23, s[12:15], s25 offen offset:3072 lds
    v_mfma_f32_16x16x32_bf16 v[60:63], a[96:99], a[16:19], v[32:35]
    v_exp_f32 v49, v49
    v_mfma_f32_16x16x32_bf16 v[60:63], a[100:103], a[20:23], v[60:63]
    v_exp_f32 v50, v50
    v_mfma_f32_16x16x32_bf16 v[60:63], a[104:107], a[24:27], v[60:63]
    v_cvt_pk_bf16_f32 v72, v48, v49
    v_mfma_f32_16x16x32_bf16 v[60:63], a[108:111], a[28:31], v[60:63]
    s_add_u32 m0, s24, 36864
    s_nop 0
    buffer_load_dwordx4 v20, s[12:15], s98 offen offset:0 lds
    v_mfma_f32_16x16x32_bf16 v[100:103], a[112:115], v[80:83], v[100:103]
    s_waitcnt vmcnt(21)
    ds_read_b64_tr_b16 a[112:113], v12 offset:32768
    ds_read_b64_tr_b16 a[114:115], v12 offset:36864
    v_mfma_f32_16x16x32_bf16 v[120:123], a[116:119], v[80:83], v[120:123]
    ds_read_b64_tr_b16 a[116:117], v13 offset:32768
    ds_read_b64_tr_b16 a[118:119], v13 offset:36864
    v_mfma_f32_16x16x32_bf16 v[140:143], a[120:123], v[80:83], v[140:143]
    v_exp_f32 v51, v51
    v_mfma_f32_16x16x32_bf16 v[160:163], a[124:127], v[80:83], v[160:163]
    buffer_load_dwordx4 v21, s[12:15], s98 offen offset:1024 lds
    ds_read_b64_tr_b16 a[120:121], v14 offset:32768
    v_mfma_f32_16x16x32_bf16 v[180:183], a[128:131], v[80:83], v[180:183]
    v_exp_f32 v52, v52
    v_mfma_f32_16x16x32_bf16 v[200:203], a[132:135], v[80:83], v[200:203]
    v_cvt_pk_bf16_f32 v73, v50, v51
    ds_read_b64_tr_b16 a[122:123], v14 offset:36864
    v_mfma_f32_16x16x32_bf16 v[220:223], a[136:139], v[80:83], v[220:223]
    v_exp_f32 v53, v53
    v_mfma_f32_16x16x32_bf16 v[240:243], a[140:143], v[80:83], v[240:243]
    buffer_load_dwordx4 v22, s[12:15], s98 offen offset:2048 lds
    ds_read_b64_tr_b16 a[124:125], v15 offset:32768
    v_mfma_f32_16x16x32_bf16 a[160:163], a[164:167], v[80:83], a[160:163]
    v_exp_f32 v54, v54
    v_mfma_f32_16x16x32_bf16 v[64:67], a[80:83], a[32:35], v[36:39]
    v_cvt_pk_bf16_f32 v74, v52, v53
    ds_read_b64_tr_b16 a[126:127], v15 offset:36864
    v_mfma_f32_16x16x32_bf16 v[64:67], a[84:87], a[36:39], v[64:67]
    v_exp_f32 v55, v55
    v_mfma_f32_16x16x32_bf16 v[64:67], a[88:91], a[40:43], v[64:67]
    v_cvt_pk_bf16_f32 v75, v54, v55
    buffer_load_dwordx4 v23, s[12:15], s98 offen offset:3072 lds
    v_mfma_f32_16x16x32_bf16 v[64:67], a[92:95], a[44:47], v[64:67]
    ds_read_b64_tr_b16 a[128:129], v16 offset:32768
    ds_read_b64_tr_b16 a[130:131], v16 offset:36864
    v_mfma_f32_16x16x32_bf16 v[68:71], a[96:99], a[32:35], v[36:39]
    ds_read_b64_tr_b16 a[132:133], v17 offset:32768
    ds_read_b64_tr_b16 a[134:135], v17 offset:36864
    v_mfma_f32_16x16x32_bf16 v[68:71], a[100:103], a[36:39], v[68:71]
    ds_read_b64_tr_b16 a[136:137], v18 offset:32768
    ds_read_b64_tr_b16 a[138:139], v18 offset:36864
    v_mfma_f32_16x16x32_bf16 v[68:71], a[104:107], a[40:43], v[68:71]
    ds_read_b64_tr_b16 a[140:141], v19 offset:32768
    ds_read_b64_tr_b16 a[142:143], v19 offset:36864
    v_mfma_f32_16x16x32_bf16 v[68:71], a[108:111], a[44:47], v[68:71]
    v_exp_f32 v56, v56
    s_waitcnt lgkmcnt(8)
    v_mfma_f32_16x16x32_bf16 v[84:87], a[112:115], v[72:75], v[84:87]
    v_exp_f32 v57, v57
    v_mfma_f32_16x16x32_bf16 v[104:107], a[116:119], v[72:75], v[104:107]
    v_exp_f32 v58, v58
    v_mfma_f32_16x16x32_bf16 v[124:127], a[120:123], v[72:75], v[124:127]
    v_cvt_pk_bf16_f32 v76, v56, v57
    v_mfma_f32_16x16x32_bf16 v[144:147], a[124:127], v[72:75], v[144:147]
    v_exp_f32 v59, v59
    s_waitcnt lgkmcnt(2)
    v_mfma_f32_16x16x32_bf16 v[164:167], a[128:131], v[72:75], v[164:167]
    v_exp_f32 v60, v60
    v_mfma_f32_16x16x32_bf16 v[184:187], a[132:135], v[72:75], v[184:187]
    v_cvt_pk_bf16_f32 v77, v58, v59
    v_mfma_f32_16x16x32_bf16 v[204:207], a[136:139], v[72:75], v[204:207]
    v_exp_f32 v61, v61
    s_waitcnt lgkmcnt(0)
    v_mfma_f32_16x16x32_bf16 v[224:227], a[140:143], v[72:75], v[224:227]
    v_exp_f32 v62, v62
    v_mfma_f32_16x16x32_bf16 a[144:147], a[164:167], v[72:75], a[144:147]
    v_cvt_pk_bf16_f32 v78, v60, v61
    v_mfma_f32_16x16x32_bf16 v[48:51], a[80:83], a[48:51], v[40:43]
    s_add_u32 m0, s24, 98304
    s_nop 0
    buffer_load_dwordx4 v24, s[16:19], s25 offen offset:0 lds
    v_mfma_f32_16x16x32_bf16 v[48:51], a[84:87], a[52:55], v[48:51]
    v_exp_f32 v63, v63
    v_mfma_f32_16x16x32_bf16 v[48:51], a[88:91], a[56:59], v[48:51]
    v_cvt_pk_bf16_f32 v79, v62, v63
    v_mfma_f32_16x16x32_bf16 v[48:51], a[92:95], a[60:63], v[48:51]
    v_exp_f32 v64, v64
    v_mfma_f32_16x16x32_bf16 v[52:55], a[96:99], a[48:51], v[40:43]
    buffer_load_dwordx4 v25, s[16:19], s25 offen offset:1024 lds
    v_mfma_f32_16x16x32_bf16 v[52:55], a[100:103], a[52:55], v[52:55]
    v_exp_f32 v65, v65
    v_mfma_f32_16x16x32_bf16 v[52:55], a[104:107], a[56:59], v[52:55]
    v_exp_f32 v66, v66
    v_mfma_f32_16x16x32_bf16 v[52:55], a[108:111], a[60:63], v[52:55]
    v_cvt_pk_bf16_f32 v80, v64, v65
    v_mfma_f32_16x16x32_bf16 v[88:91], a[112:115], v[76:79], v[88:91]
    buffer_load_dwordx4 v24, s[16:19], s25 offen offset:2048 lds
    v_mfma_f32_16x16x32_bf16 v[108:111], a[116:119], v[76:79], v[108:111]
    v_exp_f32 v67, v67
    v_mfma_f32_16x16x32_bf16 v[128:131], a[120:123], v[76:79], v[128:131]
    v_exp_f32 v68, v68
    v_mfma_f32_16x16x32_bf16 v[148:151], a[124:127], v[76:79], v[148:151]
    v_cvt_pk_bf16_f32 v81, v66, v67
    v_mfma_f32_16x16x32_bf16 v[168:171], a[128:131], v[76:79], v[168:171]
    buffer_load_dwordx4 v25, s[16:19], s25 offen offset:3072 lds
    v_mfma_f32_16x16x32_bf16 v[188:191], a[132:135], v[76:79], v[188:191]
    v_exp_f32 v69, v69
    v_mfma_f32_16x16x32_bf16 v[208:211], a[136:139], v[76:79], v[208:211]
    v_exp_f32 v70, v70
    v_mfma_f32_16x16x32_bf16 v[228:231], a[140:143], v[76:79], v[228:231]
    v_cvt_pk_bf16_f32 v82, v68, v69
    v_mfma_f32_16x16x32_bf16 a[148:151], a[164:167], v[76:79], a[148:151]
    s_add_u32 m0, s24, 102400
    s_nop 0
    buffer_load_dwordx4 v24, s[16:19], s98 offen offset:0 lds
    v_mfma_f32_16x16x32_bf16 v[56:59], a[80:83], a[64:67], v[44:47]
    v_exp_f32 v71, v71
    v_mfma_f32_16x16x32_bf16 v[56:59], a[84:87], a[68:71], v[56:59]
    v_cvt_pk_bf16_f32 v83, v70, v71
    s_waitcnt vmcnt(21)
    ds_read_b128 a[80:83], v8 offset:0
    v_mfma_f32_16x16x32_bf16 v[56:59], a[88:91], a[72:75], v[56:59]
    ds_read_b128 a[84:87], v9 offset:0
    ds_read_b128 a[88:91], v10 offset:0
    v_mfma_f32_16x16x32_bf16 v[56:59], a[92:95], a[76:79], v[56:59]
    buffer_load_dwordx4 v25, s[16:19], s98 offen offset:1024 lds
    ds_read_b128 a[92:95], v11 offset:0
    v_mfma_f32_16x16x32_bf16 v[60:63], a[96:99], a[64:67], v[44:47]
    ds_read_b128 a[96:99], v8 offset:4096
    v_mfma_f32_16x16x32_bf16 v[60:63], a[100:103], a[68:71], v[60:63]
    ds_read_b128 a[100:103], v9 offset:4096
    v_mfma_f32_16x16x32_bf16 v[60:63], a[104:107], a[72:75], v[60:63]
    ds_read_b128 a[104:107], v10 offset:4096
    v_mfma_f32_16x16x32_bf16 v[60:63], a[108:111], a[76:79], v[60:63]
    buffer_load_dwordx4 v24, s[16:19], s98 offen offset:2048 lds
    ds_read_b128 a[108:111], v11 offset:4096
    v_mfma_f32_16x16x32_bf16 v[92:95], a[112:115], v[80:83], v[92:95]
    v_exp_f32 v48, v48
    v_mfma_f32_16x16x32_bf16 v[112:115], a[116:119], v[80:83], v[112:115]
    v_exp_f32 v49, v49
    v_mfma_f32_16x16x32_bf16 v[132:135], a[120:123], v[80:83], v[132:135]
    v_exp_f32 v50, v50
    v_mfma_f32_16x16x32_bf16 v[152:155], a[124:127], v[80:83], v[152:155]
    buffer_load_dwordx4 v25, s[16:19], s98 offen offset:3072 lds
    v_cvt_pk_bf16_f32 v72, v48, v49
    v_mfma_f32_16x16x32_bf16 v[172:175], a[128:131], v[80:83], v[172:175]
    v_exp_f32 v51, v51
    v_mfma_f32_16x16x32_bf16 v[192:195], a[132:135], v[80:83], v[192:195]
    v_exp_f32 v52, v52
    v_mfma_f32_16x16x32_bf16 v[212:215], a[136:139], v[80:83], v[212:215]
    v_cvt_pk_bf16_f32 v73, v50, v51
    v_mfma_f32_16x16x32_bf16 v[232:235], a[140:143], v[80:83], v[232:235]
    v_exp_f32 v53, v53
    v_mfma_f32_16x16x32_bf16 a[152:155], a[164:167], v[80:83], a[152:155]
    v_exp_f32 v54, v54
    s_waitcnt lgkmcnt(0)
    v_mfma_f32_16x16x32_bf16 v[64:67], a[80:83], a[0:3], v[28:31]
    v_cvt_pk_bf16_f32 v74, v52, v53
    v_mfma_f32_16x16x32_bf16 v[64:67], a[84:87], a[4:7], v[64:67]
    v_exp_f32 v55, v55
    v_mfma_f32_16x16x32_bf16 v[64:67], a[88:91], a[8:11], v[64:67]
    v_cvt_pk_bf16_f32 v75, v54, v55
    v_mfma_f32_16x16x32_bf16 v[64:67], a[92:95], a[12:15], v[64:67]
    v_exp_f32 v56, v56
    v_mfma_f32_16x16x32_bf16 v[68:71], a[96:99], a[0:3], v[28:31]
    v_exp_f32 v57, v57
    v_mfma_f32_16x16x32_bf16 v[68:71], a[100:103], a[4:7], v[68:71]
    v_exp_f32 v58, v58
    v_mfma_f32_16x16x32_bf16 v[68:71], a[104:107], a[8:11], v[68:71]
    v_cvt_pk_bf16_f32 v76, v56, v57
    v_mfma_f32_16x16x32_bf16 v[68:71], a[108:111], a[12:15], v[68:71]
    v_exp_f32 v59, v59
    v_mfma_f32_16x16x32_bf16 v[96:99], a[112:115], v[72:75], v[96:99]
    s_bfe_u32 s25, s93, 0x40010
    s_lshl_b32 s25, s25, 13
    v_mfma_f32_16x16x32_bf16 v[116:119], a[116:119], v[72:75], v[116:119]
    s_add_u32 s98, s25, 4096
    s_add_u32 m0, s24, 0
    v_mfma_f32_16x16x32_bf16 v[136:139], a[120:123], v[72:75], v[136:139]
    buffer_load_dwordx4 v20, s[12:15], s25 offen offset:0 lds
    v_mfma_f32_16x16x32_bf16 v[156:159], a[124:127], v[72:75], v[156:159]
    v_exp_f32 v60, v60
    v_mfma_f32_16x16x32_bf16 v[176:179], a[128:131], v[72:75], v[176:179]
    buffer_load_dwordx4 v21, s[12:15], s25 offen offset:1024 lds
    v_cvt_pk_bf16_f32 v77, v58, v59
    v_mfma_f32_16x16x32_bf16 v[196:199], a[132:135], v[72:75], v[196:199]
    v_exp_f32 v61, v61
    v_mfma_f32_16x16x32_bf16 v[216:219], a[136:139], v[72:75], v[216:219]
    v_exp_f32 v62, v62
    v_mfma_f32_16x16x32_bf16 v[236:239], a[140:143], v[72:75], v[236:239]
    v_cvt_pk_bf16_f32 v78, v60, v61
    v_mfma_f32_16x16x32_bf16 a[156:159], a[164:167], v[72:75], a[156:159]
    buffer_load_dwordx4 v22, s[12:15], s25 offen offset:2048 lds
    v_mfma_f32_16x16x32_bf16 v[48:51], a[80:83], a[16:19], v[32:35]
    v_exp_f32 v63, v63
    v_mfma_f32_16x16x32_bf16 v[48:51], a[84:87], a[20:23], v[48:51]
    v_cvt_pk_bf16_f32 v79, v62, v63
    v_mfma_f32_16x16x32_bf16 v[48:51], a[88:91], a[24:27], v[48:51]
    v_exp_f32 v64, v64
    v_mfma_f32_16x16x32_bf16 v[48:51], a[92:95], a[28:31], v[48:51]
    buffer_load_dwordx4 v23, s[12:15], s25 offen offset:3072 lds
    v_mfma_f32_16x16x32_bf16 v[52:55], a[96:99], a[16:19], v[32:35]
    v_exp_f32 v65, v65
    v_mfma_f32_16x16x32_bf16 v[52:55], a[100:103], a[20:23], v[52:55]
    v_exp_f32 v66, v66
    v_mfma_f32_16x16x32_bf16 v[52:55], a[104:107], a[24:27], v[52:55]
    v_cvt_pk_bf16_f32 v80, v64, v65
    v_mfma_f32_16x16x32_bf16 v[52:55], a[108:111], a[28:31], v[52:55]
    s_add_u32 m0, s24, 4096
    s_nop 0
    buffer_load_dwordx4 v20, s[12:15], s98 offen offset:0 lds
    v_mfma_f32_16x16x32_bf16 v[100:103], a[112:115], v[76:79], v[100:103]
    s_waitcnt vmcnt(21)
    ds_read_b64_tr_b16 a[112:113], v12 offset:0
    ds_read_b64_tr_b16 a[114:115], v12 offset:4096
    v_mfma_f32_16x16x32_bf16 v[120:123], a[116:119], v[76:79], v[120:123]
    ds_read_b64_tr_b16 a[116:117], v13 offset:0
    ds_read_b64_tr_b16 a[118:119], v13 offset:4096
    v_mfma_f32_16x16x32_bf16 v[140:143], a[120:123], v[76:79], v[140:143]
    v_exp_f32 v67, v67
    v_mfma_f32_16x16x32_bf16 v[160:163], a[124:127], v[76:79], v[160:163]
    buffer_load_dwordx4 v21, s[12:15], s98 offen offset:1024 lds
    ds_read_b64_tr_b16 a[120:121], v14 offset:0
    v_mfma_f32_16x16x32_bf16 v[180:183], a[128:131], v[76:79], v[180:183]
    v_exp_f32 v68, v68
    v_mfma_f32_16x16x32_bf16 v[200:203], a[132:135], v[76:79], v[200:203]
    v_cvt_pk_bf16_f32 v81, v66, v67
    ds_read_b64_tr_b16 a[122:123], v14 offset:4096
    v_mfma_f32_16x16x32_bf16 v[220:223], a[136:139], v[76:79], v[220:223]
    v_exp_f32 v69, v69
    v_mfma_f32_16x16x32_bf16 v[240:243], a[140:143], v[76:79], v[240:243]
    buffer_load_dwordx4 v22, s[12:15], s98 offen offset:2048 lds
    ds_read_b64_tr_b16 a[124:125], v15 offset:0
    v_mfma_f32_16x16x32_bf16 a[160:163], a[164:167], v[76:79], a[160:163]
    v_exp_f32 v70, v70
    v_mfma_f32_16x16x32_bf16 v[56:59], a[80:83], a[32:35], v[36:39]
    v_cvt_pk_bf16_f32 v82, v68, v69
    ds_read_b64_tr_b16 a[126:127], v15 offset:4096
    v_mfma_f32_16x16x32_bf16 v[56:59], a[84:87], a[36:39], v[56:59]
    v_exp_f32 v71, v71
    v_mfma_f32_16x16x32_bf16 v[56:59], a[88:91], a[40:43], v[56:59]
    v_cvt_pk_bf16_f32 v83, v70, v71
    buffer_load_dwordx4 v23, s[12:15], s98 offen offset:3072 lds
    v_mfma_f32_16x16x32_bf16 v[56:59], a[92:95], a[44:47], v[56:59]
    ds_read_b64_tr_b16 a[128:129], v16 offset:0
    ds_read_b64_tr_b16 a[130:131], v16 offset:4096
    v_mfma_f32_16x16x32_bf16 v[60:63], a[96:99], a[32:35], v[36:39]
    ds_read_b64_tr_b16 a[132:133], v17 offset:0
    ds_read_b64_tr_b16 a[134:135], v17 offset:4096
    v_mfma_f32_16x16x32_bf16 v[60:63], a[100:103], a[36:39], v[60:63]
    ds_read_b64_tr_b16 a[136:137], v18 offset:0
    ds_read_b64_tr_b16 a[138:139], v18 offset:4096
    v_mfma_f32_16x16x32_bf16 v[60:63], a[104:107], a[40:43], v[60:63]
    ds_read_b64_tr_b16 a[140:141], v19 offset:0
    ds_read_b64_tr_b16 a[142:143], v19 offset:4096
    v_mfma_f32_16x16x32_bf16 v[60:63], a[108:111], a[44:47], v[60:63]
    v_exp_f32 v48, v48
    s_waitcnt lgkmcnt(8)
    v_mfma_f32_16x16x32_bf16 v[84:87], a[112:115], v[80:83], v[84:87]
    v_exp_f32 v49, v49
    v_mfma_f32_16x16x32_bf16 v[104:107], a[116:119], v[80:83], v[104:107]
    v_exp_f32 v50, v50
    v_mfma_f32_16x16x32_bf16 v[124:127], a[120:123], v[80:83], v[124:127]
    v_cvt_pk_bf16_f32 v72, v48, v49
    v_mfma_f32_16x16x32_bf16 v[144:147], a[124:127], v[80:83], v[144:147]
    v_exp_f32 v51, v51
    s_waitcnt lgkmcnt(2)
    v_mfma_f32_16x16x32_bf16 v[164:167], a[128:131], v[80:83], v[164:167]
    v_exp_f32 v52, v52
    v_mfma_f32_16x16x32_bf16 v[184:187], a[132:135], v[80:83], v[184:187]
    v_cvt_pk_bf16_f32 v73, v50, v51
    v_mfma_f32_16x16x32_bf16 v[204:207], a[136:139], v[80:83], v[204:207]
    v_exp_f32 v53, v53
    s_waitcnt lgkmcnt(0)
    v_mfma_f32_16x16x32_bf16 v[224:227], a[140:143], v[80:83], v[224:227]
    v_exp_f32 v54, v54
    v_mfma_f32_16x16x32_bf16 a[144:147], a[164:167], v[80:83], a[144:147]
    v_cvt_pk_bf16_f32 v74, v52, v53
    v_mfma_f32_16x16x32_bf16 v[64:67], a[80:83], a[48:51], v[40:43]
    s_add_u32 m0, s24, 65536
    s_nop 0
    buffer_load_dwordx4 v24, s[16:19], s25 offen offset:0 lds
    v_mfma_f32_16x16x32_bf16 v[64:67], a[84:87], a[52:55], v[64:67]
    v_exp_f32 v55, v55
    v_mfma_f32_16x16x32_bf16 v[64:67], a[88:91], a[56:59], v[64:67]
    v_cvt_pk_bf16_f32 v75, v54, v55
    v_mfma_f32_16x16x32_bf16 v[64:67], a[92:95], a[60:63], v[64:67]
    v_exp_f32 v56, v56
    v_mfma_f32_16x16x32_bf16 v[68:71], a[96:99], a[48:51], v[40:43]
    buffer_load_dwordx4 v25, s[16:19], s25 offen offset:1024 lds
    v_mfma_f32_16x16x32_bf16 v[68:71], a[100:103], a[52:55], v[68:71]
    v_exp_f32 v57, v57
    v_mfma_f32_16x16x32_bf16 v[68:71], a[104:107], a[56:59], v[68:71]
    v_exp_f32 v58, v58
    v_mfma_f32_16x16x32_bf16 v[68:71], a[108:111], a[60:63], v[68:71]
    v_cvt_pk_bf16_f32 v76, v56, v57
    v_mfma_f32_16x16x32_bf16 v[88:91], a[112:115], v[72:75], v[88:91]
    buffer_load_dwordx4 v24, s[16:19], s25 offen offset:2048 lds
    v_mfma_f32_16x16x32_bf16 v[108:111], a[116:119], v[72:75], v[108:111]
    v_exp_f32 v59, v59
    v_mfma_f32_16x16x32_bf16 v[128:131], a[120:123], v[72:75], v[128:131]
    v_exp_f32 v60, v60
    v_mfma_f32_16x16x32_bf16 v[148:151], a[124:127], v[72:75], v[148:151]
    v_cvt_pk_bf16_f32 v77, v58, v59
    v_mfma_f32_16x16x32_bf16 v[168:171], a[128:131], v[72:75], v[168:171]
    buffer_load_dwordx4 v25, s[16:19], s25 offen offset:3072 lds
    v_mfma_f32_16x16x32_bf16 v[188:191], a[132:135], v[72:75], v[188:191]
    v_exp_f32 v61, v61
    v_mfma_f32_16x16x32_bf16 v[208:211], a[136:139], v[72:75], v[208:211]
    v_exp_f32 v62, v62
    v_mfma_f32_16x16x32_bf16 v[228:231], a[140:143], v[72:75], v[228:231]
    v_cvt_pk_bf16_f32 v78, v60, v61
    v_mfma_f32_16x16x32_bf16 a[148:151], a[164:167], v[72:75], a[148:151]
    s_add_u32 m0, s24, 69632
    s_nop 0
    buffer_load_dwordx4 v24, s[16:19], s98 offen offset:0 lds
    v_mfma_f32_16x16x32_bf16 v[48:51], a[80:83], a[64:67], v[44:47]
    v_exp_f32 v63, v63
    v_mfma_f32_16x16x32_bf16 v[48:51], a[84:87], a[68:71], v[48:51]
    v_cvt_pk_bf16_f32 v79, v62, v63
    s_waitcnt vmcnt(21)
    ds_read_b128 a[80:83], v8 offset:32768
    v_mfma_f32_16x16x32_bf16 v[48:51], a[88:91], a[72:75], v[48:51]
    ds_read_b128 a[84:87], v9 offset:32768
    ds_read_b128 a[88:91], v10 offset:32768
    v_mfma_f32_16x16x32_bf16 v[48:51], a[92:95], a[76:79], v[48:51]
    buffer_load_dwordx4 v25, s[16:19], s98 offen offset:1024 lds
    ds_read_b128 a[92:95], v11 offset:32768
    v_mfma_f32_16x16x32_bf16 v[52:55], a[96:99], a[64:67], v[44:47]
    ds_read_b128 a[96:99], v8 offset:36864
    v_mfma_f32_16x16x32_bf16 v[52:55], a[100:103], a[68:71], v[52:55]
    ds_read_b128 a[100:103], v9 offset:36864
    v_mfma_f32_16x16x32_bf16 v[52:55], a[104:107], a[72:75], v[52:55]
    ds_read_b128 a[104:107], v10 offset:36864
    v_mfma_f32_16x16x32_bf16 v[52:55], a[108:111], a[76:79], v[52:55]
    buffer_load_dwordx4 v24, s[16:19], s98 offen offset:2048 lds
    ds_read_b128 a[108:111], v11 offset:36864
    v_mfma_f32_16x16x32_bf16 v[92:95], a[112:115], v[76:79], v[92:95]
    v_exp_f32 v64, v64
    v_mfma_f32_16x16x32_bf16 v[112:115], a[116:119], v[76:79], v[112:115]
    v_exp_f32 v65, v65
    v_mfma_f32_16x16x32_bf16 v[132:135], a[120:123], v[76:79], v[132:135]
    v_exp_f32 v66, v66
    v_mfma_f32_16x16x32_bf16 v[152:155], a[124:127], v[76:79], v[152:155]
    buffer_load_dwordx4 v25, s[16:19], s98 offen offset:3072 lds
    v_cvt_pk_bf16_f32 v80, v64, v65
    v_mfma_f32_16x16x32_bf16 v[172:175], a[128:131], v[76:79], v[172:175]
    v_exp_f32 v67, v67
    v_mfma_f32_16x16x32_bf16 v[192:195], a[132:135], v[76:79], v[192:195]
    v_exp_f32 v68, v68
    v_mfma_f32_16x16x32_bf16 v[212:215], a[136:139], v[76:79], v[212:215]
    v_cvt_pk_bf16_f32 v81, v66, v67
    v_mfma_f32_16x16x32_bf16 v[232:235], a[140:143], v[76:79], v[232:235]
    v_exp_f32 v69, v69
    v_mfma_f32_16x16x32_bf16 a[152:155], a[164:167], v[76:79], a[152:155]
    v_exp_f32 v70, v70
    s_waitcnt lgkmcnt(0)
    v_mfma_f32_16x16x32_bf16 v[56:59], a[80:83], a[0:3], v[28:31]
    v_cvt_pk_bf16_f32 v82, v68, v69
    v_mfma_f32_16x16x32_bf16 v[56:59], a[84:87], a[4:7], v[56:59]
    v_exp_f32 v71, v71
    v_mfma_f32_16x16x32_bf16 v[56:59], a[88:91], a[8:11], v[56:59]
    v_cvt_pk_bf16_f32 v83, v70, v71
    v_mfma_f32_16x16x32_bf16 v[56:59], a[92:95], a[12:15], v[56:59]
    v_exp_f32 v48, v48
    v_mfma_f32_16x16x32_bf16 v[60:63], a[96:99], a[0:3], v[28:31]
    v_exp_f32 v49, v49
    v_mfma_f32_16x16x32_bf16 v[60:63], a[100:103], a[4:7], v[60:63]
    v_exp_f32 v50, v50
    v_mfma_f32_16x16x32_bf16 v[60:63], a[104:107], a[8:11], v[60:63]
    v_cvt_pk_bf16_f32 v72, v48, v49
    v_mfma_f32_16x16x32_bf16 v[60:63], a[108:111], a[12:15], v[60:63]
    v_exp_f32 v51, v51
    v_mfma_f32_16x16x32_bf16 v[96:99], a[112:115], v[80:83], v[96:99]
    s_bfe_u32 s25, s93, 0x40014
    s_lshl_b32 s25, s25, 13
    v_mfma_f32_16x16x32_bf16 v[116:119], a[116:119], v[80:83], v[116:119]
    s_add_u32 s98, s25, 4096
    s_add_u32 m0, s24, 32768
    v_mfma_f32_16x16x32_bf16 v[136:139], a[120:123], v[80:83], v[136:139]
    buffer_load_dwordx4 v20, s[12:15], s25 offen offset:0 lds
    v_mfma_f32_16x16x32_bf16 v[156:159], a[124:127], v[80:83], v[156:159]
    v_exp_f32 v52, v52
    v_mfma_f32_16x16x32_bf16 v[176:179], a[128:131], v[80:83], v[176:179]
    buffer_load_dwordx4 v21, s[12:15], s25 offen offset:1024 lds
    v_cvt_pk_bf16_f32 v73, v50, v51
    v_mfma_f32_16x16x32_bf16 v[196:199], a[132:135], v[80:83], v[196:199]
    v_exp_f32 v53, v53
    v_mfma_f32_16x16x32_bf16 v[216:219], a[136:139], v[80:83], v[216:219]
    v_exp_f32 v54, v54
    v_mfma_f32_16x16x32_bf16 v[236:239], a[140:143], v[80:83], v[236:239]
    v_cvt_pk_bf16_f32 v74, v52, v53
    v_mfma_f32_16x16x32_bf16 a[156:159], a[164:167], v[80:83], a[156:159]
    buffer_load_dwordx4 v22, s[12:15], s25 offen offset:2048 lds
    v_mfma_f32_16x16x32_bf16 v[64:67], a[80:83], a[16:19], v[32:35]
    v_exp_f32 v55, v55
    v_mfma_f32_16x16x32_bf16 v[64:67], a[84:87], a[20:23], v[64:67]
    v_cvt_pk_bf16_f32 v75, v54, v55
    v_mfma_f32_16x16x32_bf16 v[64:67], a[88:91], a[24:27], v[64:67]
    v_exp_f32 v56, v56
    v_mfma_f32_16x16x32_bf16 v[64:67], a[92:95], a[28:31], v[64:67]
    buffer_load_dwordx4 v23, s[12:15], s25 offen offset:3072 lds
    v_mfma_f32_16x16x32_bf16 v[68:71], a[96:99], a[16:19], v[32:35]
    v_exp_f32 v57, v57
    v_mfma_f32_16x16x32_bf16 v[68:71], a[100:103], a[20:23], v[68:71]
    v_exp_f32 v58, v58
    v_mfma_f32_16x16x32_bf16 v[68:71], a[104:107], a[24:27], v[68:71]
    v_cvt_pk_bf16_f32 v76, v56, v57
    v_mfma_f32_16x16x32_bf16 v[68:71], a[108:111], a[28:31], v[68:71]
    s_add_u32 m0, s24, 36864
    s_nop 0
    buffer_load_dwordx4 v20, s[12:15], s98 offen offset:0 lds
    v_mfma_f32_16x16x32_bf16 v[100:103], a[112:115], v[72:75], v[100:103]
    s_waitcnt vmcnt(21)
    ds_read_b64_tr_b16 a[112:113], v12 offset:32768
    ds_read_b64_tr_b16 a[114:115], v12 offset:36864
    v_mfma_f32_16x16x32_bf16 v[120:123], a[116:119], v[72:75], v[120:123]
    ds_read_b64_tr_b16 a[116:117], v13 offset:32768
    ds_read_b64_tr_b16 a[118:119], v13 offset:36864
    v_mfma_f32_16x16x32_bf16 v[140:143], a[120:123], v[72:75], v[140:143]
    v_exp_f32 v59, v59
    v_mfma_f32_16x16x32_bf16 v[160:163], a[124:127], v[72:75], v[160:163]
    buffer_load_dwordx4 v21, s[12:15], s98 offen offset:1024 lds
    ds_read_b64_tr_b16 a[120:121], v14 offset:32768
    v_mfma_f32_16x16x32_bf16 v[180:183], a[128:131], v[72:75], v[180:183]
    v_exp_f32 v60, v60
    v_mfma_f32_16x16x32_bf16 v[200:203], a[132:135], v[72:75], v[200:203]
    v_cvt_pk_bf16_f32 v77, v58, v59
    ds_read_b64_tr_b16 a[122:123], v14 offset:36864
    v_mfma_f32_16x16x32_bf16 v[220:223], a[136:139], v[72:75], v[220:223]
    v_exp_f32 v61, v61
    v_mfma_f32_16x16x32_bf16 v[240:243], a[140:143], v[72:75], v[240:243]
    buffer_load_dwordx4 v22, s[12:15], s98 offen offset:2048 lds
    ds_read_b64_tr_b16 a[124:125], v15 offset:32768
    v_mfma_f32_16x16x32_bf16 a[160:163], a[164:167], v[72:75], a[160:163]
    v_exp_f32 v62, v62
    v_mfma_f32_16x16x32_bf16 v[48:51], a[80:83], a[32:35], v[36:39]
    v_cvt_pk_bf16_f32 v78, v60, v61
    ds_read_b64_tr_b16 a[126:127], v15 offset:36864
    v_mfma_f32_16x16x32_bf16 v[48:51], a[84:87], a[36:39], v[48:51]
    v_exp_f32 v63, v63
    v_mfma_f32_16x16x32_bf16 v[48:51], a[88:91], a[40:43], v[48:51]
    v_cvt_pk_bf16_f32 v79, v62, v63
    buffer_load_dwordx4 v23, s[12:15], s98 offen offset:3072 lds
    v_mfma_f32_16x16x32_bf16 v[48:51], a[92:95], a[44:47], v[48:51]
    ds_read_b64_tr_b16 a[128:129], v16 offset:32768
    ds_read_b64_tr_b16 a[130:131], v16 offset:36864
    v_mfma_f32_16x16x32_bf16 v[52:55], a[96:99], a[32:35], v[36:39]
    ds_read_b64_tr_b16 a[132:133], v17 offset:32768
    ds_read_b64_tr_b16 a[134:135], v17 offset:36864
    v_mfma_f32_16x16x32_bf16 v[52:55], a[100:103], a[36:39], v[52:55]
    ds_read_b64_tr_b16 a[136:137], v18 offset:32768
    ds_read_b64_tr_b16 a[138:139], v18 offset:36864
    v_mfma_f32_16x16x32_bf16 v[52:55], a[104:107], a[40:43], v[52:55]
    ds_read_b64_tr_b16 a[140:141], v19 offset:32768
    ds_read_b64_tr_b16 a[142:143], v19 offset:36864
    v_mfma_f32_16x16x32_bf16 v[52:55], a[108:111], a[44:47], v[52:55]
    v_exp_f32 v64, v64
    s_waitcnt lgkmcnt(8)
    v_mfma_f32_16x16x32_bf16 v[84:87], a[112:115], v[76:79], v[84:87]
    v_exp_f32 v65, v65
    v_mfma_f32_16x16x32_bf16 v[104:107], a[116:119], v[76:79], v[104:107]
    v_exp_f32 v66, v66
    v_mfma_f32_16x16x32_bf16 v[124:127], a[120:123], v[76:79], v[124:127]
    v_cvt_pk_bf16_f32 v80, v64, v65
    v_mfma_f32_16x16x32_bf16 v[144:147], a[124:127], v[76:79], v[144:147]
    v_exp_f32 v67, v67
    s_waitcnt lgkmcnt(2)
    v_mfma_f32_16x16x32_bf16 v[164:167], a[128:131], v[76:79], v[164:167]
    v_exp_f32 v68, v68
    v_mfma_f32_16x16x32_bf16 v[184:187], a[132:135], v[76:79], v[184:187]
    v_cvt_pk_bf16_f32 v81, v66, v67
    v_mfma_f32_16x16x32_bf16 v[204:207], a[136:139], v[76:79], v[204:207]
    v_exp_f32 v69, v69
    s_waitcnt lgkmcnt(0)
    v_mfma_f32_16x16x32_bf16 v[224:227], a[140:143], v[76:79], v[224:227]
    v_exp_f32 v70, v70
    v_mfma_f32_16x16x32_bf16 a[144:147], a[164:167], v[76:79], a[144:147]
    v_cvt_pk_bf16_f32 v82, v68, v69
    v_mfma_f32_16x16x32_bf16 v[56:59], a[80:83], a[48:51], v[40:43]
    s_add_u32 m0, s24, 98304
    s_nop 0
    buffer_load_dwordx4 v24, s[16:19], s25 offen offset:0 lds
    v_mfma_f32_16x16x32_bf16 v[56:59], a[84:87], a[52:55], v[56:59]
    v_exp_f32 v71, v71
    v_mfma_f32_16x16x32_bf16 v[56:59], a[88:91], a[56:59], v[56:59]
    v_cvt_pk_bf16_f32 v83, v70, v71
    v_mfma_f32_16x16x32_bf16 v[56:59], a[92:95], a[60:63], v[56:59]
    v_exp_f32 v48, v48
    v_mfma_f32_16x16x32_bf16 v[60:63], a[96:99], a[48:51], v[40:43]
    buffer_load_dwordx4 v25, s[16:19], s25 offen offset:1024 lds
    v_mfma_f32_16x16x32_bf16 v[60:63], a[100:103], a[52:55], v[60:63]
    v_exp_f32 v49, v49
    v_mfma_f32_16x16x32_bf16 v[60:63], a[104:107], a[56:59], v[60:63]
    v_exp_f32 v50, v50
    v_mfma_f32_16x16x32_bf16 v[60:63], a[108:111], a[60:63], v[60:63]
    v_cvt_pk_bf16_f32 v72, v48, v49
    v_mfma_f32_16x16x32_bf16 v[88:91], a[112:115], v[80:83], v[88:91]
    buffer_load_dwordx4 v24, s[16:19], s25 offen offset:2048 lds
    v_mfma_f32_16x16x32_bf16 v[108:111], a[116:119], v[80:83], v[108:111]
    v_exp_f32 v51, v51
    v_mfma_f32_16x16x32_bf16 v[128:131], a[120:123], v[80:83], v[128:131]
    v_exp_f32 v52, v52
    v_mfma_f32_16x16x32_bf16 v[148:151], a[124:127], v[80:83], v[148:151]
    v_cvt_pk_bf16_f32 v73, v50, v51
    v_mfma_f32_16x16x32_bf16 v[168:171], a[128:131], v[80:83], v[168:171]
    buffer_load_dwordx4 v25, s[16:19], s25 offen offset:3072 lds
    v_mfma_f32_16x16x32_bf16 v[188:191], a[132:135], v[80:83], v[188:191]
    v_exp_f32 v53, v53
    v_mfma_f32_16x16x32_bf16 v[208:211], a[136:139], v[80:83], v[208:211]
    v_exp_f32 v54, v54
    v_mfma_f32_16x16x32_bf16 v[228:231], a[140:143], v[80:83], v[228:231]
    v_cvt_pk_bf16_f32 v74, v52, v53
    v_mfma_f32_16x16x32_bf16 a[148:151], a[164:167], v[80:83], a[148:151]
    s_add_u32 m0, s24, 102400
    s_nop 0
    buffer_load_dwordx4 v24, s[16:19], s98 offen offset:0 lds
    v_mfma_f32_16x16x32_bf16 v[64:67], a[80:83], a[64:67], v[44:47]
    v_exp_f32 v55, v55
    v_mfma_f32_16x16x32_bf16 v[64:67], a[84:87], a[68:71], v[64:67]
    v_cvt_pk_bf16_f32 v75, v54, v55
    s_waitcnt vmcnt(21)
    ds_read_b128 a[80:83], v8 offset:0
    v_mfma_f32_16x16x32_bf16 v[64:67], a[88:91], a[72:75], v[64:67]
    ds_read_b128 a[84:87], v9 offset:0
    ds_read_b128 a[88:91], v10 offset:0
    v_mfma_f32_16x16x32_bf16 v[64:67], a[92:95], a[76:79], v[64:67]
    buffer_load_dwordx4 v25, s[16:19], s98 offen offset:1024 lds
    ds_read_b128 a[92:95], v11 offset:0
    v_mfma_f32_16x16x32_bf16 v[68:71], a[96:99], a[64:67], v[44:47]
    ds_read_b128 a[96:99], v8 offset:4096
    v_mfma_f32_16x16x32_bf16 v[68:71], a[100:103], a[68:71], v[68:71]
    ds_read_b128 a[100:103], v9 offset:4096
    v_mfma_f32_16x16x32_bf16 v[68:71], a[104:107], a[72:75], v[68:71]
    ds_read_b128 a[104:107], v10 offset:4096
    v_mfma_f32_16x16x32_bf16 v[68:71], a[108:111], a[76:79], v[68:71]
    buffer_load_dwordx4 v24, s[16:19], s98 offen offset:2048 lds
    ds_read_b128 a[108:111], v11 offset:4096
    v_mfma_f32_16x16x32_bf16 v[92:95], a[112:115], v[72:75], v[92:95]
    v_exp_f32 v56, v56
    v_mfma_f32_16x16x32_bf16 v[112:115], a[116:119], v[72:75], v[112:115]
    v_exp_f32 v57, v57
    v_mfma_f32_16x16x32_bf16 v[132:135], a[120:123], v[72:75], v[132:135]
    v_exp_f32 v58, v58
    v_mfma_f32_16x16x32_bf16 v[152:155], a[124:127], v[72:75], v[152:155]
    buffer_load_dwordx4 v25, s[16:19], s98 offen offset:3072 lds
    v_cvt_pk_bf16_f32 v76, v56, v57
    v_mfma_f32_16x16x32_bf16 v[172:175], a[128:131], v[72:75], v[172:175]
    v_exp_f32 v59, v59
    v_mfma_f32_16x16x32_bf16 v[192:195], a[132:135], v[72:75], v[192:195]
    v_exp_f32 v60, v60
    v_mfma_f32_16x16x32_bf16 v[212:215], a[136:139], v[72:75], v[212:215]
    v_cvt_pk_bf16_f32 v77, v58, v59
    v_mfma_f32_16x16x32_bf16 v[232:235], a[140:143], v[72:75], v[232:235]
    s_add_u32 m0, s101, 0
    s_nop 0
    buffer_load_dwordx4 v244, s[52:55], s66 offen offset:0 lds
    v_mfma_f32_16x16x32_bf16 a[152:155], a[164:167], v[72:75], a[152:155]
    v_exp_f32 v61, v61
    s_waitcnt lgkmcnt(0)
    v_mfma_f32_16x16x32_bf16 v[48:51], a[80:83], a[0:3], v[28:31]
    buffer_load_dwordx4 v245, s[52:55], s66 offen offset:1024 lds
    v_mfma_f32_16x16x32_bf16 v[48:51], a[84:87], a[4:7], v[48:51]
    v_exp_f32 v62, v62
    v_mfma_f32_16x16x32_bf16 v[48:51], a[88:91], a[8:11], v[48:51]
    v_cvt_pk_bf16_f32 v78, v60, v61
    buffer_load_dwordx4 v246, s[52:55], s66 offen offset:2048 lds
    v_mfma_f32_16x16x32_bf16 v[48:51], a[92:95], a[12:15], v[48:51]
    v_exp_f32 v63, v63
    v_mfma_f32_16x16x32_bf16 v[52:55], a[96:99], a[0:3], v[28:31]
    v_cvt_pk_bf16_f32 v79, v62, v63
    buffer_load_dwordx4 v247, s[52:55], s66 offen offset:3072 lds
    v_mfma_f32_16x16x32_bf16 v[52:55], a[100:103], a[4:7], v[52:55]
    v_exp_f32 v64, v64
    v_mfma_f32_16x16x32_bf16 v[52:55], a[104:107], a[8:11], v[52:55]
    v_exp_f32 v65, v65
    v_mfma_f32_16x16x32_bf16 v[52:55], a[108:111], a[12:15], v[52:55]
    v_exp_f32 v66, v66
    v_mfma_f32_16x16x32_bf16 v[96:99], a[112:115], v[76:79], v[96:99]
    s_bfe_u32 s25, s93, 0x40018
    s_lshl_b32 s25, s25, 13
    v_mfma_f32_16x16x32_bf16 v[116:119], a[116:119], v[76:79], v[116:119]
    s_add_u32 s98, s25, 4096
    s_add_u32 m0, s24, 0
    v_mfma_f32_16x16x32_bf16 v[136:139], a[120:123], v[76:79], v[136:139]
    buffer_load_dwordx4 v20, s[12:15], s25 offen offset:0 lds
    v_cvt_pk_bf16_f32 v80, v64, v65
    v_mfma_f32_16x16x32_bf16 v[156:159], a[124:127], v[76:79], v[156:159]
    v_exp_f32 v67, v67
    v_mfma_f32_16x16x32_bf16 v[176:179], a[128:131], v[76:79], v[176:179]
    buffer_load_dwordx4 v21, s[12:15], s25 offen offset:1024 lds
    v_mfma_f32_16x16x32_bf16 v[196:199], a[132:135], v[76:79], v[196:199]
    v_exp_f32 v68, v68
    v_mfma_f32_16x16x32_bf16 v[216:219], a[136:139], v[76:79], v[216:219]
    v_cvt_pk_bf16_f32 v81, v66, v67
    v_mfma_f32_16x16x32_bf16 v[236:239], a[140:143], v[76:79], v[236:239]
    v_exp_f32 v69, v69
    v_mfma_f32_16x16x32_bf16 a[156:159], a[164:167], v[76:79], a[156:159]
    buffer_load_dwordx4 v22, s[12:15], s25 offen offset:2048 lds
    v_mfma_f32_16x16x32_bf16 v[56:59], a[80:83], a[16:19], v[32:35]
    v_exp_f32 v70, v70
    v_mfma_f32_16x16x32_bf16 v[56:59], a[84:87], a[20:23], v[56:59]
    v_cvt_pk_bf16_f32 v82, v68, v69
    v_mfma_f32_16x16x32_bf16 v[56:59], a[88:91], a[24:27], v[56:59]
    v_exp_f32 v71, v71
    v_mfma_f32_16x16x32_bf16 v[56:59], a[92:95], a[28:31], v[56:59]
    v_cvt_pk_bf16_f32 v83, v70, v71
    buffer_load_dwordx4 v23, s[12:15], s25 offen offset:3072 lds
    v_mfma_f32_16x16x32_bf16 v[60:63], a[96:99], a[16:19], v[32:35]
    v_exp_f32 v48, v48
    v_mfma_f32_16x16x32_bf16 v[60:63], a[100:103], a[20:23], v[60:63]
    v_exp_f32 v49, v49
    v_mfma_f32_16x16x32_bf16 v[60:63], a[104:107], a[24:27], v[60:63]
    v_exp_f32 v50, v50
    v_mfma_f32_16x16x32_bf16 v[60:63], a[108:111], a[28:31], v[60:63]
    s_add_u32 m0, s24, 4096
    s_nop 0
    buffer_load_dwordx4 v20, s[12:15], s98 offen offset:0 lds
    v_mfma_f32_16x16x32_bf16 v[100:103], a[112:115], v[80:83], v[100:103]
    s_waitcnt vmcnt(25)
    ds_read_b64_tr_b16 a[112:113], v12 offset:0
    ds_read_b64_tr_b16 a[114:115], v12 offset:4096
    v_mfma_f32_16x16x32_bf16 v[120:123], a[116:119], v[80:83], v[120:123]
    ds_read_b64_tr_b16 a[116:117], v13 offset:0
    ds_read_b64_tr_b16 a[118:119], v13 offset:4096
    v_mfma_f32_16x16x32_bf16 v[140:143], a[120:123], v[80:83], v[140:143]
    v_cvt_pk_bf16_f32 v72, v48, v49
    ds_read_b64_tr_b16 a[120:121], v14 offset:0
    v_mfma_f32_16x16x32_bf16 v[160:163], a[124:127], v[80:83], v[160:163]
    buffer_load_dwordx4 v21, s[12:15], s98 offen offset:1024 lds
    ds_read_b64_tr_b16 a[122:123], v14 offset:4096
    v_mfma_f32_16x16x32_bf16 v[180:183], a[128:131], v[80:83], v[180:183]
    v_exp_f32 v51, v51
    v_mfma_f32_16x16x32_bf16 v[200:203], a[132:135], v[80:83], v[200:203]
    v_exp_f32 v52, v52
    v_mfma_f32_16x16x32_bf16 v[220:223], a[136:139], v[80:83], v[220:223]
    v_cvt_pk_bf16_f32 v73, v50, v51
    ds_read_b64_tr_b16 a[124:125], v15 offset:0
    v_mfma_f32_16x16x32_bf16 v[240:243], a[140:143], v[80:83], v[240:243]
    buffer_load_dwordx4 v22, s[12:15], s98 offen offset:2048 lds
    ds_read_b64_tr_b16 a[126:127], v15 offset:4096
    v_mfma_f32_16x16x32_bf16 a[160:163], a[164:167], v[80:83], a[160:163]
    v_exp_f32 v53, v53
    v_mfma_f32_16x16x32_bf16 v[64:67], a[80:83], a[32:35], v[36:39]
    v_exp_f32 v54, v54
    v_mfma_f32_16x16x32_bf16 v[64:67], a[84:87], a[36:39], v[64:67]
    v_cvt_pk_bf16_f32 v74, v52, v53
    ds_read_b64_tr_b16 a[128:129], v16 offset:0
    v_mfma_f32_16x16x32_bf16 v[64:67], a[88:91], a[40:43], v[64:67]
    v_exp_f32 v55, v55
    v_mfma_f32_16x16x32_bf16 v[64:67], a[92:95], a[44:47], v[64:67]
    v_cvt_pk_bf16_f32 v75, v54, v55
    buffer_load_dwordx4 v23, s[12:15], s98 offen offset:3072 lds
    v_mfma_f32_16x16x32_bf16 v[68:71], a[96:99], a[32:35], v[36:39]
    ds_read_b64_tr_b16 a[130:131], v16 offset:4096
    ds_read_b64_tr_b16 a[132:133], v17 offset:0
    v_mfma_f32_16x16x32_bf16 v[68:71], a[100:103], a[36:39], v[68:71]
    ds_read_b64_tr_b16 a[134:135], v17 offset:4096
    ds_read_b64_tr_b16 a[136:137], v18 offset:0
    v_mfma_f32_16x16x32_bf16 v[68:71], a[104:107], a[40:43], v[68:71]
    ds_read_b64_tr_b16 a[138:139], v18 offset:4096
    ds_read_b64_tr_b16 a[140:141], v19 offset:0
    v_mfma_f32_16x16x32_bf16 v[68:71], a[108:111], a[44:47], v[68:71]
    ds_read_b64_tr_b16 a[142:143], v19 offset:4096
    s_waitcnt lgkmcnt(7)
    v_mfma_f32_16x16x32_bf16 v[84:87], a[112:115], v[72:75], v[84:87]
    v_exp_f32 v56, v56
    v_mfma_f32_16x16x32_bf16 v[104:107], a[116:119], v[72:75], v[104:107]
    v_exp_f32 v57, v57
    v_mfma_f32_16x16x32_bf16 v[124:127], a[120:123], v[72:75], v[124:127]
    v_exp_f32 v58, v58
    v_mfma_f32_16x16x32_bf16 v[144:147], a[124:127], v[72:75], v[144:147]
    v_cvt_pk_bf16_f32 v76, v56, v57
    s_waitcnt lgkmcnt(3)
    v_mfma_f32_16x16x32_bf16 v[164:167], a[128:131], v[72:75], v[164:167]
    v_exp_f32 v59, v59
    v_mfma_f32_16x16x32_bf16 v[184:187], a[132:135], v[72:75], v[184:187]
    v_exp_f32 v60, v60
    s_waitcnt lgkmcnt(0)
    v_mfma_f32_16x16x32_bf16 v[204:207], a[136:139], v[72:75], v[204:207]
    v_cvt_pk_bf16_f32 v77, v58, v59
    v_mfma_f32_16x16x32_bf16 v[224:227], a[140:143], v[72:75], v[224:227]
    v_exp_f32 v61, v61
    v_mfma_f32_16x16x32_bf16 a[144:147], a[164:167], v[72:75], a[144:147]
    v_exp_f32 v62, v62
    v_mfma_f32_16x16x32_bf16 v[48:51], a[80:83], a[48:51], v[40:43]
    s_add_u32 m0, s24, 65536
    s_nop 0
    buffer_load_dwordx4 v24, s[16:19], s25 offen offset:0 lds
    v_mfma_f32_16x16x32_bf16 v[48:51], a[84:87], a[52:55], v[48:51]
    v_cvt_pk_bf16_f32 v78, v60, v61
    v_mfma_f32_16x16x32_bf16 v[48:51], a[88:91], a[56:59], v[48:51]
    v_exp_f32 v63, v63
    v_mfma_f32_16x16x32_bf16 v[48:51], a[92:95], a[60:63], v[48:51]
    v_cvt_pk_bf16_f32 v79, v62, v63
    v_mfma_f32_16x16x32_bf16 v[52:55], a[96:99], a[48:51], v[40:43]
    buffer_load_dwordx4 v25, s[16:19], s25 offen offset:1024 lds
    v_mfma_f32_16x16x32_bf16 v[52:55], a[100:103], a[52:55], v[52:55]
    v_exp_f32 v64, v64
    v_mfma_f32_16x16x32_bf16 v[52:55], a[104:107], a[56:59], v[52:55]
    v_exp_f32 v65, v65
    v_mfma_f32_16x16x32_bf16 v[52:55], a[108:111], a[60:63], v[52:55]
    v_exp_f32 v66, v66
    v_mfma_f32_16x16x32_bf16 v[88:91], a[112:115], v[76:79], v[88:91]
    buffer_load_dwordx4 v24, s[16:19], s25 offen offset:2048 lds
    v_cvt_pk_bf16_f32 v80, v64, v65
    v_mfma_f32_16x16x32_bf16 v[108:111], a[116:119], v[76:79], v[108:111]
    v_exp_f32 v67, v67
    v_mfma_f32_16x16x32_bf16 v[128:131], a[120:123], v[76:79], v[128:131]
    v_exp_f32 v68, v68
    v_mfma_f32_16x16x32_bf16 v[148:151], a[124:127], v[76:79], v[148:151]
    v_cvt_pk_bf16_f32 v81, v66, v67
    v_mfma_f32_16x16x32_bf16 v[168:171], a[128:131], v[76:79], v[168:171]
    buffer_load_dwordx4 v25, s[16:19], s25 offen offset:3072 lds
    v_mfma_f32_16x16x32_bf16 v[188:191], a[132:135], v[76:79], v[188:191]
    v_exp_f32 v69, v69
    v_mfma_f32_16x16x32_bf16 v[208:211], a[136:139], v[76:79], v[208:211]
    v_exp_f32 v70, v70
    v_mfma_f32_16x16x32_bf16 v[228:231], a[140:143], v[76:79], v[228:231]
    v_cvt_pk_bf16_f32 v82, v68, v69
    v_mfma_f32_16x16x32_bf16 a[148:151], a[164:167], v[76:79], a[148:151]
    s_add_u32 m0, s24, 69632
    s_nop 0
    buffer_load_dwordx4 v24, s[16:19], s98 offen offset:0 lds
    v_mfma_f32_16x16x32_bf16 v[56:59], a[80:83], a[64:67], v[44:47]
    v_exp_f32 v71, v71
    v_mfma_f32_16x16x32_bf16 v[56:59], a[84:87], a[68:71], v[56:59]
    v_cvt_pk_bf16_f32 v83, v70, v71
    s_waitcnt vmcnt(25)
    ds_read_b128 a[80:83], v8 offset:32768
    v_mfma_f32_16x16x32_bf16 v[56:59], a[88:91], a[72:75], v[56:59]
    ds_read_b128 a[84:87], v9 offset:32768
    ds_read_b128 a[88:91], v10 offset:32768
    v_mfma_f32_16x16x32_bf16 v[56:59], a[92:95], a[76:79], v[56:59]
    buffer_load_dwordx4 v25, s[16:19], s98 offen offset:1024 lds
    ds_read_b128 a[92:95], v11 offset:32768
    v_mfma_f32_16x16x32_bf16 v[60:63], a[96:99], a[64:67], v[44:47]
    ds_read_b128 a[96:99], v8 offset:36864
    v_mfma_f32_16x16x32_bf16 v[60:63], a[100:103], a[68:71], v[60:63]
    ds_read_b128 a[100:103], v9 offset:36864
    v_mfma_f32_16x16x32_bf16 v[60:63], a[104:107], a[72:75], v[60:63]
    ds_read_b128 a[104:107], v10 offset:36864
    v_mfma_f32_16x16x32_bf16 v[60:63], a[108:111], a[76:79], v[60:63]
    buffer_load_dwordx4 v24, s[16:19], s98 offen offset:2048 lds
    ds_read_b128 a[108:111], v11 offset:36864
    v_mfma_f32_16x16x32_bf16 v[92:95], a[112:115], v[80:83], v[92:95]
    v_exp_f32 v48, v48
    v_mfma_f32_16x16x32_bf16 v[112:115], a[116:119], v[80:83], v[112:115]
    v_exp_f32 v49, v49
    v_mfma_f32_16x16x32_bf16 v[132:135], a[120:123], v[80:83], v[132:135]
    v_exp_f32 v50, v50
    v_mfma_f32_16x16x32_bf16 v[152:155], a[124:127], v[80:83], v[152:155]
    buffer_load_dwordx4 v25, s[16:19], s98 offen offset:3072 lds
    v_cvt_pk_bf16_f32 v72, v48, v49
    v_mfma_f32_16x16x32_bf16 v[172:175], a[128:131], v[80:83], v[172:175]
    v_exp_f32 v51, v51
    v_mfma_f32_16x16x32_bf16 v[192:195], a[132:135], v[80:83], v[192:195]
    v_exp_f32 v52, v52
    v_mfma_f32_16x16x32_bf16 v[212:215], a[136:139], v[80:83], v[212:215]
    v_cvt_pk_bf16_f32 v73, v50, v51
    v_mfma_f32_16x16x32_bf16 v[232:235], a[140:143], v[80:83], v[232:235]
    v_exp_f32 v53, v53
    v_mfma_f32_16x16x32_bf16 a[152:155], a[164:167], v[80:83], a[152:155]
    v_exp_f32 v54, v54
    s_waitcnt lgkmcnt(0)
    v_mfma_f32_16x16x32_bf16 v[64:67], a[80:83], a[0:3], v[28:31]
    v_cvt_pk_bf16_f32 v74, v52, v53
    v_mfma_f32_16x16x32_bf16 v[64:67], a[84:87], a[4:7], v[64:67]
    v_exp_f32 v55, v55
    v_mfma_f32_16x16x32_bf16 v[64:67], a[88:91], a[8:11], v[64:67]
    v_cvt_pk_bf16_f32 v75, v54, v55
    v_mfma_f32_16x16x32_bf16 v[64:67], a[92:95], a[12:15], v[64:67]
    v_exp_f32 v56, v56
    v_mfma_f32_16x16x32_bf16 v[68:71], a[96:99], a[0:3], v[28:31]
    v_exp_f32 v57, v57
    v_mfma_f32_16x16x32_bf16 v[68:71], a[100:103], a[4:7], v[68:71]
    v_exp_f32 v58, v58
    v_mfma_f32_16x16x32_bf16 v[68:71], a[104:107], a[8:11], v[68:71]
    v_cvt_pk_bf16_f32 v76, v56, v57
    v_mfma_f32_16x16x32_bf16 v[68:71], a[108:111], a[12:15], v[68:71]
    v_exp_f32 v59, v59
    v_mfma_f32_16x16x32_bf16 v[96:99], a[112:115], v[72:75], v[96:99]
    s_bfe_u32 s25, s93, 0x4001c
    s_lshl_b32 s25, s25, 13
    v_mfma_f32_16x16x32_bf16 v[116:119], a[116:119], v[72:75], v[116:119]
    s_add_u32 s98, s25, 4096
    s_add_u32 m0, s24, 32768
    v_mfma_f32_16x16x32_bf16 v[136:139], a[120:123], v[72:75], v[136:139]
    buffer_load_dwordx4 v20, s[12:15], s25 offen offset:0 lds
    v_mfma_f32_16x16x32_bf16 v[156:159], a[124:127], v[72:75], v[156:159]
    v_exp_f32 v60, v60
    v_mfma_f32_16x16x32_bf16 v[176:179], a[128:131], v[72:75], v[176:179]
    buffer_load_dwordx4 v21, s[12:15], s25 offen offset:1024 lds
    v_cvt_pk_bf16_f32 v77, v58, v59
    v_mfma_f32_16x16x32_bf16 v[196:199], a[132:135], v[72:75], v[196:199]
    v_exp_f32 v61, v61
    v_mfma_f32_16x16x32_bf16 v[216:219], a[136:139], v[72:75], v[216:219]
    v_exp_f32 v62, v62
    v_mfma_f32_16x16x32_bf16 v[236:239], a[140:143], v[72:75], v[236:239]
    v_cvt_pk_bf16_f32 v78, v60, v61
    v_mfma_f32_16x16x32_bf16 a[156:159], a[164:167], v[72:75], a[156:159]
    buffer_load_dwordx4 v22, s[12:15], s25 offen offset:2048 lds
    v_mfma_f32_16x16x32_bf16 v[48:51], a[80:83], a[16:19], v[32:35]
    v_exp_f32 v63, v63
    v_mfma_f32_16x16x32_bf16 v[48:51], a[84:87], a[20:23], v[48:51]
    v_cvt_pk_bf16_f32 v79, v62, v63
    v_mfma_f32_16x16x32_bf16 v[48:51], a[88:91], a[24:27], v[48:51]
    v_exp_f32 v64, v64
    v_mfma_f32_16x16x32_bf16 v[48:51], a[92:95], a[28:31], v[48:51]
    buffer_load_dwordx4 v23, s[12:15], s25 offen offset:3072 lds
    v_mfma_f32_16x16x32_bf16 v[52:55], a[96:99], a[16:19], v[32:35]
    v_exp_f32 v65, v65
    v_mfma_f32_16x16x32_bf16 v[52:55], a[100:103], a[20:23], v[52:55]
    v_exp_f32 v66, v66
    v_mfma_f32_16x16x32_bf16 v[52:55], a[104:107], a[24:27], v[52:55]
    v_cvt_pk_bf16_f32 v80, v64, v65
    v_mfma_f32_16x16x32_bf16 v[52:55], a[108:111], a[28:31], v[52:55]
    s_add_u32 m0, s24, 36864
    s_nop 0
    buffer_load_dwordx4 v20, s[12:15], s98 offen offset:0 lds
    v_mfma_f32_16x16x32_bf16 v[100:103], a[112:115], v[76:79], v[100:103]
    s_waitcnt vmcnt(25)
    ds_read_b64_tr_b16 a[112:113], v12 offset:32768
    ds_read_b64_tr_b16 a[114:115], v12 offset:36864
    v_mfma_f32_16x16x32_bf16 v[120:123], a[116:119], v[76:79], v[120:123]
    ds_read_b64_tr_b16 a[116:117], v13 offset:32768
    ds_read_b64_tr_b16 a[118:119], v13 offset:36864
    v_mfma_f32_16x16x32_bf16 v[140:143], a[120:123], v[76:79], v[140:143]
    v_exp_f32 v67, v67
    v_mfma_f32_16x16x32_bf16 v[160:163], a[124:127], v[76:79], v[160:163]
    buffer_load_dwordx4 v21, s[12:15], s98 offen offset:1024 lds
    ds_read_b64_tr_b16 a[120:121], v14 offset:32768
    v_mfma_f32_16x16x32_bf16 v[180:183], a[128:131], v[76:79], v[180:183]
    v_exp_f32 v68, v68
    v_mfma_f32_16x16x32_bf16 v[200:203], a[132:135], v[76:79], v[200:203]
    v_cvt_pk_bf16_f32 v81, v66, v67
    ds_read_b64_tr_b16 a[122:123], v14 offset:36864
    v_mfma_f32_16x16x32_bf16 v[220:223], a[136:139], v[76:79], v[220:223]
    v_exp_f32 v69, v69
    v_mfma_f32_16x16x32_bf16 v[240:243], a[140:143], v[76:79], v[240:243]
    buffer_load_dwordx4 v22, s[12:15], s98 offen offset:2048 lds
    ds_read_b64_tr_b16 a[124:125], v15 offset:32768
    v_mfma_f32_16x16x32_bf16 a[160:163], a[164:167], v[76:79], a[160:163]
    v_exp_f32 v70, v70
    v_mfma_f32_16x16x32_bf16 v[56:59], a[80:83], a[32:35], v[36:39]
    v_cvt_pk_bf16_f32 v82, v68, v69
    ds_read_b64_tr_b16 a[126:127], v15 offset:36864
    v_mfma_f32_16x16x32_bf16 v[56:59], a[84:87], a[36:39], v[56:59]
    v_exp_f32 v71, v71
    v_mfma_f32_16x16x32_bf16 v[56:59], a[88:91], a[40:43], v[56:59]
    v_cvt_pk_bf16_f32 v83, v70, v71
    buffer_load_dwordx4 v23, s[12:15], s98 offen offset:3072 lds
    v_mfma_f32_16x16x32_bf16 v[56:59], a[92:95], a[44:47], v[56:59]
    ds_read_b64_tr_b16 a[128:129], v16 offset:32768
    ds_read_b64_tr_b16 a[130:131], v16 offset:36864
    v_mfma_f32_16x16x32_bf16 v[60:63], a[96:99], a[32:35], v[36:39]
    ds_read_b64_tr_b16 a[132:133], v17 offset:32768
    ds_read_b64_tr_b16 a[134:135], v17 offset:36864
    v_mfma_f32_16x16x32_bf16 v[60:63], a[100:103], a[36:39], v[60:63]
    ds_read_b64_tr_b16 a[136:137], v18 offset:32768
    ds_read_b64_tr_b16 a[138:139], v18 offset:36864
    v_mfma_f32_16x16x32_bf16 v[60:63], a[104:107], a[40:43], v[60:63]
    ds_read_b64_tr_b16 a[140:141], v19 offset:32768
    ds_read_b64_tr_b16 a[142:143], v19 offset:36864
    v_mfma_f32_16x16x32_bf16 v[60:63], a[108:111], a[44:47], v[60:63]
    v_exp_f32 v48, v48
    s_waitcnt lgkmcnt(8)
    v_mfma_f32_16x16x32_bf16 v[84:87], a[112:115], v[80:83], v[84:87]
    v_exp_f32 v49, v49
    v_mfma_f32_16x16x32_bf16 v[104:107], a[116:119], v[80:83], v[104:107]
    v_exp_f32 v50, v50
    v_mfma_f32_16x16x32_bf16 v[124:127], a[120:123], v[80:83], v[124:127]
    v_cvt_pk_bf16_f32 v72, v48, v49
    v_mfma_f32_16x16x32_bf16 v[144:147], a[124:127], v[80:83], v[144:147]
    v_exp_f32 v51, v51
    s_waitcnt lgkmcnt(2)
    v_mfma_f32_16x16x32_bf16 v[164:167], a[128:131], v[80:83], v[164:167]
    v_exp_f32 v52, v52
    v_mfma_f32_16x16x32_bf16 v[184:187], a[132:135], v[80:83], v[184:187]
    v_cvt_pk_bf16_f32 v73, v50, v51
    v_mfma_f32_16x16x32_bf16 v[204:207], a[136:139], v[80:83], v[204:207]
    v_exp_f32 v53, v53
    s_waitcnt lgkmcnt(0)
    v_mfma_f32_16x16x32_bf16 v[224:227], a[140:143], v[80:83], v[224:227]
    v_exp_f32 v54, v54
    v_mfma_f32_16x16x32_bf16 a[144:147], a[164:167], v[80:83], a[144:147]
    v_cvt_pk_bf16_f32 v74, v52, v53
    v_mfma_f32_16x16x32_bf16 v[64:67], a[80:83], a[48:51], v[40:43]
    s_add_u32 m0, s24, 98304
    s_nop 0
    buffer_load_dwordx4 v24, s[16:19], s25 offen offset:0 lds
    v_mfma_f32_16x16x32_bf16 v[64:67], a[84:87], a[52:55], v[64:67]
    v_exp_f32 v55, v55
    v_mfma_f32_16x16x32_bf16 v[64:67], a[88:91], a[56:59], v[64:67]
    v_cvt_pk_bf16_f32 v75, v54, v55
    v_mfma_f32_16x16x32_bf16 v[64:67], a[92:95], a[60:63], v[64:67]
    v_exp_f32 v56, v56
    v_mfma_f32_16x16x32_bf16 v[68:71], a[96:99], a[48:51], v[40:43]
    buffer_load_dwordx4 v25, s[16:19], s25 offen offset:1024 lds
    v_mfma_f32_16x16x32_bf16 v[68:71], a[100:103], a[52:55], v[68:71]
    v_exp_f32 v57, v57
    v_mfma_f32_16x16x32_bf16 v[68:71], a[104:107], a[56:59], v[68:71]
    v_exp_f32 v58, v58
    v_mfma_f32_16x16x32_bf16 v[68:71], a[108:111], a[60:63], v[68:71]
    v_cvt_pk_bf16_f32 v76, v56, v57
    v_mfma_f32_16x16x32_bf16 v[88:91], a[112:115], v[72:75], v[88:91]
    buffer_load_dwordx4 v24, s[16:19], s25 offen offset:2048 lds
    v_mfma_f32_16x16x32_bf16 v[108:111], a[116:119], v[72:75], v[108:111]
    v_exp_f32 v59, v59
    v_mfma_f32_16x16x32_bf16 v[128:131], a[120:123], v[72:75], v[128:131]
    v_exp_f32 v60, v60
    v_mfma_f32_16x16x32_bf16 v[148:151], a[124:127], v[72:75], v[148:151]
    v_cvt_pk_bf16_f32 v77, v58, v59
    v_mfma_f32_16x16x32_bf16 v[168:171], a[128:131], v[72:75], v[168:171]
    buffer_load_dwordx4 v25, s[16:19], s25 offen offset:3072 lds
    v_mfma_f32_16x16x32_bf16 v[188:191], a[132:135], v[72:75], v[188:191]
    v_exp_f32 v61, v61
    v_mfma_f32_16x16x32_bf16 v[208:211], a[136:139], v[72:75], v[208:211]
    v_exp_f32 v62, v62
    v_mfma_f32_16x16x32_bf16 v[228:231], a[140:143], v[72:75], v[228:231]
    v_cvt_pk_bf16_f32 v78, v60, v61
    v_mfma_f32_16x16x32_bf16 a[148:151], a[164:167], v[72:75], a[148:151]
    s_add_u32 m0, s24, 102400
    s_nop 0
    buffer_load_dwordx4 v24, s[16:19], s98 offen offset:0 lds
    v_mfma_f32_16x16x32_bf16 v[48:51], a[80:83], a[64:67], v[44:47]
    v_exp_f32 v63, v63
    v_mfma_f32_16x16x32_bf16 v[48:51], a[84:87], a[68:71], v[48:51]
    v_cvt_pk_bf16_f32 v79, v62, v63
    s_waitcnt vmcnt(21)
    ds_read_b128 a[80:83], v8 offset:0
    v_mfma_f32_16x16x32_bf16 v[48:51], a[88:91], a[72:75], v[48:51]
    ds_read_b128 a[84:87], v9 offset:0
    ds_read_b128 a[88:91], v10 offset:0
    v_mfma_f32_16x16x32_bf16 v[48:51], a[92:95], a[76:79], v[48:51]
    buffer_load_dwordx4 v25, s[16:19], s98 offen offset:1024 lds
    ds_read_b128 a[92:95], v11 offset:0
    v_mfma_f32_16x16x32_bf16 v[52:55], a[96:99], a[64:67], v[44:47]
    ds_read_b128 a[96:99], v8 offset:4096
    v_mfma_f32_16x16x32_bf16 v[52:55], a[100:103], a[68:71], v[52:55]
    ds_read_b128 a[100:103], v9 offset:4096
    v_mfma_f32_16x16x32_bf16 v[52:55], a[104:107], a[72:75], v[52:55]
    ds_read_b128 a[104:107], v10 offset:4096
    v_mfma_f32_16x16x32_bf16 v[52:55], a[108:111], a[76:79], v[52:55]
    buffer_load_dwordx4 v24, s[16:19], s98 offen offset:2048 lds
    ds_read_b128 a[108:111], v11 offset:4096
    v_mfma_f32_16x16x32_bf16 v[92:95], a[112:115], v[76:79], v[92:95]
    v_exp_f32 v64, v64
    v_mfma_f32_16x16x32_bf16 v[112:115], a[116:119], v[76:79], v[112:115]
    v_exp_f32 v65, v65
    v_mfma_f32_16x16x32_bf16 v[132:135], a[120:123], v[76:79], v[132:135]
    v_exp_f32 v66, v66
    v_mfma_f32_16x16x32_bf16 v[152:155], a[124:127], v[76:79], v[152:155]
    buffer_load_dwordx4 v25, s[16:19], s98 offen offset:3072 lds
    v_cvt_pk_bf16_f32 v80, v64, v65
    v_mfma_f32_16x16x32_bf16 v[172:175], a[128:131], v[76:79], v[172:175]
    v_exp_f32 v67, v67
    v_mfma_f32_16x16x32_bf16 v[192:195], a[132:135], v[76:79], v[192:195]
    v_exp_f32 v68, v68
    v_mfma_f32_16x16x32_bf16 v[212:215], a[136:139], v[76:79], v[212:215]
    v_cvt_pk_bf16_f32 v81, v66, v67
    v_mfma_f32_16x16x32_bf16 v[232:235], a[140:143], v[76:79], v[232:235]
    v_exp_f32 v69, v69
    v_mfma_f32_16x16x32_bf16 a[152:155], a[164:167], v[76:79], a[152:155]
    v_exp_f32 v70, v70
    s_waitcnt lgkmcnt(0)
    v_mfma_f32_16x16x32_bf16 v[56:59], a[80:83], a[0:3], v[28:31]
    v_cvt_pk_bf16_f32 v82, v68, v69
    v_mfma_f32_16x16x32_bf16 v[56:59], a[84:87], a[4:7], v[56:59]
    v_exp_f32 v71, v71
    v_mfma_f32_16x16x32_bf16 v[56:59], a[88:91], a[8:11], v[56:59]
    v_cvt_pk_bf16_f32 v83, v70, v71
    v_mfma_f32_16x16x32_bf16 v[56:59], a[92:95], a[12:15], v[56:59]
    v_exp_f32 v48, v48
    v_mfma_f32_16x16x32_bf16 v[60:63], a[96:99], a[0:3], v[28:31]
    v_exp_f32 v49, v49
    v_mfma_f32_16x16x32_bf16 v[60:63], a[100:103], a[4:7], v[60:63]
    v_exp_f32 v50, v50
    v_mfma_f32_16x16x32_bf16 v[60:63], a[104:107], a[8:11], v[60:63]
    v_cvt_pk_bf16_f32 v72, v48, v49
    v_mfma_f32_16x16x32_bf16 v[60:63], a[108:111], a[12:15], v[60:63]
    v_exp_f32 v51, v51
    v_mfma_f32_16x16x32_bf16 v[96:99], a[112:115], v[80:83], v[96:99]
    v_exp_f32 v52, v52
    v_mfma_f32_16x16x32_bf16 v[116:119], a[116:119], v[80:83], v[116:119]
    v_cvt_pk_bf16_f32 v73, v50, v51
    v_mfma_f32_16x16x32_bf16 v[136:139], a[120:123], v[80:83], v[136:139]
    v_exp_f32 v53, v53
    v_mfma_f32_16x16x32_bf16 v[156:159], a[124:127], v[80:83], v[156:159]
    v_exp_f32 v54, v54
    v_mfma_f32_16x16x32_bf16 v[176:179], a[128:131], v[80:83], v[176:179]
    v_cvt_pk_bf16_f32 v74, v52, v53
    v_mfma_f32_16x16x32_bf16 v[196:199], a[132:135], v[80:83], v[196:199]
    v_exp_f32 v55, v55
    v_mfma_f32_16x16x32_bf16 v[216:219], a[136:139], v[80:83], v[216:219]
    v_cvt_pk_bf16_f32 v75, v54, v55
    v_mfma_f32_16x16x32_bf16 v[236:239], a[140:143], v[80:83], v[236:239]
    v_exp_f32 v56, v56
    v_mfma_f32_16x16x32_bf16 a[156:159], a[164:167], v[80:83], a[156:159]
    v_exp_f32 v57, v57
    v_mfma_f32_16x16x32_bf16 v[64:67], a[80:83], a[16:19], v[32:35]
    v_exp_f32 v58, v58
    v_mfma_f32_16x16x32_bf16 v[64:67], a[84:87], a[20:23], v[64:67]
    v_cvt_pk_bf16_f32 v76, v56, v57
    v_mfma_f32_16x16x32_bf16 v[64:67], a[88:91], a[24:27], v[64:67]
    v_exp_f32 v59, v59
    v_mfma_f32_16x16x32_bf16 v[64:67], a[92:95], a[28:31], v[64:67]
    v_exp_f32 v60, v60
    v_mfma_f32_16x16x32_bf16 v[68:71], a[96:99], a[16:19], v[32:35]
    v_cvt_pk_bf16_f32 v77, v58, v59
    v_mfma_f32_16x16x32_bf16 v[68:71], a[100:103], a[20:23], v[68:71]
    v_exp_f32 v61, v61
    v_mfma_f32_16x16x32_bf16 v[68:71], a[104:107], a[24:27], v[68:71]
    v_exp_f32 v62, v62
    v_mfma_f32_16x16x32_bf16 v[68:71], a[108:111], a[28:31], v[68:71]
    v_cvt_pk_bf16_f32 v78, v60, v61
    v_mfma_f32_16x16x32_bf16 v[100:103], a[112:115], v[72:75], v[100:103]
    s_waitcnt vmcnt(16)
    ds_read_b64_tr_b16 a[112:113], v12 offset:0
    ds_read_b64_tr_b16 a[114:115], v12 offset:4096
    v_mfma_f32_16x16x32_bf16 v[120:123], a[116:119], v[72:75], v[120:123]
    ds_read_b64_tr_b16 a[116:117], v13 offset:0
    ds_read_b64_tr_b16 a[118:119], v13 offset:4096
    v_mfma_f32_16x16x32_bf16 v[140:143], a[120:123], v[72:75], v[140:143]
    v_exp_f32 v63, v63
    v_mfma_f32_16x16x32_bf16 v[160:163], a[124:127], v[72:75], v[160:163]
    v_cvt_pk_bf16_f32 v79, v62, v63
    ds_read_b64_tr_b16 a[120:121], v14 offset:0
    v_mfma_f32_16x16x32_bf16 v[180:183], a[128:131], v[72:75], v[180:183]
    ds_read_b64_tr_b16 a[122:123], v14 offset:4096
    ds_read_b64_tr_b16 a[124:125], v15 offset:0
    v_mfma_f32_16x16x32_bf16 v[200:203], a[132:135], v[72:75], v[200:203]
    ds_read_b64_tr_b16 a[126:127], v15 offset:4096
    ds_read_b64_tr_b16 a[128:129], v16 offset:0
    v_mfma_f32_16x16x32_bf16 v[220:223], a[136:139], v[72:75], v[220:223]
    ds_read_b64_tr_b16 a[130:131], v16 offset:4096
    ds_read_b64_tr_b16 a[132:133], v17 offset:0
    v_mfma_f32_16x16x32_bf16 v[240:243], a[140:143], v[72:75], v[240:243]
    ds_read_b64_tr_b16 a[134:135], v17 offset:4096
    ds_read_b64_tr_b16 a[136:137], v18 offset:0
    v_mfma_f32_16x16x32_bf16 a[160:163], a[164:167], v[72:75], a[160:163]
    ds_read_b64_tr_b16 a[138:139], v18 offset:4096
    ds_read_b64_tr_b16 a[140:141], v19 offset:0
    v_mfma_f32_16x16x32_bf16 v[48:51], a[80:83], a[32:35], v[36:39]
    ds_read_b64_tr_b16 a[142:143], v19 offset:4096
    v_mfma_f32_16x16x32_bf16 v[48:51], a[84:87], a[36:39], v[48:51]
    v_exp_f32 v64, v64
    v_mfma_f32_16x16x32_bf16 v[48:51], a[88:91], a[40:43], v[48:51]
    v_exp_f32 v65, v65
    v_mfma_f32_16x16x32_bf16 v[48:51], a[92:95], a[44:47], v[48:51]
    v_exp_f32 v66, v66
    v_mfma_f32_16x16x32_bf16 v[52:55], a[96:99], a[32:35], v[36:39]
    v_cvt_pk_bf16_f32 v80, v64, v65
    v_mfma_f32_16x16x32_bf16 v[52:55], a[100:103], a[36:39], v[52:55]
    v_exp_f32 v67, v67
    v_mfma_f32_16x16x32_bf16 v[52:55], a[104:107], a[40:43], v[52:55]
    v_exp_f32 v68, v68
    v_mfma_f32_16x16x32_bf16 v[52:55], a[108:111], a[44:47], v[52:55]
    v_cvt_pk_bf16_f32 v81, v66, v67
    s_waitcnt lgkmcnt(0)
    v_mfma_f32_16x16x32_bf16 v[84:87], a[112:115], v[76:79], v[84:87]
    v_exp_f32 v69, v69
    v_mfma_f32_16x16x32_bf16 v[104:107], a[116:119], v[76:79], v[104:107]
    v_exp_f32 v70, v70
    v_mfma_f32_16x16x32_bf16 v[124:127], a[120:123], v[76:79], v[124:127]
    v_cvt_pk_bf16_f32 v82, v68, v69
    v_mfma_f32_16x16x32_bf16 v[144:147], a[124:127], v[76:79], v[144:147]
    v_exp_f32 v71, v71
    v_mfma_f32_16x16x32_bf16 v[164:167], a[128:131], v[76:79], v[164:167]
    v_cvt_pk_bf16_f32 v83, v70, v71
    v_mfma_f32_16x16x32_bf16 v[184:187], a[132:135], v[76:79], v[184:187]
    v_exp_f32 v48, v48
    v_mfma_f32_16x16x32_bf16 v[204:207], a[136:139], v[76:79], v[204:207]
    v_exp_f32 v49, v49
    v_mfma_f32_16x16x32_bf16 v[224:227], a[140:143], v[76:79], v[224:227]
    v_exp_f32 v50, v50
    v_mfma_f32_16x16x32_bf16 a[144:147], a[164:167], v[76:79], a[144:147]
    v_cvt_pk_bf16_f32 v72, v48, v49
    v_mfma_f32_16x16x32_bf16 v[56:59], a[80:83], a[48:51], v[40:43]
    v_exp_f32 v51, v51
    v_mfma_f32_16x16x32_bf16 v[56:59], a[84:87], a[52:55], v[56:59]
    v_exp_f32 v52, v52
    v_mfma_f32_16x16x32_bf16 v[56:59], a[88:91], a[56:59], v[56:59]
    v_cvt_pk_bf16_f32 v73, v50, v51
    v_mfma_f32_16x16x32_bf16 v[56:59], a[92:95], a[60:63], v[56:59]
    v_exp_f32 v53, v53
    v_mfma_f32_16x16x32_bf16 v[60:63], a[96:99], a[48:51], v[40:43]
    v_exp_f32 v54, v54
    v_mfma_f32_16x16x32_bf16 v[60:63], a[100:103], a[52:55], v[60:63]
    v_cvt_pk_bf16_f32 v74, v52, v53
    v_mfma_f32_16x16x32_bf16 v[60:63], a[104:107], a[56:59], v[60:63]
    v_exp_f32 v55, v55
    v_mfma_f32_16x16x32_bf16 v[60:63], a[108:111], a[60:63], v[60:63]
    v_cvt_pk_bf16_f32 v75, v54, v55
    v_mfma_f32_16x16x32_bf16 v[88:91], a[112:115], v[80:83], v[88:91]
    v_exp_f32 v56, v56
    v_mfma_f32_16x16x32_bf16 v[108:111], a[116:119], v[80:83], v[108:111]
    v_exp_f32 v57, v57
    v_mfma_f32_16x16x32_bf16 v[128:131], a[120:123], v[80:83], v[128:131]
    v_exp_f32 v58, v58
    v_mfma_f32_16x16x32_bf16 v[148:151], a[124:127], v[80:83], v[148:151]
    v_cvt_pk_bf16_f32 v76, v56, v57
    v_mfma_f32_16x16x32_bf16 v[168:171], a[128:131], v[80:83], v[168:171]
    v_exp_f32 v59, v59
    v_mfma_f32_16x16x32_bf16 v[188:191], a[132:135], v[80:83], v[188:191]
    v_exp_f32 v60, v60
    v_mfma_f32_16x16x32_bf16 v[208:211], a[136:139], v[80:83], v[208:211]
    v_cvt_pk_bf16_f32 v77, v58, v59
    v_mfma_f32_16x16x32_bf16 v[228:231], a[140:143], v[80:83], v[228:231]
    v_exp_f32 v61, v61
    v_mfma_f32_16x16x32_bf16 a[148:151], a[164:167], v[80:83], a[148:151]
    v_exp_f32 v62, v62
    v_mfma_f32_16x16x32_bf16 v[64:67], a[80:83], a[64:67], v[44:47]
    s_waitcnt vmcnt(8)
    ds_read_b128 a[80:83], v8 offset:32768
    v_cvt_pk_bf16_f32 v78, v60, v61
    v_mfma_f32_16x16x32_bf16 v[64:67], a[84:87], a[68:71], v[64:67]
    ds_read_b128 a[84:87], v9 offset:32768
    v_mfma_f32_16x16x32_bf16 v[64:67], a[88:91], a[72:75], v[64:67]
    ds_read_b128 a[88:91], v10 offset:32768
    v_mfma_f32_16x16x32_bf16 v[64:67], a[92:95], a[76:79], v[64:67]
    ds_read_b128 a[92:95], v11 offset:32768
    v_mfma_f32_16x16x32_bf16 v[68:71], a[96:99], a[64:67], v[44:47]
    ds_read_b128 a[96:99], v8 offset:36864
    v_mfma_f32_16x16x32_bf16 v[68:71], a[100:103], a[68:71], v[68:71]
    ds_read_b128 a[100:103], v9 offset:36864
    v_mfma_f32_16x16x32_bf16 v[68:71], a[104:107], a[72:75], v[68:71]
    ds_read_b128 a[104:107], v10 offset:36864
    v_mfma_f32_16x16x32_bf16 v[68:71], a[108:111], a[76:79], v[68:71]
    ds_read_b128 a[108:111], v11 offset:36864
    v_mfma_f32_16x16x32_bf16 v[92:95], a[112:115], v[72:75], v[92:95]
    v_exp_f32 v63, v63
    v_mfma_f32_16x16x32_bf16 v[112:115], a[116:119], v[72:75], v[112:115]
    v_cvt_pk_bf16_f32 v79, v62, v63
    v_mfma_f32_16x16x32_bf16 v[132:135], a[120:123], v[72:75], v[132:135]
    v_exp_f32 v64, v64
    v_mfma_f32_16x16x32_bf16 v[152:155], a[124:127], v[72:75], v[152:155]
    v_exp_f32 v65, v65
    v_mfma_f32_16x16x32_bf16 v[172:175], a[128:131], v[72:75], v[172:175]
    v_exp_f32 v66, v66
    v_mfma_f32_16x16x32_bf16 v[192:195], a[132:135], v[72:75], v[192:195]
    v_cvt_pk_bf16_f32 v80, v64, v65
    v_mfma_f32_16x16x32_bf16 v[212:215], a[136:139], v[72:75], v[212:215]
    v_exp_f32 v67, v67
    v_mfma_f32_16x16x32_bf16 v[232:235], a[140:143], v[72:75], v[232:235]
    v_exp_f32 v68, v68
    v_mfma_f32_16x16x32_bf16 a[152:155], a[164:167], v[72:75], a[152:155]
    v_cvt_pk_bf16_f32 v81, v66, v67
    s_waitcnt lgkmcnt(0)
    v_mfma_f32_16x16x32_bf16 v[48:51], a[80:83], a[0:3], v[28:31]
    v_exp_f32 v69, v69
    v_mfma_f32_16x16x32_bf16 v[48:51], a[84:87], a[4:7], v[48:51]
    v_exp_f32 v70, v70
    v_mfma_f32_16x16x32_bf16 v[48:51], a[88:91], a[8:11], v[48:51]
    v_cvt_pk_bf16_f32 v82, v68, v69
    v_mfma_f32_16x16x32_bf16 v[48:51], a[92:95], a[12:15], v[48:51]
    v_exp_f32 v71, v71
    v_mfma_f32_16x16x32_bf16 v[52:55], a[96:99], a[0:3], v[28:31]
    v_cvt_pk_bf16_f32 v83, v70, v71
    v_mfma_f32_16x16x32_bf16 v[52:55], a[100:103], a[4:7], v[52:55]
    v_mfma_f32_16x16x32_bf16 v[52:55], a[104:107], a[8:11], v[52:55]
    v_mfma_f32_16x16x32_bf16 v[52:55], a[108:111], a[12:15], v[52:55]
    v_mfma_f32_16x16x32_bf16 v[96:99], a[112:115], v[76:79], v[96:99]
    s_nop 0
    v_exp_f32 v48, v48
    v_mfma_f32_16x16x32_bf16 v[116:119], a[116:119], v[76:79], v[116:119]
    v_exp_f32 v49, v49
    v_mfma_f32_16x16x32_bf16 v[136:139], a[120:123], v[76:79], v[136:139]
    v_exp_f32 v50, v50
    v_mfma_f32_16x16x32_bf16 v[156:159], a[124:127], v[76:79], v[156:159]
    v_cvt_pk_bf16_f32 v72, v48, v49
    v_mfma_f32_16x16x32_bf16 v[176:179], a[128:131], v[76:79], v[176:179]
    v_exp_f32 v51, v51
    v_mfma_f32_16x16x32_bf16 v[196:199], a[132:135], v[76:79], v[196:199]
    v_exp_f32 v52, v52
    v_mfma_f32_16x16x32_bf16 v[216:219], a[136:139], v[76:79], v[216:219]
    v_cvt_pk_bf16_f32 v73, v50, v51
    v_mfma_f32_16x16x32_bf16 v[236:239], a[140:143], v[76:79], v[236:239]
    v_exp_f32 v53, v53
    v_mfma_f32_16x16x32_bf16 a[156:159], a[164:167], v[76:79], a[156:159]
    v_exp_f32 v54, v54
    v_mfma_f32_16x16x32_bf16 v[56:59], a[80:83], a[16:19], v[32:35]
    v_cvt_pk_bf16_f32 v74, v52, v53
    v_mfma_f32_16x16x32_bf16 v[56:59], a[84:87], a[20:23], v[56:59]
    v_exp_f32 v55, v55
    v_mfma_f32_16x16x32_bf16 v[56:59], a[88:91], a[24:27], v[56:59]
    v_cvt_pk_bf16_f32 v75, v54, v55
    v_mfma_f32_16x16x32_bf16 v[56:59], a[92:95], a[28:31], v[56:59]
    v_mfma_f32_16x16x32_bf16 v[60:63], a[96:99], a[16:19], v[32:35]
    v_mfma_f32_16x16x32_bf16 v[60:63], a[100:103], a[20:23], v[60:63]
    v_mfma_f32_16x16x32_bf16 v[60:63], a[104:107], a[24:27], v[60:63]
    v_mfma_f32_16x16x32_bf16 v[60:63], a[108:111], a[28:31], v[60:63]
    v_mfma_f32_16x16x32_bf16 v[100:103], a[112:115], v[80:83], v[100:103]
    s_waitcnt vmcnt(0)
    ds_read_b64_tr_b16 a[112:113], v12 offset:32768
    ds_read_b64_tr_b16 a[114:115], v12 offset:36864
    v_mfma_f32_16x16x32_bf16 v[120:123], a[116:119], v[80:83], v[120:123]
    ds_read_b64_tr_b16 a[116:117], v13 offset:32768
    ds_read_b64_tr_b16 a[118:119], v13 offset:36864
    v_mfma_f32_16x16x32_bf16 v[140:143], a[120:123], v[80:83], v[140:143]
    ds_read_b64_tr_b16 a[120:121], v14 offset:32768
    ds_read_b64_tr_b16 a[122:123], v14 offset:36864
    v_mfma_f32_16x16x32_bf16 v[160:163], a[124:127], v[80:83], v[160:163]
    ds_read_b64_tr_b16 a[124:125], v15 offset:32768
    ds_read_b64_tr_b16 a[126:127], v15 offset:36864
    v_mfma_f32_16x16x32_bf16 v[180:183], a[128:131], v[80:83], v[180:183]
    ds_read_b64_tr_b16 a[128:129], v16 offset:32768
    ds_read_b64_tr_b16 a[130:131], v16 offset:36864
    v_mfma_f32_16x16x32_bf16 v[200:203], a[132:135], v[80:83], v[200:203]
    ds_read_b64_tr_b16 a[132:133], v17 offset:32768
    ds_read_b64_tr_b16 a[134:135], v17 offset:36864
    v_mfma_f32_16x16x32_bf16 v[220:223], a[136:139], v[80:83], v[220:223]
    ds_read_b64_tr_b16 a[136:137], v18 offset:32768
    ds_read_b64_tr_b16 a[138:139], v18 offset:36864
    v_mfma_f32_16x16x32_bf16 v[240:243], a[140:143], v[80:83], v[240:243]
    ds_read_b64_tr_b16 a[140:141], v19 offset:32768
    ds_read_b64_tr_b16 a[142:143], v19 offset:36864
    v_mfma_f32_16x16x32_bf16 a[160:163], a[164:167], v[80:83], a[160:163]
    v_exp_f32 v56, v56
    v_mfma_f32_16x16x32_bf16 v[64:67], a[80:83], a[32:35], v[36:39]
    v_exp_f32 v57, v57
    v_mfma_f32_16x16x32_bf16 v[64:67], a[84:87], a[36:39], v[64:67]
    v_exp_f32 v58, v58
    v_mfma_f32_16x16x32_bf16 v[64:67], a[88:91], a[40:43], v[64:67]
    v_cvt_pk_bf16_f32 v76, v56, v57
    v_mfma_f32_16x16x32_bf16 v[64:67], a[92:95], a[44:47], v[64:67]
    v_exp_f32 v59, v59
    v_mfma_f32_16x16x32_bf16 v[68:71], a[96:99], a[32:35], v[36:39]
    v_exp_f32 v60, v60
    v_mfma_f32_16x16x32_bf16 v[68:71], a[100:103], a[36:39], v[68:71]
    v_cvt_pk_bf16_f32 v77, v58, v59
    v_mfma_f32_16x16x32_bf16 v[68:71], a[104:107], a[40:43], v[68:71]
    v_exp_f32 v61, v61
    v_mfma_f32_16x16x32_bf16 v[68:71], a[108:111], a[44:47], v[68:71]
    v_exp_f32 v62, v62
    s_waitcnt lgkmcnt(0)
    v_mfma_f32_16x16x32_bf16 v[84:87], a[112:115], v[72:75], v[84:87]
    v_cvt_pk_bf16_f32 v78, v60, v61
    v_mfma_f32_16x16x32_bf16 v[104:107], a[116:119], v[72:75], v[104:107]
    v_exp_f32 v63, v63
    v_mfma_f32_16x16x32_bf16 v[124:127], a[120:123], v[72:75], v[124:127]
    v_cvt_pk_bf16_f32 v79, v62, v63
    v_mfma_f32_16x16x32_bf16 v[144:147], a[124:127], v[72:75], v[144:147]
    v_exp_f32 v64, v64
    v_mfma_f32_16x16x32_bf16 v[164:167], a[128:131], v[72:75], v[164:167]
    v_exp_f32 v65, v65
    v_mfma_f32_16x16x32_bf16 v[184:187], a[132:135], v[72:75], v[184:187]
    v_exp_f32 v66, v66
    v_mfma_f32_16x16x32_bf16 v[204:207], a[136:139], v[72:75], v[204:207]
    v_cvt_pk_bf16_f32 v80, v64, v65
    v_mfma_f32_16x16x32_bf16 v[224:227], a[140:143], v[72:75], v[224:227]
    v_exp_f32 v67, v67
    v_mfma_f32_16x16x32_bf16 a[144:147], a[164:167], v[72:75], a[144:147]
    v_exp_f32 v68, v68
    v_mfma_f32_16x16x32_bf16 v[48:51], a[80:83], a[48:51], v[40:43]
    v_cvt_pk_bf16_f32 v81, v66, v67
    v_mfma_f32_16x16x32_bf16 v[48:51], a[84:87], a[52:55], v[48:51]
    v_exp_f32 v69, v69
    v_mfma_f32_16x16x32_bf16 v[48:51], a[88:91], a[56:59], v[48:51]
    v_exp_f32 v70, v70
    v_mfma_f32_16x16x32_bf16 v[48:51], a[92:95], a[60:63], v[48:51]
    v_cvt_pk_bf16_f32 v84, v84, v85
    v_cvt_pk_bf16_f32 v85, v86, v87
    v_mfma_f32_16x16x32_bf16 v[52:55], a[96:99], a[48:51], v[40:43]
    v_cvt_pk_bf16_f32 v86, v104, v105
    v_cvt_pk_bf16_f32 v87, v106, v107
    v_mfma_f32_16x16x32_bf16 v[52:55], a[100:103], a[52:55], v[52:55]
    ds_write_b128 v253, v[84:87] offset:0
    v_cvt_pk_bf16_f32 v124, v124, v125
    v_mfma_f32_16x16x32_bf16 v[52:55], a[104:107], a[56:59], v[52:55]
    v_cvt_pk_bf16_f32 v125, v126, v127
    v_cvt_pk_bf16_f32 v126, v144, v145
    v_mfma_f32_16x16x32_bf16 v[52:55], a[108:111], a[60:63], v[52:55]
    v_cvt_pk_bf16_f32 v127, v146, v147
    ds_write_b128 v253, v[124:127] offset:1024
    v_mfma_f32_16x16x32_bf16 v[88:91], a[112:115], v[76:79], v[88:91]
    v_cvt_pk_bf16_f32 v164, v164, v165
    v_cvt_pk_bf16_f32 v165, v166, v167
    v_mfma_f32_16x16x32_bf16 v[108:111], a[116:119], v[76:79], v[108:111]
    v_cvt_pk_bf16_f32 v166, v184, v185
    v_cvt_pk_bf16_f32 v167, v186, v187
    v_mfma_f32_16x16x32_bf16 v[128:131], a[120:123], v[76:79], v[128:131]
    ds_write_b128 v253, v[164:167] offset:2048
    v_cvt_pk_bf16_f32 v204, v204, v205
    v_mfma_f32_16x16x32_bf16 v[148:151], a[124:127], v[76:79], v[148:151]
    v_cvt_pk_bf16_f32 v205, v206, v207
    v_cvt_pk_bf16_f32 v206, v224, v225
    v_mfma_f32_16x16x32_bf16 v[168:171], a[128:131], v[76:79], v[168:171]
    v_cvt_pk_bf16_f32 v207, v226, v227
    ds_write_b128 v253, v[204:207] offset:3072
    v_mfma_f32_16x16x32_bf16 v[188:191], a[132:135], v[76:79], v[188:191]
    v_cvt_pk_bf16_f32 v82, v68, v69
    v_accvgpr_read_b32 v255, a144
    v_mfma_f32_16x16x32_bf16 v[208:211], a[136:139], v[76:79], v[208:211]
    v_exp_f32 v71, v71
    v_mfma_f32_16x16x32_bf16 v[228:231], a[140:143], v[76:79], v[228:231]
    v_cvt_pk_bf16_f32 v83, v70, v71
    ds_write_b32 v254, v255 offset:0
    v_mfma_f32_16x16x32_bf16 a[148:151], a[164:167], v[76:79], a[148:151]
    v_exp_f32 v48, v48
    v_mfma_f32_16x16x32_bf16 v[56:59], a[80:83], a[64:67], v[44:47]
    v_exp_f32 v49, v49
    v_mfma_f32_16x16x32_bf16 v[56:59], a[84:87], a[68:71], v[56:59]
    v_exp_f32 v50, v50
    v_mfma_f32_16x16x32_bf16 v[56:59], a[88:91], a[72:75], v[56:59]
    v_cvt_pk_bf16_f32 v72, v48, v49
    v_mfma_f32_16x16x32_bf16 v[56:59], a[92:95], a[76:79], v[56:59]
    v_cvt_pk_bf16_f32 v88, v88, v89
    v_cvt_pk_bf16_f32 v89, v90, v91
    v_mfma_f32_16x16x32_bf16 v[60:63], a[96:99], a[64:67], v[44:47]
    v_cvt_pk_bf16_f32 v90, v108, v109
    v_cvt_pk_bf16_f32 v91, v110, v111
    v_mfma_f32_16x16x32_bf16 v[60:63], a[100:103], a[68:71], v[60:63]
    v_exp_f32 v51, v51
    v_mfma_f32_16x16x32_bf16 v[60:63], a[104:107], a[72:75], v[60:63]
    v_exp_f32 v52, v52
    v_mfma_f32_16x16x32_bf16 v[60:63], a[108:111], a[76:79], v[60:63]
    v_cvt_pk_bf16_f32 v73, v50, v51
    ds_write_b128 v253, v[88:91] offset:4096
    v_mfma_f32_16x16x32_bf16 v[92:95], a[112:115], v[80:83], v[92:95]
    v_exp_f32 v53, v53
    v_mfma_f32_16x16x32_bf16 v[112:115], a[116:119], v[80:83], v[112:115]
    v_exp_f32 v54, v54
    v_mfma_f32_16x16x32_bf16 v[132:135], a[120:123], v[80:83], v[132:135]
    v_cvt_pk_bf16_f32 v74, v52, v53
    v_cvt_pk_bf16_f32 v128, v128, v129
    v_mfma_f32_16x16x32_bf16 v[152:155], a[124:127], v[80:83], v[152:155]
    v_exp_f32 v55, v55
    v_mfma_f32_16x16x32_bf16 v[172:175], a[128:131], v[80:83], v[172:175]
    v_cvt_pk_bf16_f32 v75, v54, v55
    v_cvt_pk_bf16_f32 v129, v130, v131
    v_mfma_f32_16x16x32_bf16 v[192:195], a[132:135], v[80:83], v[192:195]
    v_cvt_pk_bf16_f32 v130, v148, v149
    v_cvt_pk_bf16_f32 v131, v150, v151
    v_mfma_f32_16x16x32_bf16 v[212:215], a[136:139], v[80:83], v[212:215]
    ds_write_b128 v253, v[128:131] offset:5120
    v_cvt_pk_bf16_f32 v168, v168, v169
    v_mfma_f32_16x16x32_bf16 v[232:235], a[140:143], v[80:83], v[232:235]
    v_cvt_pk_bf16_f32 v169, v170, v171
    v_cvt_pk_bf16_f32 v170, v188, v189
    v_mfma_f32_16x16x32_bf16 a[152:155], a[164:167], v[80:83], a[152:155]
    v_cvt_pk_bf16_f32 v171, v190, v191
    ds_write_b128 v253, v[168:171] offset:6144
    v_mfma_f32_16x16x32_bf16 v[96:99], a[112:115], v[72:75], v[96:99]
    v_cvt_pk_bf16_f32 v208, v208, v209
    v_cvt_pk_bf16_f32 v209, v210, v211
    v_mfma_f32_16x16x32_bf16 v[116:119], a[116:119], v[72:75], v[116:119]
    v_cvt_pk_bf16_f32 v210, v228, v229
    v_cvt_pk_bf16_f32 v211, v230, v231
    v_mfma_f32_16x16x32_bf16 v[136:139], a[120:123], v[72:75], v[136:139]
    ds_write_b128 v253, v[208:211] offset:7168
    v_accvgpr_read_b32 v255, a148
    v_mfma_f32_16x16x32_bf16 v[156:159], a[124:127], v[72:75], v[156:159]
    ds_write_b32 v254, v255 offset:256
    v_cvt_pk_bf16_f32 v92, v92, v93
    v_mfma_f32_16x16x32_bf16 v[176:179], a[128:131], v[72:75], v[176:179]
    v_exp_f32 v56, v56
    v_mfma_f32_16x16x32_bf16 v[196:199], a[132:135], v[72:75], v[196:199]
    v_exp_f32 v57, v57
    v_mfma_f32_16x16x32_bf16 v[216:219], a[136:139], v[72:75], v[216:219]
    v_exp_f32 v58, v58
    v_mfma_f32_16x16x32_bf16 v[236:239], a[140:143], v[72:75], v[236:239]
    v_cvt_pk_bf16_f32 v76, v56, v57
    v_exp_f32 v59, v59
    v_exp_f32 v60, v60
    v_cvt_pk_bf16_f32 v77, v58, v59
    v_exp_f32 v61, v61
    v_exp_f32 v62, v62
    v_cvt_pk_bf16_f32 v78, v60, v61
    v_exp_f32 v63, v63
    s_nop 0
    v_cvt_pk_bf16_f32 v79, v62, v63
    v_mfma_f32_16x16x32_bf16 a[156:159], a[164:167], v[72:75], a[156:159]
    v_cvt_pk_bf16_f32 v93, v94, v95
    v_cvt_pk_bf16_f32 v94, v112, v113
    v_mfma_f32_16x16x32_bf16 v[100:103], a[112:115], v[76:79], v[100:103]
    v_cvt_pk_bf16_f32 v95, v114, v115
    ds_write_b128 v253, v[92:95] offset:32768
    v_mfma_f32_16x16x32_bf16 v[120:123], a[116:119], v[76:79], v[120:123]
    v_cvt_pk_bf16_f32 v132, v132, v133
    v_cvt_pk_bf16_f32 v133, v134, v135
    v_mfma_f32_16x16x32_bf16 v[140:143], a[120:123], v[76:79], v[140:143]
    v_cvt_pk_bf16_f32 v134, v152, v153
    v_cvt_pk_bf16_f32 v135, v154, v155
    v_mfma_f32_16x16x32_bf16 v[160:163], a[124:127], v[76:79], v[160:163]
    ds_write_b128 v253, v[132:135] offset:33792
    v_cvt_pk_bf16_f32 v172, v172, v173
    v_mfma_f32_16x16x32_bf16 v[180:183], a[128:131], v[76:79], v[180:183]
    v_cvt_pk_bf16_f32 v173, v174, v175
    v_cvt_pk_bf16_f32 v174, v192, v193
    v_mfma_f32_16x16x32_bf16 v[200:203], a[132:135], v[76:79], v[200:203]
    v_cvt_pk_bf16_f32 v175, v194, v195
    ds_write_b128 v253, v[172:175] offset:34816
    v_mfma_f32_16x16x32_bf16 v[220:223], a[136:139], v[76:79], v[220:223]
    v_cvt_pk_bf16_f32 v212, v212, v213
    v_cvt_pk_bf16_f32 v213, v214, v215
    v_mfma_f32_16x16x32_bf16 v[240:243], a[140:143], v[76:79], v[240:243]
    v_cvt_pk_bf16_f32 v214, v232, v233
    v_cvt_pk_bf16_f32 v215, v234, v235
    v_mfma_f32_16x16x32_bf16 a[160:163], a[164:167], v[76:79], a[160:163]
    ds_write_b128 v253, v[212:215] offset:35840
    v_accvgpr_read_b32 v255, a152
    ds_write_b32 v254, v255 offset:512
    v_cvt_pk_bf16_f32 v96, v96, v97
    v_cvt_pk_bf16_f32 v97, v98, v99
    v_cvt_pk_bf16_f32 v98, v116, v117
    v_cvt_pk_bf16_f32 v99, v118, v119
    ds_write_b128 v253, v[96:99] offset:36864
    v_cvt_pk_bf16_f32 v136, v136, v137
    v_cvt_pk_bf16_f32 v137, v138, v139
    v_cvt_pk_bf16_f32 v138, v156, v157
    v_cvt_pk_bf16_f32 v139, v158, v159
    ds_write_b128 v253, v[136:139] offset:37888
    v_cvt_pk_bf16_f32 v176, v176, v177
    v_cvt_pk_bf16_f32 v177, v178, v179
    v_cvt_pk_bf16_f32 v178, v196, v197
    v_cvt_pk_bf16_f32 v179, v198, v199
    ds_write_b128 v253, v[176:179] offset:38912
    v_cvt_pk_bf16_f32 v216, v216, v217
    v_cvt_pk_bf16_f32 v217, v218, v219
    v_cvt_pk_bf16_f32 v218, v236, v237
    v_cvt_pk_bf16_f32 v219, v238, v239
    ds_write_b128 v253, v[216:219] offset:39936
    v_accvgpr_read_b32 v255, a156
    ds_write_b32 v254, v255 offset:768
    s_nop 7
    v_add_u32 v44, 0x10000, v253
    v_cvt_pk_bf16_f32 v100, v100, v101
    v_cvt_pk_bf16_f32 v101, v102, v103
    v_cvt_pk_bf16_f32 v102, v120, v121
    v_cvt_pk_bf16_f32 v103, v122, v123
    ds_write_b128 v44, v[100:103] offset:0
    v_cvt_pk_bf16_f32 v140, v140, v141
    v_cvt_pk_bf16_f32 v141, v142, v143
    v_cvt_pk_bf16_f32 v142, v160, v161
    v_cvt_pk_bf16_f32 v143, v162, v163
    ds_write_b128 v44, v[140:143] offset:1024
    v_cvt_pk_bf16_f32 v180, v180, v181
    v_cvt_pk_bf16_f32 v181, v182, v183
    v_cvt_pk_bf16_f32 v182, v200, v201
    v_cvt_pk_bf16_f32 v183, v202, v203
    ds_write_b128 v44, v[180:183] offset:2048
    v_cvt_pk_bf16_f32 v220, v220, v221
    v_cvt_pk_bf16_f32 v221, v222, v223
    v_cvt_pk_bf16_f32 v222, v240, v241
    v_cvt_pk_bf16_f32 v223, v242, v243
    ds_write_b128 v44, v[220:223] offset:3072
    v_accvgpr_read_b32 v255, a160
    ds_write_b32 v254, v255 offset:1024
    s_lshl_b32 s28, s21, 5
    v_mov_b32 v83, s28
    buffer_load_dword v82, v83, s[60:63], 0 offen sc1
    s_add_u32 s100, s94, 0
    s_add_u32 m0, s24, 131072
    s_nop 0
    buffer_load_dwordx4 v244, s[52:55], s100 offen offset:0 lds
    buffer_load_dwordx4 v245, s[52:55], s100 offen offset:1024 lds
    buffer_load_dwordx4 v246, s[52:55], s100 offen offset:2048 lds
    buffer_load_dwordx4 v247, s[52:55], s100 offen offset:3072 lds
    s_add_u32 s100, s94, 16384
    s_add_u32 m0, s24, 135168
    s_nop 0
    buffer_load_dwordx4 v244, s[52:55], s100 offen offset:0 lds
    buffer_load_dwordx4 v245, s[52:55], s100 offen offset:1024 lds
    buffer_load_dwordx4 v246, s[52:55], s100 offen offset:2048 lds
    buffer_load_dwordx4 v247, s[52:55], s100 offen offset:3072 lds
    s_lshl_b32 s28, s20, 10
    v_add_u32 v5, s28, v252
    v_add_u32 v45, 0x10000, v5
    v_lshlrev_b32 v6, 2, v0
    v_add_u32 v6, 69632, v6
    s_waitcnt lgkmcnt(0)
    s_barrier
    ds_read_b128 v[84:87], v5 offset:0
    ds_read_b128 v[88:91], v5 offset:8192
    ds_read_b128 v[92:95], v5 offset:16384
    ds_read_b128 v[96:99], v5 offset:24576
    ds_read_b128 v[100:103], v5 offset:4096
    ds_read_b128 v[104:107], v5 offset:12288
    ds_read_b128 v[108:111], v5 offset:20480
    ds_read_b128 v[112:115], v5 offset:28672
    s_lshl_b32 s28, s20, 10
    v_add_u32 v44, s28, v252
    v_add_u32 v44, 65536, v44
    s_lshl_b32 s31, s65, 2
    s_add_u32 s31, s31, s22
    s_mul_i32 s31, s31, 20480
    s_add_u32 s93, s31, s28
    s_add_u32 s93, s93, 29360128
    s_waitcnt lgkmcnt(7)
    v_mfma_f32_16x16x32_bf16 v[164:167], a[168:171], v[84:87], 0
    ds_read_b128 v[116:119], v5 offset:32768
    v_mfma_f32_16x16x32_bf16 v[168:171], a[172:175], v[84:87], 0
    s_waitcnt lgkmcnt(7)
    v_mfma_f32_16x16x32_bf16 v[164:167], a[168:171], v[88:91], v[164:167]
    ds_read_b128 v[120:123], v5 offset:40960
    ds_read_b32 v56, v6 offset:0
    v_mfma_f32_16x16x32_bf16 v[168:171], a[172:175], v[88:91], v[168:171]
    ds_read_b32 v57, v6 offset:8192
    ds_read_b32 v58, v6 offset:16384
    s_waitcnt lgkmcnt(7)
    v_mfma_f32_16x16x32_bf16 v[164:167], a[168:171], v[92:95], v[164:167]
    ds_read_b128 v[124:127], v5 offset:49152
    ds_read_b32 v59, v6 offset:24576
    v_mfma_f32_16x16x32_bf16 v[168:171], a[172:175], v[92:95], v[168:171]
    ds_read_b32 v60, v6 offset:256
    ds_read_b32 v61, v6 offset:8448
    v_mfma_f32_16x16x32_bf16 v[164:167], a[168:171], v[96:99], v[164:167]
    ds_read_b32 v62, v6 offset:16640
    ds_read_b32 v63, v6 offset:24832
    v_mfma_f32_16x16x32_bf16 v[168:171], a[172:175], v[96:99], v[168:171]
    ds_read_b32 v64, v6 offset:512
    ds_read_b32 v65, v6 offset:8704
    v_mfma_f32_16x16x32_bf16 v[172:175], a[168:171], v[100:103], 0
    ds_read_b32 v66, v6 offset:16896
    ds_read_b32 v67, v6 offset:25088
    v_mfma_f32_16x16x32_bf16 v[176:179], a[172:175], v[100:103], 0
    ds_read_b32 v68, v6 offset:768
    ds_read_b32 v69, v6 offset:8960
    v_mfma_f32_16x16x32_bf16 v[172:175], a[168:171], v[104:107], v[172:175]
    ds_read_b32 v70, v6 offset:17152
    ds_read_b32 v71, v6 offset:25344
    v_mfma_f32_16x16x32_bf16 v[176:179], a[172:175], v[104:107], v[176:179]
    ds_read_b32 v72, v6 offset:1024
    ds_read_b32 v73, v6 offset:9216
    s_waitcnt lgkmcnt(12)
    v_mfma_f32_16x16x32_bf16 v[172:175], a[168:171], v[108:111], v[172:175]
    ds_read_b32 v74, v6 offset:17408
    ds_read_b32 v75, v6 offset:25600
    v_mfma_f32_16x16x32_bf16 v[176:179], a[172:175], v[108:111], v[176:179]
    ds_read_b128 v[128:131], v5 offset:57344
    ds_read_b128 v[132:135], v5 offset:36864
    v_mfma_f32_16x16x32_bf16 v[172:175], a[168:171], v[112:115], v[172:175]
    ds_read_b128 v[136:139], v5 offset:45056
    ds_read_b128 v[140:143], v5 offset:53248
    v_mfma_f32_16x16x32_bf16 v[176:179], a[172:175], v[112:115], v[176:179]
    ds_read_b128 v[144:147], v5 offset:61440
    v_add_f32 v56, v56, v57
    v_mfma_f32_16x16x32_bf16 v[180:183], a[168:171], v[116:119], 0
    ds_read_b128 v[148:151], v45 offset:0
    v_add_f32 v58, v58, v59
    v_mfma_f32_16x16x32_bf16 v[184:187], a[172:175], v[116:119], 0
    v_add_f32 v56, v56, v58
    v_add_f32 v60, v60, v61
    v_mfma_f32_16x16x32_bf16 v[180:183], a[168:171], v[120:123], v[180:183]
    ds_read_b128 v[152:155], v45 offset:8192
    s_waitcnt lgkmcnt(7)
    v_add_f32 v62, v62, v63
    v_mfma_f32_16x16x32_bf16 v[184:187], a[172:175], v[120:123], v[184:187]
    v_add_f32 v60, v60, v62
    s_add_u32 s100, s95, 0
    v_mfma_f32_16x16x32_bf16 v[180:183], a[168:171], v[124:127], v[180:183]
    ds_read_b128 v[156:159], v45 offset:16384
    v_add_f32 v64, v64, v65
    v_mfma_f32_16x16x32_bf16 v[184:187], a[172:175], v[124:127], v[184:187]
    v_add_f32 v66, v66, v67
    s_add_u32 m0, s24, 98304
    s_waitcnt lgkmcnt(3)
    v_mfma_f32_16x16x32_bf16 v[180:183], a[168:171], v[128:131], v[180:183]
    ds_read_b128 v[160:163], v45 offset:24576
    v_add_f32 v64, v64, v66
    v_mfma_f32_16x16x32_bf16 v[184:187], a[172:175], v[128:131], v[184:187]
    v_add_f32 v68, v68, v69
    buffer_load_dwordx4 v244, s[52:55], s100 offen offset:0 lds
    v_mfma_f32_16x16x32_bf16 v[188:191], a[168:171], v[132:135], 0
    v_add_f32 v70, v70, v71
    buffer_load_dwordx4 v245, s[52:55], s100 offen offset:1024 lds
    v_mfma_f32_16x16x32_bf16 v[192:195], a[172:175], v[132:135], 0
    v_add_f32 v68, v68, v70
    buffer_load_dwordx4 v246, s[52:55], s100 offen offset:2048 lds
    v_mfma_f32_16x16x32_bf16 v[188:191], a[168:171], v[136:139], v[188:191]
    v_add_f32 v72, v72, v73
    buffer_load_dwordx4 v247, s[52:55], s100 offen offset:3072 lds
    v_mfma_f32_16x16x32_bf16 v[192:195], a[172:175], v[136:139], v[192:195]
    v_add_f32 v74, v74, v75
    s_add_u32 s100, s95, 16384
    v_mfma_f32_16x16x32_bf16 v[188:191], a[168:171], v[140:143], v[188:191]
    v_add_f32 v72, v72, v74
    s_add_u32 m0, s24, 102400
    v_mfma_f32_16x16x32_bf16 v[192:195], a[172:175], v[140:143], v[192:195]
    v_max3_f32 v46, v56, v60, v64
    buffer_load_dwordx4 v244, s[52:55], s100 offen offset:0 lds
    v_mfma_f32_16x16x32_bf16 v[188:191], a[168:171], v[144:147], v[188:191]
    v_max3_f32 v46, v46, v68, v72
    buffer_load_dwordx4 v245, s[52:55], s100 offen offset:1024 lds
    v_mfma_f32_16x16x32_bf16 v[192:195], a[172:175], v[144:147], v[192:195]
    v_min3_f32 v47, v56, v60, v64
    buffer_load_dwordx4 v246, s[52:55], s100 offen offset:2048 lds
    s_waitcnt lgkmcnt(0)
    v_mfma_f32_16x16x32_bf16 v[196:199], a[168:171], v[148:151], 0
    v_min3_f32 v47, v47, v68, v72
    buffer_load_dwordx4 v247, s[52:55], s100 offen offset:3072 lds
    v_mfma_f32_16x16x32_bf16 v[200:203], a[172:175], v[148:151], 0
    s_mov_b32 s29, 0x21800000
    v_mfma_f32_16x16x32_bf16 v[196:199], a[168:171], v[152:155], v[196:199]
    s_mov_b32 s30, 0x5d800000
    v_mfma_f32_16x16x32_bf16 v[200:203], a[172:175], v[152:155], v[200:203]
    v_cmp_nle_f32 s[90:91], v46, s30
    v_mfma_f32_16x16x32_bf16 v[196:199], a[168:171], v[156:159], v[196:199]
    v_cmp_nge_f32 vcc, v47, s29
    v_mfma_f32_16x16x32_bf16 v[200:203], a[172:175], v[156:159], v[200:203]
    v_rcp_f32 v56, v56
    v_mfma_f32_16x16x32_bf16 v[196:199], a[168:171], v[160:163], v[196:199]
    v_rcp_f32 v60, v60
    v_mfma_f32_16x16x32_bf16 v[200:203], a[172:175], v[160:163], v[200:203]
    v_rcp_f32 v64, v64
    v_rcp_f32 v68, v68
    v_rcp_f32 v72, v72
    s_or_b64 s[90:91], s[90:91], vcc
    s_cmp_lg_u64 s[90:91], 0
    s_cselect_b32 s31, 1, 0
    s_cmp_eq_u32 s27, 0
    s_cselect_b32 s31, s31, 0
    s_cmp_lg_u32 s31, 0
    s_cbranch_scc1 L_fallback
    v_mul_f32 v164, v164, v56
    v_mul_f32 v165, v165, v56
    v_mul_f32 v166, v166, v56
    v_mul_f32 v167, v167, v56
    v_mul_f32 v168, v168, v56
    v_mul_f32 v169, v169, v56
    v_mul_f32 v170, v170, v56
    v_mul_f32 v171, v171, v56
    v_cvt_pk_bf16_f32 v164, v164, v165
    v_cvt_pk_bf16_f32 v165, v166, v167
    v_cvt_pk_bf16_f32 v166, v168, v169
    v_cvt_pk_bf16_f32 v167, v170, v171
    s_add_u32 s28, s93, 0
    buffer_store_dwordx4 v[164:167], v252, s[40:43], s28 offen sc1
    v_mul_f32 v172, v172, v60
    v_mul_f32 v173, v173, v60
    v_mul_f32 v174, v174, v60
    v_mul_f32 v175, v175, v60
    v_mul_f32 v176, v176, v60
    v_mul_f32 v177, v177, v60
    v_mul_f32 v178, v178, v60
    v_mul_f32 v179, v179, v60
    v_cvt_pk_bf16_f32 v172, v172, v173
    v_cvt_pk_bf16_f32 v173, v174, v175
    v_cvt_pk_bf16_f32 v174, v176, v177
    v_cvt_pk_bf16_f32 v175, v178, v179
    s_add_u32 s28, s93, 4096
    buffer_store_dwordx4 v[172:175], v252, s[40:43], s28 offen sc1
    v_mul_f32 v180, v180, v64
    v_mul_f32 v181, v181, v64
    v_mul_f32 v182, v182, v64
    v_mul_f32 v183, v183, v64
    v_mul_f32 v184, v184, v64
    v_mul_f32 v185, v185, v64
    v_mul_f32 v186, v186, v64
    v_mul_f32 v187, v187, v64
    v_cvt_pk_bf16_f32 v180, v180, v181
    v_cvt_pk_bf16_f32 v181, v182, v183
    v_cvt_pk_bf16_f32 v182, v184, v185
    v_cvt_pk_bf16_f32 v183, v186, v187
    s_add_u32 s28, s93, 8192
    buffer_store_dwordx4 v[180:183], v252, s[40:43], s28 offen sc1
    v_mul_f32 v188, v188, v68
    v_mul_f32 v189, v189, v68
    v_mul_f32 v190, v190, v68
    v_mul_f32 v191, v191, v68
    v_mul_f32 v192, v192, v68
    v_mul_f32 v193, v193, v68
    v_mul_f32 v194, v194, v68
    v_mul_f32 v195, v195, v68
    v_cvt_pk_bf16_f32 v188, v188, v189
    v_cvt_pk_bf16_f32 v189, v190, v191
    v_cvt_pk_bf16_f32 v190, v192, v193
    v_cvt_pk_bf16_f32 v191, v194, v195
    s_add_u32 s28, s93, 12288
    buffer_store_dwordx4 v[188:191], v252, s[40:43], s28 offen sc1
    v_mul_f32 v196, v196, v72
    v_mul_f32 v197, v197, v72
    v_mul_f32 v198, v198, v72
    v_mul_f32 v199, v199, v72
    v_mul_f32 v200, v200, v72
    v_mul_f32 v201, v201, v72
    v_mul_f32 v202, v202, v72
    v_mul_f32 v203, v203, v72
    v_cvt_pk_bf16_f32 v196, v196, v197
    v_cvt_pk_bf16_f32 v197, v198, v199
    v_cvt_pk_bf16_f32 v198, v200, v201
    v_cvt_pk_bf16_f32 v199, v202, v203
    s_add_u32 s28, s93, 16384
    buffer_store_dwordx4 v[196:199], v252, s[40:43], s28 offen sc1
    s_waitcnt lgkmcnt(0)
    s_barrier
    ds_write_b128 v44, v[164:167] offset:0
    ds_write_b128 v44, v[172:175] offset:4096
    ds_write_b128 v44, v[180:183] offset:8192
    ds_write_b128 v44, v[188:191] offset:12288
    ds_write_b128 v44, v[196:199] offset:16384
    s_add_u32 s100, s96, 0
    s_add_u32 m0, s24, 0
    s_nop 0
    buffer_load_dwordx4 v244, s[52:55], s100 offen offset:0 lds
    buffer_load_dwordx4 v245, s[52:55], s100 offen offset:1024 lds
    buffer_load_dwordx4 v246, s[52:55], s100 offen offset:2048 lds
    buffer_load_dwordx4 v247, s[52:55], s100 offen offset:3072 lds
    s_add_u32 s100, s96, 16384
    s_add_u32 m0, s24, 4096
    s_nop 0
    buffer_load_dwordx4 v244, s[52:55], s100 offen offset:0 lds
    buffer_load_dwordx4 v245, s[52:55], s100 offen offset:1024 lds
    buffer_load_dwordx4 v246, s[52:55], s100 offen offset:2048 lds
    buffer_load_dwordx4 v247, s[52:55], s100 offen offset:3072 lds
    s_add_u32 s100, s97, 0
    s_add_u32 m0, s24, 32768
    s_nop 0
    buffer_load_dwordx4 v244, s[52:55], s100 offen offset:0 lds
    buffer_load_dwordx4 v245, s[52:55], s100 offen offset:1024 lds
    buffer_load_dwordx4 v246, s[52:55], s100 offen offset:2048 lds
    buffer_load_dwordx4 v247, s[52:55], s100 offen offset:3072 lds
    s_add_u32 s100, s97, 16384
    s_add_u32 m0, s24, 36864
    s_nop 0
    buffer_load_dwordx4 v244, s[52:55], s100 offen offset:0 lds
    buffer_load_dwordx4 v245, s[52:55], s100 offen offset:1024 lds
    buffer_load_dwordx4 v246, s[52:55], s100 offen offset:2048 lds
    buffer_load_dwordx4 v247, s[52:55], s100 offen offset:3072 lds
    s_lshl_b32 s30, s65, 7
    s_add_u32 s30, s30, 41943040
    s_add_u32 s30, s30, 65536
    s_lshl_b32 s28, s22, 2
    s_add_u32 s28, s28, s20
    s_lshl_b32 s28, s28, 3
    s_add_u32 s31, s30, s28
    v_add_u32 v76, 0x10000, v26
    v_add_u32 v77, 0x10000, v27
    v_add_u32 v78, 0x20000, v26
    v_add_u32 v79, 0x20000, v27
    s_waitcnt vmcnt(16)
    s_cmp_lg_u32 s64, 0
    s_cbranch_scc1 L_have_nonce
    v_readfirstlane_b32 s64, v82
    s_nop 3
    s_cmp_lg_u32 s64, 0
    s_cbranch_scc1 L_have_nonce
    s_lshl_b32 s28, s21, 5
    v_mov_b32 v4, s28
    s_mov_b32 s29, 0
L_nonce_poll:
    buffer_load_dword v5, v4, s[60:63], 0 offen sc1
    s_waitcnt vmcnt(0)
    v_readfirstlane_b32 s64, v5
    s_nop 3
    s_cmp_lg_u32 s64, 0
    s_cbranch_scc1 L_have_nonce
    s_add_u32 s29, s29, 1
    s_cmp_lt_u32 s29, 0x40000
    s_cbranch_scc0 L_have_nonce
    s_sleep 2
    s_branch L_nonce_poll
L_have_nonce:
    v_mov_b32 v4, s31
    v_mov_b32 v6, s64
    v_mov_b32 v7, 0
    s_mov_b64 exec, 1
    buffer_store_dwordx2 v[6:7], v4, s[40:43], 0 offen sc1
    s_mov_b64 exec, -1
    s_waitcnt lgkmcnt(0)
    s_barrier
    v_mov_b32 v248, v252
    v_add_u32 v249, 0x10000, v252
    v_add_u32 v250, 0x20000, v252
    ds_read_b64_tr_b16 a[0:1], v78 offset:0
    ds_read_b64_tr_b16 a[2:3], v78 offset:4096
    ds_read_b64_tr_b16 a[4:5], v79 offset:0
    ds_read_b64_tr_b16 a[6:7], v79 offset:4096
    ds_read_b64_tr_b16 a[8:9], v78 offset:8192
    ds_read_b64_tr_b16 a[10:11], v78 offset:12288
    ds_read_b64_tr_b16 a[12:13], v79 offset:8192
    ds_read_b64_tr_b16 a[14:15], v79 offset:12288
    ds_read_b64_tr_b16 a[16:17], v78 offset:16384
    ds_read_b64_tr_b16 a[18:19], v78 offset:20480
    ds_read_b64_tr_b16 a[20:21], v79 offset:16384
    ds_read_b64_tr_b16 a[22:23], v79 offset:20480
    ds_read_b64_tr_b16 a[24:25], v78 offset:24576
    ds_read_b64_tr_b16 a[26:27], v78 offset:28672
    ds_read_b64_tr_b16 a[28:29], v79 offset:24576
    ds_read_b64_tr_b16 a[30:31], v79 offset:28672
    ds_read_b64_tr_b16 a[32:33], v76 offset:32768
    ds_read_b64_tr_b16 a[34:35], v76 offset:36864
    ds_read_b64_tr_b16 a[36:37], v77 offset:32768
    ds_read_b64_tr_b16 a[38:39], v77 offset:36864
    ds_read_b64_tr_b16 a[40:41], v76 offset:40960
    ds_read_b64_tr_b16 a[42:43], v76 offset:45056
    ds_read_b64_tr_b16 a[44:45], v77 offset:40960
    ds_read_b64_tr_b16 a[46:47], v77 offset:45056
    ds_read_b64_tr_b16 a[48:49], v76 offset:49152
    ds_read_b64_tr_b16 a[50:51], v76 offset:53248
    ds_read_b64_tr_b16 a[52:53], v77 offset:49152
    ds_read_b64_tr_b16 a[54:55], v77 offset:53248
    ds_read_b64_tr_b16 a[56:57], v76 offset:57344
    ds_read_b64_tr_b16 a[58:59], v76 offset:61440
    ds_read_b64_tr_b16 a[60:61], v77 offset:57344
    ds_read_b64_tr_b16 a[62:63], v77 offset:61440
    ds_read_b128 v[28:31], v249 offset:0
    ds_read_b128 v[32:35], v249 offset:4096
    ds_read_b128 v[36:39], v249 offset:8192
    ds_read_b128 v[40:43], v249 offset:12288
    ds_read_b128 v[44:47], v249 offset:16384
    ds_read_b128 v[48:51], v249 offset:1024
    s_waitcnt lgkmcnt(5)
    v_mfma_f32_16x16x32_bf16 v[84:87], a[0:3], v[28:31], 0
    ds_read_b128 v[52:55], v249 offset:5120
    v_mfma_f32_16x16x32_bf16 v[104:107], a[4:7], v[28:31], 0
    s_waitcnt lgkmcnt(5)
    v_mfma_f32_16x16x32_bf16 v[88:91], a[0:3], v[32:35], 0
    ds_read_b128 v[56:59], v249 offset:9216
    v_mfma_f32_16x16x32_bf16 v[108:111], a[4:7], v[32:35], 0
    s_waitcnt lgkmcnt(5)
    v_mfma_f32_16x16x32_bf16 v[92:95], a[0:3], v[36:39], 0
    ds_read_b128 v[60:63], v249 offset:13312
    v_mfma_f32_16x16x32_bf16 v[112:115], a[4:7], v[36:39], 0
    s_waitcnt lgkmcnt(5)
    v_mfma_f32_16x16x32_bf16 v[96:99], a[0:3], v[40:43], 0
    ds_read_b128 v[64:67], v249 offset:17408
    v_mfma_f32_16x16x32_bf16 v[116:119], a[4:7], v[40:43], 0
    s_waitcnt lgkmcnt(3)
    v_mfma_f32_16x16x32_bf16 v[100:103], a[0:3], v[44:47], 0
    ds_read_b128 v[68:71], v249 offset:2048
    v_mfma_f32_16x16x32_bf16 v[120:123], a[4:7], v[44:47], 0
    v_mfma_f32_16x16x32_bf16 v[84:87], a[8:11], v[48:51], v[84:87]
    ds_read_b128 v[72:75], v249 offset:6144
    v_mfma_f32_16x16x32_bf16 v[104:107], a[12:15], v[48:51], v[104:107]
    v_mfma_f32_16x16x32_bf16 v[88:91], a[8:11], v[52:55], v[88:91]
    ds_read_b128 v[28:31], v249 offset:10240
    v_mfma_f32_16x16x32_bf16 v[108:111], a[12:15], v[52:55], v[108:111]
    s_waitcnt lgkmcnt(4)
    v_mfma_f32_16x16x32_bf16 v[92:95], a[8:11], v[56:59], v[92:95]
    ds_read_b128 v[32:35], v249 offset:14336
    v_mfma_f32_16x16x32_bf16 v[112:115], a[12:15], v[56:59], v[112:115]
    v_mfma_f32_16x16x32_bf16 v[96:99], a[8:11], v[60:63], v[96:99]
    ds_read_b128 v[36:39], v249 offset:18432
    v_mfma_f32_16x16x32_bf16 v[116:119], a[12:15], v[60:63], v[116:119]
    s_waitcnt lgkmcnt(4)
    v_mfma_f32_16x16x32_bf16 v[100:103], a[8:11], v[64:67], v[100:103]
    ds_read_b128 v[40:43], v249 offset:3072
    v_mfma_f32_16x16x32_bf16 v[120:123], a[12:15], v[64:67], v[120:123]
    v_mfma_f32_16x16x32_bf16 v[84:87], a[16:19], v[68:71], v[84:87]
    ds_read_b128 v[44:47], v249 offset:7168
    v_mfma_f32_16x16x32_bf16 v[104:107], a[20:23], v[68:71], v[104:107]
    s_waitcnt lgkmcnt(4)
    v_mfma_f32_16x16x32_bf16 v[88:91], a[16:19], v[72:75], v[88:91]
    ds_read_b128 v[48:51], v249 offset:11264
    v_mfma_f32_16x16x32_bf16 v[108:111], a[20:23], v[72:75], v[108:111]
    v_mfma_f32_16x16x32_bf16 v[92:95], a[16:19], v[28:31], v[92:95]
    ds_read_b128 v[52:55], v249 offset:15360
    v_mfma_f32_16x16x32_bf16 v[112:115], a[20:23], v[28:31], v[112:115]
    s_waitcnt lgkmcnt(4)
    v_mfma_f32_16x16x32_bf16 v[96:99], a[16:19], v[32:35], v[96:99]
    ds_read_b128 v[56:59], v249 offset:19456
    v_mfma_f32_16x16x32_bf16 v[116:119], a[20:23], v[32:35], v[116:119]
    v_mfma_f32_16x16x32_bf16 v[100:103], a[16:19], v[36:39], v[100:103]
    v_mfma_f32_16x16x32_bf16 v[120:123], a[20:23], v[36:39], v[120:123]
    s_waitcnt lgkmcnt(3)
    v_mfma_f32_16x16x32_bf16 v[84:87], a[24:27], v[40:43], v[84:87]
    v_mfma_f32_16x16x32_bf16 v[104:107], a[28:31], v[40:43], v[104:107]
    v_mfma_f32_16x16x32_bf16 v[88:91], a[24:27], v[44:47], v[88:91]
    v_mfma_f32_16x16x32_bf16 v[108:111], a[28:31], v[44:47], v[108:111]
    s_waitcnt lgkmcnt(1)
    v_mfma_f32_16x16x32_bf16 v[92:95], a[24:27], v[48:51], v[92:95]
    v_mfma_f32_16x16x32_bf16 v[112:115], a[28:31], v[48:51], v[112:115]
    v_mfma_f32_16x16x32_bf16 v[96:99], a[24:27], v[52:55], v[96:99]
    v_mfma_f32_16x16x32_bf16 v[116:119], a[28:31], v[52:55], v[116:119]
    s_waitcnt lgkmcnt(0)
    v_mfma_f32_16x16x32_bf16 v[100:103], a[24:27], v[56:59], v[100:103]
    v_mfma_f32_16x16x32_bf16 v[120:123], a[28:31], v[56:59], v[120:123]
    s_cmp_eq_u32 s20, 0
    s_cbranch_scc0 L_nopoll2
    v_and_b32 v4, 15, v0
    v_lshlrev_b32 v4, 3, v4
    v_add_u32 v4, s30, v4
    s_mov_b32 s29, 0
L_pf5:
    buffer_load_dwordx2 v[6:7], v4, s[40:43], 0 offen sc1
    s_waitcnt vmcnt(0)
    v_cmp_ne_u32 vcc, s64, v6
    s_nop 3
    s_cbranch_vccz L_pf5_ok
    s_add_u32 s29, s29, 1
    s_cmp_lt_u32 s29, 0x40000
    s_sleep 1
    s_cbranch_scc1 L_pf5
L_pf5_ok:
L_nopoll2:
    s_waitcnt vmcnt(0)
    s_waitcnt lgkmcnt(0)
    s_barrier
    s_mul_i32 s31, s20, 5120
    s_mul_i32 s93, s65, 81920
    s_add_u32 s93, s93, s31
    s_add_u32 s93, s93, 29360128
    s_add_u32 s29, s22, 1
    s_and_b32 s29, s29, 3
    s_mul_i32 s29, s29, 20480
    s_add_u32 s29, s29, s93
    s_add_u32 m0, s31, 86016
    s_nop 0
    buffer_load_dwordx4 v252, s[40:43], s29 offen offset:0 sc1 lds
    buffer_load_dwordx4 v252, s[40:43], s29 offen offset:1024 sc1 lds
    buffer_load_dwordx4 v252, s[40:43], s29 offen offset:2048 sc1 lds
    buffer_load_dwordx4 v252, s[40:43], s29 offen offset:3072 sc1 lds
    s_add_u32 s29, s29, 4096
    s_add_u32 m0, s31, 90112
    s_nop 0
    buffer_load_dwordx4 v252, s[40:43], s29 offen offset:0 sc1 lds
    s_add_u32 s29, s22, 2
    s_and_b32 s29, s29, 3
    s_mul_i32 s29, s29, 20480
    s_add_u32 s29, s29, s93
    s_add_u32 m0, s31, 106496
    s_nop 0
    buffer_load_dwordx4 v252, s[40:43], s29 offen offset:0 sc1 lds
    buffer_load_dwordx4 v252, s[40:43], s29 offen offset:1024 sc1 lds
    buffer_load_dwordx4 v252, s[40:43], s29 offen offset:2048 sc1 lds
    buffer_load_dwordx4 v252, s[40:43], s29 offen offset:3072 sc1 lds
    s_add_u32 s29, s29, 4096
    s_add_u32 m0, s31, 110592
    s_nop 0
    buffer_load_dwordx4 v252, s[40:43], s29 offen offset:0 sc1 lds
    ds_read_b64_tr_b16 a[64:65], v26 offset:0
    ds_read_b64_tr_b16 a[66:67], v26 offset:4096
    ds_read_b64_tr_b16 a[68:69], v27 offset:0
    ds_read_b64_tr_b16 a[70:71], v27 offset:4096
    ds_read_b64_tr_b16 a[72:73], v26 offset:8192
    ds_read_b64_tr_b16 a[74:75], v26 offset:12288
    ds_read_b64_tr_b16 a[76:77], v27 offset:8192
    ds_read_b64_tr_b16 a[78:79], v27 offset:12288
    ds_read_b64_tr_b16 a[80:81], v26 offset:16384
    ds_read_b64_tr_b16 a[82:83], v26 offset:20480
    ds_read_b64_tr_b16 a[84:85], v27 offset:16384
    ds_read_b64_tr_b16 a[86:87], v27 offset:20480
    ds_read_b64_tr_b16 a[88:89], v26 offset:24576
    ds_read_b64_tr_b16 a[90:91], v26 offset:28672
    ds_read_b64_tr_b16 a[92:93], v27 offset:24576
    ds_read_b64_tr_b16 a[94:95], v27 offset:28672
    s_waitcnt vmcnt(5)
    s_barrier
    ds_read_b128 v[60:63], v249 offset:20480
    ds_read_b128 v[64:67], v249 offset:24576
    ds_read_b128 v[68:71], v249 offset:28672
    ds_read_b128 v[72:75], v249 offset:32768
    ds_read_b128 v[28:31], v249 offset:36864
    ds_read_b128 v[32:35], v249 offset:21504
    s_waitcnt lgkmcnt(5)
    v_mfma_f32_16x16x32_bf16 v[84:87], a[32:35], v[60:63], v[84:87]
    ds_read_b128 v[36:39], v249 offset:25600
    v_mfma_f32_16x16x32_bf16 v[104:107], a[36:39], v[60:63], v[104:107]
    s_waitcnt lgkmcnt(5)
    v_mfma_f32_16x16x32_bf16 v[88:91], a[32:35], v[64:67], v[88:91]
    s_add_u32 s29, s22, 3
    s_and_b32 s29, s29, 3
    v_mfma_f32_16x16x32_bf16 v[108:111], a[36:39], v[64:67], v[108:111]
    s_mul_i32 s29, s29, 20480
    s_add_u32 s29, s29, s93
    s_waitcnt lgkmcnt(4)
    v_mfma_f32_16x16x32_bf16 v[92:95], a[32:35], v[68:71], v[92:95]
    s_add_u32 m0, s31, 126976
    s_nop 0
    buffer_load_dwordx4 v252, s[40:43], s29 offen offset:0 sc1 lds
    v_mfma_f32_16x16x32_bf16 v[112:115], a[36:39], v[68:71], v[112:115]
    ds_read_b128 v[40:43], v249 offset:29696
    ds_read_b128 v[44:47], v249 offset:33792
    s_waitcnt lgkmcnt(3)
    v_mfma_f32_16x16x32_bf16 v[96:99], a[32:35], v[72:75], v[96:99]
    ds_read_b128 v[48:51], v249 offset:37888
    ds_read_b64_tr_b16 a[96:97], v26 offset:32768
    v_mfma_f32_16x16x32_bf16 v[116:119], a[36:39], v[72:75], v[116:119]
    ds_read_b64_tr_b16 a[98:99], v26 offset:36864
    v_mfma_f32_16x16x32_bf16 v[100:103], a[32:35], v[28:31], v[100:103]
    buffer_load_dwordx4 v252, s[40:43], s29 offen offset:1024 sc1 lds
    ds_read_b128 v[52:55], v249 offset:22528
    v_mfma_f32_16x16x32_bf16 v[120:123], a[36:39], v[28:31], v[120:123]
    ds_read_b64_tr_b16 a[100:101], v27 offset:32768
    v_mfma_f32_16x16x32_bf16 v[84:87], a[40:43], v[32:35], v[84:87]
    ds_read_b128 v[56:59], v249 offset:26624
    ds_read_b64_tr_b16 a[102:103], v27 offset:36864
    v_mfma_f32_16x16x32_bf16 v[104:107], a[44:47], v[32:35], v[104:107]
    s_waitcnt lgkmcnt(7)
    v_mfma_f32_16x16x32_bf16 v[88:91], a[40:43], v[36:39], v[88:91]
    ds_read_b128 v[60:63], v249 offset:30720
    ds_read_b64_tr_b16 a[104:105], v26 offset:40960
    v_mfma_f32_16x16x32_bf16 v[108:111], a[44:47], v[36:39], v[108:111]
    v_mfma_f32_16x16x32_bf16 v[92:95], a[40:43], v[40:43], v[92:95]
    buffer_load_dwordx4 v252, s[40:43], s29 offen offset:2048 sc1 lds
    ds_read_b128 v[64:67], v249 offset:34816
    v_mfma_f32_16x16x32_bf16 v[112:115], a[44:47], v[40:43], v[112:115]
    ds_read_b64_tr_b16 a[106:107], v26 offset:45056
    v_mfma_f32_16x16x32_bf16 v[96:99], a[40:43], v[44:47], v[96:99]
    ds_read_b128 v[68:71], v249 offset:38912
    ds_read_b64_tr_b16 a[108:109], v27 offset:40960
    v_mfma_f32_16x16x32_bf16 v[116:119], a[44:47], v[44:47], v[116:119]
    s_waitcnt lgkmcnt(6)
    v_mfma_f32_16x16x32_bf16 v[100:103], a[40:43], v[48:51], v[100:103]
    ds_read_b128 v[72:75], v249 offset:23552
    ds_read_b64_tr_b16 a[110:111], v27 offset:45056
    v_mfma_f32_16x16x32_bf16 v[120:123], a[44:47], v[48:51], v[120:123]
    v_mfma_f32_16x16x32_bf16 v[84:87], a[48:51], v[52:55], v[84:87]
    buffer_load_dwordx4 v252, s[40:43], s29 offen offset:3072 sc1 lds
    ds_read_b128 v[28:31], v249 offset:27648
    v_mfma_f32_16x16x32_bf16 v[104:107], a[52:55], v[52:55], v[104:107]
    ds_read_b64_tr_b16 a[112:113], v26 offset:49152
    v_mfma_f32_16x16x32_bf16 v[88:91], a[48:51], v[56:59], v[88:91]
    ds_read_b128 v[32:35], v249 offset:31744
    ds_read_b64_tr_b16 a[114:115], v26 offset:53248
    v_mfma_f32_16x16x32_bf16 v[108:111], a[52:55], v[56:59], v[108:111]
    s_waitcnt lgkmcnt(6)
    v_mfma_f32_16x16x32_bf16 v[92:95], a[48:51], v[60:63], v[92:95]
    ds_read_b128 v[36:39], v249 offset:35840
    ds_read_b64_tr_b16 a[116:117], v27 offset:49152
    v_mfma_f32_16x16x32_bf16 v[112:115], a[52:55], v[60:63], v[112:115]
    v_mfma_f32_16x16x32_bf16 v[96:99], a[48:51], v[64:67], v[96:99]
    s_add_u32 s29, s29, 4096
    s_add_u32 m0, s31, 131072
    v_mfma_f32_16x16x32_bf16 v[116:119], a[52:55], v[64:67], v[116:119]
    buffer_load_dwordx4 v252, s[40:43], s29 offen offset:0 sc1 lds
    ds_read_b128 v[40:43], v249 offset:39936
    v_mfma_f32_16x16x32_bf16 v[100:103], a[48:51], v[68:71], v[100:103]
    ds_read_b64_tr_b16 a[118:119], v27 offset:53248
    ds_read_b64_tr_b16 a[120:121], v26 offset:57344
    v_mfma_f32_16x16x32_bf16 v[120:123], a[52:55], v[68:71], v[120:123]
    s_waitcnt lgkmcnt(5)
    v_mfma_f32_16x16x32_bf16 v[84:87], a[56:59], v[72:75], v[84:87]
    ds_read_b64_tr_b16 a[122:123], v26 offset:61440
    v_mfma_f32_16x16x32_bf16 v[104:107], a[60:63], v[72:75], v[104:107]
    v_mfma_f32_16x16x32_bf16 v[88:91], a[56:59], v[28:31], v[88:91]
    ds_read_b64_tr_b16 a[124:125], v27 offset:57344
    v_mfma_f32_16x16x32_bf16 v[108:111], a[60:63], v[28:31], v[108:111]
    v_mfma_f32_16x16x32_bf16 v[92:95], a[56:59], v[32:35], v[92:95]
    ds_read_b64_tr_b16 a[126:127], v27 offset:61440
    v_mfma_f32_16x16x32_bf16 v[112:115], a[60:63], v[32:35], v[112:115]
    s_waitcnt lgkmcnt(4)
    v_mfma_f32_16x16x32_bf16 v[96:99], a[56:59], v[36:39], v[96:99]
    v_mfma_f32_16x16x32_bf16 v[116:119], a[60:63], v[36:39], v[116:119]
    v_mfma_f32_16x16x32_bf16 v[100:103], a[56:59], v[40:43], v[100:103]
    v_mfma_f32_16x16x32_bf16 v[120:123], a[60:63], v[40:43], v[120:123]
    s_waitcnt vmcnt(5)
    s_barrier
    ds_read_b128 v[44:47], v249 offset:40960
    ds_read_b128 v[48:51], v249 offset:45056
    ds_read_b128 v[52:55], v249 offset:49152
    ds_read_b128 v[56:59], v249 offset:53248
    ds_read_b128 v[60:63], v249 offset:57344
    ds_read_b128 v[64:67], v249 offset:41984
    s_waitcnt lgkmcnt(5)
    v_mfma_f32_16x16x32_bf16 v[84:87], a[64:67], v[44:47], v[84:87]
    ds_read_b128 v[68:71], v249 offset:46080
    v_mfma_f32_16x16x32_bf16 v[104:107], a[68:71], v[44:47], v[104:107]
    s_waitcnt lgkmcnt(5)
    v_mfma_f32_16x16x32_bf16 v[88:91], a[64:67], v[48:51], v[88:91]
    ds_read_b128 v[72:75], v249 offset:50176
    v_mfma_f32_16x16x32_bf16 v[108:111], a[68:71], v[48:51], v[108:111]
    s_waitcnt lgkmcnt(5)
    v_mfma_f32_16x16x32_bf16 v[92:95], a[64:67], v[52:55], v[92:95]
    ds_read_b128 v[28:31], v249 offset:54272
    v_mfma_f32_16x16x32_bf16 v[112:115], a[68:71], v[52:55], v[112:115]
    s_waitcnt lgkmcnt(5)
    v_mfma_f32_16x16x32_bf16 v[96:99], a[64:67], v[56:59], v[96:99]
    ds_read_b128 v[32:35], v249 offset:58368
    v_mfma_f32_16x16x32_bf16 v[116:119], a[68:71], v[56:59], v[116:119]
    s_waitcnt lgkmcnt(3)
    v_mfma_f32_16x16x32_bf16 v[100:103], a[64:67], v[60:63], v[100:103]
    ds_read_b128 v[36:39], v249 offset:43008
    v_mfma_f32_16x16x32_bf16 v[120:123], a[68:71], v[60:63], v[120:123]
    v_mfma_f32_16x16x32_bf16 v[84:87], a[72:75], v[64:67], v[84:87]
    ds_read_b128 v[40:43], v249 offset:47104
    v_mfma_f32_16x16x32_bf16 v[104:107], a[76:79], v[64:67], v[104:107]
    v_mfma_f32_16x16x32_bf16 v[88:91], a[72:75], v[68:71], v[88:91]
    ds_read_b128 v[44:47], v249 offset:51200
    v_mfma_f32_16x16x32_bf16 v[108:111], a[76:79], v[68:71], v[108:111]
    s_waitcnt lgkmcnt(4)
    v_mfma_f32_16x16x32_bf16 v[92:95], a[72:75], v[72:75], v[92:95]
    ds_read_b128 v[48:51], v249 offset:55296
    v_mfma_f32_16x16x32_bf16 v[112:115], a[76:79], v[72:75], v[112:115]
    v_mfma_f32_16x16x32_bf16 v[96:99], a[72:75], v[28:31], v[96:99]
    ds_read_b128 v[52:55], v249 offset:59392
    v_mfma_f32_16x16x32_bf16 v[116:119], a[76:79], v[28:31], v[116:119]
    s_waitcnt lgkmcnt(4)
    v_mfma_f32_16x16x32_bf16 v[100:103], a[72:75], v[32:35], v[100:103]
    ds_read_b128 v[56:59], v249 offset:44032
    v_mfma_f32_16x16x32_bf16 v[120:123], a[76:79], v[32:35], v[120:123]
    v_mfma_f32_16x16x32_bf16 v[84:87], a[80:83], v[36:39], v[84:87]
    ds_read_b128 v[60:63], v249 offset:48128
    v_mfma_f32_16x16x32_bf16 v[104:107], a[84:87], v[36:39], v[104:107]
    s_waitcnt lgkmcnt(4)
    v_mfma_f32_16x16x32_bf16 v[88:91], a[80:83], v[40:43], v[88:91]
    ds_read_b128 v[64:67], v249 offset:52224
    v_mfma_f32_16x16x32_bf16 v[108:111], a[84:87], v[40:43], v[108:111]
    v_mfma_f32_16x16x32_bf16 v[92:95], a[80:83], v[44:47], v[92:95]
    ds_read_b128 v[68:71], v249 offset:56320
    v_mfma_f32_16x16x32_bf16 v[112:115], a[84:87], v[44:47], v[112:115]
    s_waitcnt lgkmcnt(4)
    v_mfma_f32_16x16x32_bf16 v[96:99], a[80:83], v[48:51], v[96:99]
    ds_read_b128 v[72:75], v249 offset:60416
    v_mfma_f32_16x16x32_bf16 v[116:119], a[84:87], v[48:51], v[116:119]
    v_mfma_f32_16x16x32_bf16 v[100:103], a[80:83], v[52:55], v[100:103]
    v_mfma_f32_16x16x32_bf16 v[120:123], a[84:87], v[52:55], v[120:123]
    s_waitcnt lgkmcnt(3)
    v_mfma_f32_16x16x32_bf16 v[84:87], a[88:91], v[56:59], v[84:87]
    v_mfma_f32_16x16x32_bf16 v[104:107], a[92:95], v[56:59], v[104:107]
    v_mfma_f32_16x16x32_bf16 v[88:91], a[88:91], v[60:63], v[88:91]
    v_mfma_f32_16x16x32_bf16 v[108:111], a[92:95], v[60:63], v[108:111]
    s_waitcnt lgkmcnt(1)
    v_mfma_f32_16x16x32_bf16 v[92:95], a[88:91], v[64:67], v[92:95]
    v_mfma_f32_16x16x32_bf16 v[112:115], a[92:95], v[64:67], v[112:115]
    v_mfma_f32_16x16x32_bf16 v[96:99], a[88:91], v[68:71], v[96:99]
    v_mfma_f32_16x16x32_bf16 v[116:119], a[92:95], v[68:71], v[116:119]
    s_waitcnt lgkmcnt(0)
    v_mfma_f32_16x16x32_bf16 v[100:103], a[88:91], v[72:75], v[100:103]
    v_mfma_f32_16x16x32_bf16 v[120:123], a[92:95], v[72:75], v[120:123]
    s_waitcnt vmcnt(0)
    s_barrier
    ds_read_b128 v[28:31], v249 offset:61440
    ds_read_b128 v[32:35], v250 offset:0
    ds_read_b128 v[36:39], v250 offset:4096
    ds_read_b128 v[40:43], v250 offset:8192
    ds_read_b128 v[44:47], v250 offset:12288
    ds_read_b128 v[48:51], v249 offset:62464
    s_waitcnt lgkmcnt(5)
    v_mfma_f32_16x16x32_bf16 v[84:87], a[96:99], v[28:31], v[84:87]
    ds_read_b128 v[52:55], v250 offset:1024
    v_mfma_f32_16x16x32_bf16 v[104:107], a[100:103], v[28:31], v[104:107]
    s_waitcnt lgkmcnt(5)
    v_mfma_f32_16x16x32_bf16 v[88:91], a[96:99], v[32:35], v[88:91]
    ds_read_b128 v[56:59], v250 offset:5120
    v_mfma_f32_16x16x32_bf16 v[108:111], a[100:103], v[32:35], v[108:111]
    s_waitcnt lgkmcnt(5)
    v_mfma_f32_16x16x32_bf16 v[92:95], a[96:99], v[36:39], v[92:95]
    ds_read_b128 v[60:63], v250 offset:9216
    v_mfma_f32_16x16x32_bf16 v[112:115], a[100:103], v[36:39], v[112:115]
    s_waitcnt lgkmcnt(5)
    v_mfma_f32_16x16x32_bf16 v[96:99], a[96:99], v[40:43], v[96:99]
    ds_read_b128 v[64:67], v250 offset:13312
    v_mfma_f32_16x16x32_bf16 v[116:119], a[100:103], v[40:43], v[116:119]
    s_waitcnt lgkmcnt(3)
    v_mfma_f32_16x16x32_bf16 v[100:103], a[96:99], v[44:47], v[100:103]
    ds_read_b128 v[68:71], v249 offset:63488
    v_mfma_f32_16x16x32_bf16 v[120:123], a[100:103], v[44:47], v[120:123]
    v_mfma_f32_16x16x32_bf16 v[84:87], a[104:107], v[48:51], v[84:87]
    ds_read_b128 v[72:75], v250 offset:2048
    v_mfma_f32_16x16x32_bf16 v[104:107], a[108:111], v[48:51], v[104:107]
    v_mfma_f32_16x16x32_bf16 v[88:91], a[104:107], v[52:55], v[88:91]
    ds_read_b128 v[28:31], v250 offset:6144
    v_mfma_f32_16x16x32_bf16 v[108:111], a[108:111], v[52:55], v[108:111]
    s_waitcnt lgkmcnt(4)
    v_mfma_f32_16x16x32_bf16 v[92:95], a[104:107], v[56:59], v[92:95]
    ds_read_b128 v[32:35], v250 offset:10240
    v_mfma_f32_16x16x32_bf16 v[112:115], a[108:111], v[56:59], v[112:115]
    v_mfma_f32_16x16x32_bf16 v[96:99], a[104:107], v[60:63], v[96:99]
    ds_read_b128 v[36:39], v250 offset:14336
    v_mfma_f32_16x16x32_bf16 v[116:119], a[108:111], v[60:63], v[116:119]
    s_waitcnt lgkmcnt(4)
    v_mfma_f32_16x16x32_bf16 v[100:103], a[104:107], v[64:67], v[100:103]
    ds_read_b128 v[40:43], v249 offset:64512
    v_mfma_f32_16x16x32_bf16 v[120:123], a[108:111], v[64:67], v[120:123]
    v_mfma_f32_16x16x32_bf16 v[84:87], a[112:115], v[68:71], v[84:87]
    ds_read_b128 v[44:47], v250 offset:3072
    v_mfma_f32_16x16x32_bf16 v[104:107], a[116:119], v[68:71], v[104:107]
    s_waitcnt lgkmcnt(4)
    v_mfma_f32_16x16x32_bf16 v[88:91], a[112:115], v[72:75], v[88:91]
    ds_read_b128 v[48:51], v250 offset:7168
    v_mfma_f32_16x16x32_bf16 v[108:111], a[116:119], v[72:75], v[108:111]
    v_mfma_f32_16x16x32_bf16 v[92:95], a[112:115], v[28:31], v[92:95]
    ds_read_b128 v[52:55], v250 offset:11264
    v_mfma_f32_16x16x32_bf16 v[112:115], a[116:119], v[28:31], v[112:115]
    s_waitcnt lgkmcnt(4)
    v_mfma_f32_16x16x32_bf16 v[96:99], a[112:115], v[32:35], v[96:99]
    ds_read_b128 v[56:59], v250 offset:15360
    v_mfma_f32_16x16x32_bf16 v[116:119], a[116:119], v[32:35], v[116:119]
    v_mfma_f32_16x16x32_bf16 v[100:103], a[112:115], v[36:39], v[100:103]
    v_mfma_f32_16x16x32_bf16 v[120:123], a[116:119], v[36:39], v[120:123]
    s_waitcnt lgkmcnt(3)
    v_mfma_f32_16x16x32_bf16 v[84:87], a[120:123], v[40:43], v[84:87]
    v_mfma_f32_16x16x32_bf16 v[104:107], a[124:127], v[40:43], v[104:107]
    v_mfma_f32_16x16x32_bf16 v[88:91], a[120:123], v[44:47], v[88:91]
    v_mfma_f32_16x16x32_bf16 v[108:111], a[124:127], v[44:47], v[108:111]
    s_waitcnt lgkmcnt(1)
    v_mfma_f32_16x16x32_bf16 v[92:95], a[120:123], v[48:51], v[92:95]
    v_mfma_f32_16x16x32_bf16 v[112:115], a[124:127], v[48:51], v[112:115]
    v_mfma_f32_16x16x32_bf16 v[96:99], a[120:123], v[52:55], v[96:99]
    v_mfma_f32_16x16x32_bf16 v[116:119], a[124:127], v[52:55], v[116:119]
    s_waitcnt lgkmcnt(0)
    v_mfma_f32_16x16x32_bf16 v[100:103], a[120:123], v[56:59], v[100:103]
    v_mfma_f32_16x16x32_bf16 v[120:123], a[124:127], v[56:59], v[120:123]
    s_lshl_b32 s28, s21, 2
    s_add_u32 s28, s28, s22
    s_mul_i32 s28, s28, 20
    s_mul_i32 s29, s20, 5
    s_add_u32 s28, s28, s29
    s_lshl_b32 s28, s28, 3
    s_add_u32 s28, s28, s23
    s_lshl_b32 s28, s28, 10
    s_add_u32 s28, s28, 35651584
    v_cvt_pk_bf16_f32 v28, v84, v85
    v_cvt_pk_bf16_f32 v29, v86, v87
    v_cvt_pk_bf16_f32 v30, v104, v105
    v_cvt_pk_bf16_f32 v31, v106, v107
    s_add_u32 s29, s28, 0
    buffer_store_dwordx4 v[28:31], v252, s[40:43], s29 offen sc1
    v_cvt_pk_bf16_f32 v32, v88, v89
    v_cvt_pk_bf16_f32 v33, v90, v91
    v_cvt_pk_bf16_f32 v34, v108, v109
    v_cvt_pk_bf16_f32 v35, v110, v111
    s_add_u32 s29, s28, 8192
    buffer_store_dwordx4 v[32:35], v252, s[40:43], s29 offen sc1
    v_cvt_pk_bf16_f32 v36, v92, v93
    v_cvt_pk_bf16_f32 v37, v94, v95
    v_cvt_pk_bf16_f32 v38, v112, v113
    v_cvt_pk_bf16_f32 v39, v114, v115
    s_add_u32 s29, s28, 16384
    buffer_store_dwordx4 v[36:39], v252, s[40:43], s29 offen sc1
    v_cvt_pk_bf16_f32 v40, v96, v97
    v_cvt_pk_bf16_f32 v41, v98, v99
    v_cvt_pk_bf16_f32 v42, v116, v117
    v_cvt_pk_bf16_f32 v43, v118, v119
    s_add_u32 s29, s28, 24576
    buffer_store_dwordx4 v[40:43], v252, s[40:43], s29 offen sc1
    v_cvt_pk_bf16_f32 v44, v100, v101
    v_cvt_pk_bf16_f32 v45, v102, v103
    v_cvt_pk_bf16_f32 v46, v120, v121
    v_cvt_pk_bf16_f32 v47, v122, v123
    s_add_u32 s29, s28, 32768
    buffer_store_dwordx4 v[44:47], v252, s[40:43], s29 offen sc1
    s_lshl_b32 s28, s21, 2
    s_add_u32 s28, s28, s22
    s_mov_b32 s67, s28
    s_lshl_b32 s28, s28, 2
    s_add_u32 s29, s28, s20
    s_lshl_b32 s29, s29, 6
    s_add_u32 s29, s29, 42041344
    s_lshl_b32 s30, s23, 3
    s_add_u32 s31, s29, s30
    s_waitcnt vmcnt(0)
    v_mov_b32 v4, s31
    v_mov_b32 v6, s64
    v_mov_b32 v7, 0
    s_mov_b64 exec, 1
    buffer_store_dwordx2 v[6:7], v4, s[40:43], 0 offen sc1
    s_mov_b64 exec, -1
    s_cmp_lt_u32 s23, 5
    s_cbranch_scc0 L_done
    s_lshl_b32 s28, s23, 2
    s_add_u32 s65, s28, s20
    s_mul_i32 s29, s65, 52
    s_lshr_b32 s92, s29, 8
    s_cmp_eq_u32 s20, 0
    s_cbranch_scc0 L_nopoll3
    s_add_u32 s29, s28, 3
    s_mul_i32 s29, s29, 52
    s_lshr_b32 s29, s29, 8
    s_sub_u32 s29, s29, s92
    s_lshl_b32 s28, s67, 2
    s_add_u32 s28, s28, s92
    s_lshl_b32 s28, s28, 6
    s_add_u32 s31, s28, 42041344
    v_and_b32 v4, 7, v0
    v_lshlrev_b32 v4, 3, v4
    v_bfe_u32 v5, v0, 3, 1
    v_mul_lo_u32 v5, v5, s29
    v_lshl_add_u32 v4, v5, 6, v4
    v_add_u32 v4, s31, v4
    s_mov_b32 s29, 0
L_pf6:
    buffer_load_dwordx2 v[6:7], v4, s[40:43], 0 offen sc1
    s_waitcnt vmcnt(0)
    v_cmp_ne_u32 vcc, s64, v6
    s_nop 3
    s_cbranch_vccz L_pf6_ok
    s_add_u32 s29, s29, 1
    s_cmp_lt_u32 s29, 0x40000
    s_sleep 1
    s_cbranch_scc1 L_pf6
L_pf6_ok:
L_nopoll3:
    s_barrier
    s_mul_i32 s29, s67, 20
    s_add_u32 s29, s29, s65
    s_lshl_b32 s29, s29, 13
    s_add_u32 s29, s29, 35651584
    s_add_u32 s30, s29, 4096
    buffer_load_dwordx4 v[84:87], v252, s[40:43], s29 offen offset:0 sc1
    buffer_load_dwordx4 v[88:91], v252, s[40:43], s29 offen offset:1024 sc1
    buffer_load_dwordx4 v[92:95], v252, s[40:43], s29 offen offset:2048 sc1
    buffer_load_dwordx4 v[96:99], v252, s[40:43], s29 offen offset:3072 sc1
    buffer_load_dwordx4 v[100:103], v252, s[40:43], s30 offen offset:0 sc1
    buffer_load_dwordx4 v[104:107], v252, s[40:43], s30 offen offset:1024 sc1
    buffer_load_dwordx4 v[108:111], v252, s[40:43], s30 offen offset:2048 sc1
    buffer_load_dwordx4 v[112:115], v252, s[40:43], s30 offen offset:3072 sc1
    s_waitcnt vmcnt(7)
    v_mfma_f32_16x16x32_bf16 v[60:63], a[168:171], v[84:87], 0
    v_mfma_f32_16x16x32_bf16 v[64:67], a[172:175], v[84:87], 0
    s_waitcnt vmcnt(6)
    v_mfma_f32_16x16x32_bf16 v[60:63], a[168:171], v[88:91], v[60:63]
    v_mfma_f32_16x16x32_bf16 v[64:67], a[172:175], v[88:91], v[64:67]
    s_waitcnt vmcnt(5)
    v_mfma_f32_16x16x32_bf16 v[60:63], a[168:171], v[92:95], v[60:63]
    v_mfma_f32_16x16x32_bf16 v[64:67], a[172:175], v[92:95], v[64:67]
    s_waitcnt vmcnt(4)
    v_mfma_f32_16x16x32_bf16 v[60:63], a[168:171], v[96:99], v[60:63]
    v_mfma_f32_16x16x32_bf16 v[64:67], a[172:175], v[96:99], v[64:67]
    s_waitcnt vmcnt(3)
    v_mfma_f32_16x16x32_bf16 v[60:63], a[168:171], v[100:103], v[60:63]
    v_mfma_f32_16x16x32_bf16 v[64:67], a[172:175], v[100:103], v[64:67]
    s_waitcnt vmcnt(2)
    v_mfma_f32_16x16x32_bf16 v[60:63], a[168:171], v[104:107], v[60:63]
    v_mfma_f32_16x16x32_bf16 v[64:67], a[172:175], v[104:107], v[64:67]
    s_waitcnt vmcnt(1)
    v_mfma_f32_16x16x32_bf16 v[60:63], a[168:171], v[108:111], v[60:63]
    v_mfma_f32_16x16x32_bf16 v[64:67], a[172:175], v[108:111], v[64:67]
    s_waitcnt vmcnt(0)
    v_mfma_f32_16x16x32_bf16 v[60:63], a[168:171], v[112:115], v[60:63]
    v_mfma_f32_16x16x32_bf16 v[64:67], a[172:175], v[112:115], v[64:67]
    s_mul_i32 s29, s92, 5
    s_sub_u32 s29, s65, s29
    s_lshl_b32 s29, s29, 14
    s_lshl_b32 s28, s92, 6
    s_add_u32 s28, s28, s29
    s_lshl_b32 s29, s22, 8
    s_add_u32 s28, s28, s29
    s_mul_i32 s29, s21, 81920
    s_add_u32 s28, s28, s29
    v_lshlrev_b32 v4, 10, v2
    v_lshl_add_u32 v4, v3, 3, v4
    v_cvt_pk_bf16_f32 v68, v60, v61
    v_cvt_pk_bf16_f32 v69, v62, v63
    v_cvt_pk_bf16_f32 v70, v64, v65
    v_cvt_pk_bf16_f32 v71, v66, v67
    buffer_store_dwordx2 v[68:69], v4, s[56:59], s28 offen
    buffer_store_dwordx2 v[70:71], v4, s[56:59], s28 offen offset:32
L_done:
    s_waitcnt vmcnt(0)
    s_endpgm
L_fallback:
    s_mov_b32 s27, 1
    s_waitcnt vmcnt(0) lgkmcnt(0)
    s_barrier
    s_branch L_restart
L_end:
    s_endpgm

.section .rodata,"a"
.p2align 6
.amdhsa_kernel standalone__gqa_block_cached__near_ridge_kernel
  .amdhsa_next_free_vgpr 512
  .amdhsa_next_free_sgpr 102
  .amdhsa_accum_offset 256
  .amdhsa_group_segment_fixed_size 0
  .amdhsa_kernarg_size 64
  .amdhsa_user_sgpr_count 2
  .amdhsa_user_sgpr_kernarg_segment_ptr 1
  .amdhsa_system_sgpr_workgroup_id_x 1
.end_amdhsa_kernel
```
